```python
import torch

def _softmax(x, axis=-1):
    return torch.softmax(x, dim=axis)
def _gelu(x):
    return torch.nn.functional.gelu(x, approximate="tanh")
def _silu(x):
    return torch.nn.functional.silu(x)
def _sigmoid(x):
    return torch.sigmoid(x)
def _layernorm(x, axis=-1, eps=1e-5):
    m = x.mean(dim=axis, keepdim=True)
    v = x.var(dim=axis, keepdim=True, unbiased=False)
    return (x - m) / torch.sqrt(v + eps)
def _scatter_add(tgt, idx, src, axis=0):
    return tgt.clone().index_add_(axis, idx, src)
def _segment_sum(src, seg, n):
    out = torch.zeros((n,) + src.shape[1:], dtype=src.dtype)
    return out.index_add_(0, seg, src)
def _pad(x, pw):
    flat = tuple(v for pair in reversed(pw) for v in pair)
    return torch.nn.functional.pad(x, flat)

kernel_name = 'standalone__gqa_block_cached__near_ridge'

def setup_inputs():

    _w = (lambda a: (lambda t: t.to(torch.bfloat16) if t.is_floating_point() else t)(torch.as_tensor(a)))
    B, Sq, D = 8, 256, 640
    Hq, Hkv, Sk, Dh = 32, 32, 1024, 192
    assert Hq % Hkv == 0, (Hq, Hkv)
    return {
        "x": _w((lambda *s: torch.randn(*s, dtype=torch.bfloat16) * 0.8)(B, Sq, D)),
        "k_cache": _w((lambda *s: torch.randn(*s, dtype=torch.bfloat16) * 0.8)(B, Hkv, Sk, Dh)),
        "v_cache": _w((lambda *s: torch.randn(*s, dtype=torch.bfloat16) * 0.05)(B, Hkv, Sk, Dh)),
        "wq": _w((lambda *s: torch.randn(*s, dtype=torch.bfloat16) * 0.8)(D, Hq * Dh) * (D ** -0.5)),
        "wo": _w((lambda *s: torch.randn(*s, dtype=torch.bfloat16) * 0.05)(Hq * Dh, D) * ((Hq * Dh) ** -0.5)),
    }

def reference(x, k_cache, v_cache, wq, wo):
    B, Sq, D = x.shape
    Hq, Dh = 32, 192
    Hkv = k_cache.shape[1]
    rep = Hq // Hkv
    q = (lambda x, *d: x.permute(*d))((x @ wq).reshape(B, Sq, Hq, Dh), 0, 2, 1, 3)
    k = (lambda x, n, axis: torch.repeat_interleave(x, n, dim=axis))(k_cache, rep, axis=1)
    v = (lambda x, n, axis: torch.repeat_interleave(x, n, dim=axis))(v_cache, rep, axis=1)
    scores = torch.einsum("bhqd,bhkd->bhqk", q, k) * (Dh ** -0.5)
    p = _softmax(scores, axis=-1)
    o = torch.einsum("bhqk,bhkd->bhqd", p, v)
    return (lambda x, *d: x.permute(*d))(o, 0, 2, 1, 3).reshape(B, Sq, Hq * Dh) @ wo
```

```asm
; @launch grid=(256,1,1) block=(256,1,1) lds=163840
.amdgcn_target "amdgcn-amd-amdhsa--gfx950"
.text
.globl standalone__gqa_block_cached__near_ridge_kernel
.p2align 8
.type standalone__gqa_block_cached__near_ridge_kernel,@function
standalone__gqa_block_cached__near_ridge_kernel:
    s_cmp_ge_u32 s2, 256
    s_cbranch_scc1 K_END
    s_load_dwordx16 s[4:19], s[0:1], 0
    s_getpc_b64 s[56:57]
K_PC:
    s_lshr_b32 s3, s2, 3
    s_lshl_b32 s3, s3, 11
    v_lshrrev_b32 v36, 4, v0
    v_lshl_add_u32 v36, v36, 7, s3
    v_min_u32 v36, K_CODE_END-K_PC-4, v36
    global_load_dword v47, v36, s[56:57]
    v_lshrrev_b32 v38, 6, v0
    v_and_b32 v37, 63, v0
    v_readfirstlane_b32 s40, v38
    s_and_b32 s100, s2, 1
    s_lshl_b32 s100, s100, 2
    s_bfe_u32 s3, s2, 0x20003
    s_add_u32 s100, s100, s3
    s_bfe_u32 s101, s2, 0x20001
    s_lshl_b32 s101, s101, 3
    s_lshr_b32 s3, s2, 5
    s_add_u32 s101, s101, s3
    s_mul_i32 s41, s40, 3072
    s_lshl_b32 s42, s40, 13
    s_add_u32 s42, s42, 98304
    s_mul_i32 s53, s40, 81920
    v_lshrrev_b32 v38, 3, v37
    v_mul_u32_u24 v38, 1280, v38
    v_add_u32 v38, s53, v38
    v_and_b32 v39, 7, v37
    v_lshrrev_b32 v40, 4, v37
    v_xor_b32 v39, v39, v40
    v_lshl_add_u32 v51, v39, 4, v38
    v_xor_b32 v39, 4, v39
    v_lshl_add_u32 v52, v39, 4, v38
    s_and_b32 s53, s40, 1
    s_lshl_b32 s53, s53, 2
    s_lshr_b32 s3, s40, 1
    s_add_u32 s53, s53, s3
    s_mul_i32 s53, s53, 49152
    v_add_u32 v38, 0, v37
    v_mul_u32_u24 v38, 2731, v38
    v_lshrrev_b32 v38, 16, v38
    v_and_b32 v39, 2, v38
    v_lshlrev_b32 v39, 1, v39
    v_bfe_u32 v40, v38, 2, 1
    v_lshl_or_b32 v39, v40, 0, v39
    v_xor_b32 v39, v39, v37
    v_lshlrev_b32 v39, 4, v39
    v_mul_u32_u24 v40, 49152, v40
    v_mul_u32_u24 v38, 11904, v38
    v_add3_u32 v38, v38, v39, v40
    v_add_u32 v48, s53, v38
    v_add_u32 v38, 64, v37
    v_mul_u32_u24 v38, 2731, v38
    v_lshrrev_b32 v38, 16, v38
    v_and_b32 v39, 2, v38
    v_lshlrev_b32 v39, 1, v39
    v_bfe_u32 v40, v38, 2, 1
    v_lshl_or_b32 v39, v40, 0, v39
    v_xor_b32 v39, v39, v37
    v_lshlrev_b32 v39, 4, v39
    v_mul_u32_u24 v40, 49152, v40
    v_mul_u32_u24 v38, 11904, v38
    v_add3_u32 v38, v38, v39, v40
    v_add_u32 v49, s53, v38
    v_add_u32 v38, 128, v37
    v_mul_u32_u24 v38, 2731, v38
    v_lshrrev_b32 v38, 16, v38
    v_and_b32 v39, 2, v38
    v_lshlrev_b32 v39, 1, v39
    v_bfe_u32 v40, v38, 2, 1
    v_lshl_or_b32 v39, v40, 0, v39
    v_xor_b32 v39, v39, v37
    v_lshlrev_b32 v39, 4, v39
    v_mul_u32_u24 v40, 49152, v40
    v_mul_u32_u24 v38, 11904, v38
    v_add3_u32 v38, v38, v39, v40
    v_add_u32 v50, s53, v38
    s_mul_i32 s3, s100, 327680
    s_mul_i32 s53, s101, 384
    s_mov_b32 s22, 327680
    s_mov_b32 s23, 0x20000
    s_sub_u32 s26, 7864320, s53
    s_mov_b32 s27, 0x20000
    s_waitcnt lgkmcnt(0)
    s_add_u32 s20, s4, s3
    s_addc_u32 s21, s5, 0
    s_add_u32 s24, s10, s53
    s_addc_u32 s25, s11, 0
    s_add_u32 m0, s41, 49152
    s_mov_b32 s53, 0
    buffer_load_dwordx4 v48, s[24:27], s53 offen offset:0 lds
    buffer_load_dwordx4 v49, s[24:27], s53 offen offset:1024 lds
    buffer_load_dwordx4 v50, s[24:27], s53 offen offset:2048 lds
    s_add_u32 m0, s42, 0
    s_mov_b32 s53, 0
    buffer_load_dwordx4 v51, s[20:23], s53 offen offset:0 lds
    s_mov_b32 s53, 9216
    buffer_load_dwordx4 v52, s[20:23], s53 offen offset:1024 lds
    s_mov_b32 s53, 18432
    buffer_load_dwordx4 v51, s[20:23], s53 offen offset:2048 lds
    s_mov_b32 s53, 27648
    buffer_load_dwordx4 v52, s[20:23], s53 offen offset:3072 lds
    s_add_u32 m0, s42, 4096
    s_mov_b32 s53, 40960
    buffer_load_dwordx4 v51, s[20:23], s53 offen offset:0 lds
    s_mov_b32 s53, 50176
    buffer_load_dwordx4 v52, s[20:23], s53 offen offset:1024 lds
    s_mov_b32 s53, 59392
    buffer_load_dwordx4 v51, s[20:23], s53 offen offset:2048 lds
    s_mov_b32 s53, 68608
    buffer_load_dwordx4 v52, s[20:23], s53 offen offset:3072 lds
    s_add_u32 m0, s41, 61440
    s_mov_b32 s53, 393216
    buffer_load_dwordx4 v48, s[24:27], s53 offen offset:0 lds
    buffer_load_dwordx4 v49, s[24:27], s53 offen offset:1024 lds
    buffer_load_dwordx4 v50, s[24:27], s53 offen offset:2048 lds
    v_lshrrev_b32 v42, 4, v37
    v_bfe_u32 v43, v37, 2, 2
    v_and_b32 v44, 3, v37
    v_lshlrev_b32 v44, 3, v44
    v_and_b32 v38, 15, v37
    v_bfe_u32 v39, v37, 1, 3
    v_xor_b32 v39, v39, v42
    v_lshlrev_b32 v40, 7, v38
    v_add_u32 v40, s42, v40
    v_lshl_add_u32 v53, v39, 4, v40
    v_xor_b32 v39, 4, v39
    v_lshl_add_u32 v54, v39, 4, v40
    v_lshl_or_b32 v38, v42, 2, v43
    v_and_b32 v39, 2, v38
    v_lshlrev_b32 v39, 1, v39
    v_bfe_u32 v41, v38, 2, 1
    v_lshl_or_b32 v39, v41, 0, v39
    v_and_b32 v41, 3, v37
    v_xor_b32 v39, v39, v41
    v_mul_u32_u24 v40, 384, v38
    v_and_b32 v41, 8, v44
    v_add_u32 v40, v40, v41
    v_lshl_add_u32 v55, v39, 4, v40
    v_xor_b32 v56, 8, v55
    v_xor_b32 v39, 4, v39
    v_lshl_add_u32 v57, v39, 4, v40
    v_xor_b32 v58, 8, v57
    v_add_u32 v59, 36864, v55
    v_add_u32 v60, 36864, v56
    v_add_u32 v61, 36864, v57
    v_add_u32 v62, 36864, v58
    v_lshlrev_b32 v46, 7, v37
    s_lshl_b32 s3, s100, 5
    s_add_u32 s3, s3, s101
    s_mul_i32 s3, s3, 393216
    s_add_u32 s28, s6, s3
    s_addc_u32 s29, s7, 0
    s_mov_b32 s30, 393216
    s_mov_b32 s31, 0x20000
    s_add_u32 s32, s8, s3
    s_addc_u32 s33, s9, 0
    s_mov_b32 s34, 393216
    s_mov_b32 s35, 0x20000
    s_mul_i32 s3, s100, 3145728
    s_mul_i32 s53, s101, 12288
    s_add_u32 s3, s3, s53
    s_add_u32 s36, s18, s3
    s_addc_u32 s37, s19, 0
    s_sub_u32 s38, 3145728, s53
    s_mov_b32 s39, 0x20000
    s_add_u32 s6, s18, 50331648
    s_addc_u32 s7, s19, 0
    s_lshr_b32 s3, s101, 3
    s_mul_i32 s3, s3, 1966080
    s_add_u32 s8, s12, s3
    s_addc_u32 s9, s13, 0
    s_mov_b32 s10, 1966080
    s_mov_b32 s11, 0x20000
    s_lshr_b32 s4, s2, 3
    s_lshl_b32 s4, s4, 2
    s_add_u32 s4, s4, s40
    s_lshl_b32 s4, s4, 13
    s_sub_u32 s4, s4, 12582912
    s_lshl_b32 s3, s100, 7
    s_add_u32 s3, s3, 65536
    s_load_dword s5, s[6:7], s3
    v_add_u32 v38, 0, v0
    v_mul_u32_u24 v40, 2731, v38
    v_lshrrev_b32 v40, 16, v40
    v_and_b32 v39, 2, v40
    v_lshlrev_b32 v39, 1, v39
    v_bfe_u32 v41, v40, 2, 1
    v_lshl_or_b32 v39, v41, 1, v39
    v_xor_b32 v39, v39, v38
    v_lshlrev_b32 v1, 4, v39
    v_add_u32 v38, 256, v0
    v_mul_u32_u24 v40, 2731, v38
    v_lshrrev_b32 v40, 16, v40
    v_and_b32 v39, 2, v40
    v_lshlrev_b32 v39, 1, v39
    v_bfe_u32 v41, v40, 2, 1
    v_lshl_or_b32 v39, v41, 1, v39
    v_xor_b32 v39, v39, v38
    v_lshlrev_b32 v2, 4, v39
    v_add_u32 v38, 512, v0
    v_mul_u32_u24 v40, 2731, v38
    v_lshrrev_b32 v40, 16, v40
    v_and_b32 v39, 2, v40
    v_lshlrev_b32 v39, 1, v39
    v_bfe_u32 v41, v40, 2, 1
    v_lshl_or_b32 v39, v41, 1, v39
    v_xor_b32 v39, v39, v38
    v_lshlrev_b32 v3, 4, v39
    s_lshl_b32 s58, s40, 10
    s_add_u32 m0, s42, 32768
    s_mov_b32 s53, 128
    buffer_load_dwordx4 v51, s[20:23], s53 offen offset:0 lds
    s_mov_b32 s53, 9344
    buffer_load_dwordx4 v52, s[20:23], s53 offen offset:1024 lds
    s_mov_b32 s53, 18560
    buffer_load_dwordx4 v51, s[20:23], s53 offen offset:2048 lds
    s_mov_b32 s53, 27776
    buffer_load_dwordx4 v52, s[20:23], s53 offen offset:3072 lds
    s_add_u32 m0, s42, 36864
    s_mov_b32 s53, 41088
    buffer_load_dwordx4 v51, s[20:23], s53 offen offset:0 lds
    s_mov_b32 s53, 50304
    buffer_load_dwordx4 v52, s[20:23], s53 offen offset:1024 lds
    s_mov_b32 s53, 59520
    buffer_load_dwordx4 v51, s[20:23], s53 offen offset:2048 lds
    s_mov_b32 s53, 68736
    buffer_load_dwordx4 v52, s[20:23], s53 offen offset:3072 lds
    s_add_u32 m0, s41, 0
    s_mov_b32 s53, 786432
    buffer_load_dwordx4 v48, s[24:27], s53 offen offset:0 lds
    buffer_load_dwordx4 v49, s[24:27], s53 offen offset:1024 lds
    buffer_load_dwordx4 v50, s[24:27], s53 offen offset:2048 lds
    s_add_u32 m0, s41, 12288
    s_mov_b32 s53, 1179648
    buffer_load_dwordx4 v48, s[24:27], s53 offen offset:0 lds
    buffer_load_dwordx4 v49, s[24:27], s53 offen offset:1024 lds
    buffer_load_dwordx4 v50, s[24:27], s53 offen offset:2048 lds
    s_waitcnt lgkmcnt(0)
    s_mul_i32 s5, s5, 0x9e3779b1
    s_add_u32 s5, s5, 0x7f4a7c15
    s_waitcnt vmcnt(17)
    s_barrier
    ds_read_b128 a[0:3], v53 offset:0
    ds_read_b128 a[4:7], v53 offset:2048
    ds_read_b128 a[8:11], v53 offset:4096
    ds_read_b128 a[12:15], v53 offset:6144
    ds_read_b128 a[16:19], v54 offset:0
    ds_read_b128 a[20:23], v54 offset:2048
    ds_read_b128 a[24:27], v54 offset:4096
    ds_read_b128 a[28:31], v54 offset:6144
    ds_read_b64_tr_b16 a[208:209], v59 offset:12288
    ds_read_b64_tr_b16 a[210:211], v59 offset:18432
    ds_read_b64_tr_b16 a[212:213], v60 offset:12288
    ds_read_b64_tr_b16 a[214:215], v60 offset:18432
    ds_read_b64_tr_b16 a[216:217], v61 offset:12288
    ds_read_b64_tr_b16 a[218:219], v61 offset:18432
    ds_read_b64_tr_b16 a[220:221], v62 offset:12288
    ds_read_b64_tr_b16 a[222:223], v62 offset:18432
    s_waitcnt lgkmcnt(6)
    v_mfma_f32_16x16x32_bf16 v[64:67], a[208:211], a[0:3], 0
    ds_read_b64_tr_b16 a[192:193], v59 offset:12416
    ds_read_b64_tr_b16 a[194:195], v59 offset:18560
    v_mfma_f32_16x16x32_bf16 v[72:75], a[208:211], a[4:7], 0
    s_add_u32 m0, s42, 0
    s_mov_b32 s53, 256
    v_mfma_f32_16x16x32_bf16 v[80:83], a[208:211], a[8:11], 0
    buffer_load_dwordx4 v51, s[20:23], s53 offen offset:0 lds
    v_mfma_f32_16x16x32_bf16 v[88:91], a[208:211], a[12:15], 0
    s_waitcnt lgkmcnt(6)
    v_mfma_f32_16x16x32_bf16 v[68:71], a[212:215], a[0:3], 0
    ds_read_b64_tr_b16 a[196:197], v60 offset:12416
    ds_read_b64_tr_b16 a[198:199], v60 offset:18560
    v_mfma_f32_16x16x32_bf16 v[76:79], a[212:215], a[4:7], 0
    v_mfma_f32_16x16x32_bf16 v[84:87], a[212:215], a[8:11], 0
    s_mov_b32 s53, 9472
    buffer_load_dwordx4 v52, s[20:23], s53 offen offset:1024 lds
    v_mfma_f32_16x16x32_bf16 v[92:95], a[212:215], a[12:15], 0
    s_waitcnt lgkmcnt(4)
    v_mfma_f32_16x16x32_bf16 v[96:99], a[216:219], a[0:3], 0
    ds_read_b64_tr_b16 a[200:201], v61 offset:12416
    ds_read_b64_tr_b16 a[202:203], v61 offset:18560
    v_mfma_f32_16x16x32_bf16 v[104:107], a[216:219], a[4:7], 0
    v_mfma_f32_16x16x32_bf16 v[112:115], a[216:219], a[8:11], 0
    s_mov_b32 s53, 18688
    buffer_load_dwordx4 v51, s[20:23], s53 offen offset:2048 lds
    v_mfma_f32_16x16x32_bf16 v[120:123], a[216:219], a[12:15], 0
    v_mfma_f32_16x16x32_bf16 v[100:103], a[220:223], a[0:3], 0
    ds_read_b64_tr_b16 a[204:205], v62 offset:12416
    ds_read_b64_tr_b16 a[206:207], v62 offset:18560
    v_mfma_f32_16x16x32_bf16 v[108:111], a[220:223], a[4:7], 0
    s_waitcnt vmcnt(17)
    s_barrier
    v_mfma_f32_16x16x32_bf16 v[116:119], a[220:223], a[8:11], 0
    s_mov_b32 s53, 27904
    buffer_load_dwordx4 v52, s[20:23], s53 offen offset:3072 lds
    v_mfma_f32_16x16x32_bf16 v[124:127], a[220:223], a[12:15], 0
    s_waitcnt lgkmcnt(4)
    v_mfma_f32_16x16x32_bf16 v[128:131], a[192:195], a[0:3], 0
    ds_read_b64_tr_b16 a[208:209], v59 offset:12544
    ds_read_b64_tr_b16 a[210:211], v59 offset:18688
    v_mfma_f32_16x16x32_bf16 v[136:139], a[192:195], a[4:7], 0
    v_mfma_f32_16x16x32_bf16 v[144:147], a[192:195], a[8:11], 0
    s_add_u32 m0, s41, 24576
    s_mov_b32 s53, 1572864
    v_mfma_f32_16x16x32_bf16 v[152:155], a[192:195], a[12:15], 0
    buffer_load_dwordx4 v48, s[24:27], s53 offen offset:0 lds
    v_mfma_f32_16x16x32_bf16 v[132:135], a[196:199], a[0:3], 0
    ds_read_b64_tr_b16 a[212:213], v60 offset:12544
    ds_read_b64_tr_b16 a[214:215], v60 offset:18688
    v_mfma_f32_16x16x32_bf16 v[140:143], a[196:199], a[4:7], 0
    v_mfma_f32_16x16x32_bf16 v[148:151], a[196:199], a[8:11], 0
    v_mfma_f32_16x16x32_bf16 v[156:159], a[196:199], a[12:15], 0
    s_waitcnt lgkmcnt(4)
    buffer_load_dwordx4 v49, s[24:27], s53 offen offset:1024 lds
    v_mfma_f32_16x16x32_bf16 v[160:163], a[200:203], a[0:3], 0
    ds_read_b64_tr_b16 a[216:217], v61 offset:12544
    ds_read_b64_tr_b16 a[218:219], v61 offset:18688
    v_mfma_f32_16x16x32_bf16 v[168:171], a[200:203], a[4:7], 0
    v_mfma_f32_16x16x32_bf16 v[176:179], a[200:203], a[8:11], 0
    v_mfma_f32_16x16x32_bf16 v[184:187], a[200:203], a[12:15], 0
    buffer_load_dwordx4 v50, s[24:27], s53 offen offset:2048 lds
    v_mfma_f32_16x16x32_bf16 v[164:167], a[204:207], a[0:3], 0
    s_waitcnt vmcnt(13)
    ds_read_b64_tr_b16 a[220:221], v62 offset:12544
    ds_read_b64_tr_b16 a[222:223], v62 offset:18688
    v_mfma_f32_16x16x32_bf16 v[172:175], a[204:207], a[4:7], 0
    v_mfma_f32_16x16x32_bf16 v[180:183], a[204:207], a[8:11], 0
    ds_read_b128 a[32:35], v53 offset:32768
    ds_read_b128 a[36:39], v53 offset:34816
    v_mfma_f32_16x16x32_bf16 v[188:191], a[204:207], a[12:15], 0
    s_waitcnt lgkmcnt(6)
    s_add_u32 m0, s42, 4096
    s_mov_b32 s53, 41216
    v_mfma_f32_16x16x32_bf16 v[192:195], a[208:211], a[0:3], 0
    ds_read_b64_tr_b16 a[192:193], v59 offset:24576
    ds_read_b64_tr_b16 a[194:195], v59 offset:30720
    v_mfma_f32_16x16x32_bf16 v[200:203], a[208:211], a[4:7], 0
    buffer_load_dwordx4 v51, s[20:23], s53 offen offset:0 lds
    v_mfma_f32_16x16x32_bf16 v[208:211], a[208:211], a[8:11], 0
    ds_read_b128 a[40:43], v53 offset:36864
    ds_read_b128 a[44:47], v53 offset:38912
    v_mfma_f32_16x16x32_bf16 v[216:219], a[208:211], a[12:15], 0
    v_mfma_f32_16x16x32_bf16 v[196:199], a[212:215], a[0:3], 0
    ds_read_b64_tr_b16 a[196:197], v60 offset:24576
    ds_read_b64_tr_b16 a[198:199], v60 offset:30720
    v_mfma_f32_16x16x32_bf16 v[204:207], a[212:215], a[4:7], 0
    s_mov_b32 s53, 50432
    buffer_load_dwordx4 v52, s[20:23], s53 offen offset:1024 lds
    v_mfma_f32_16x16x32_bf16 v[212:215], a[212:215], a[8:11], 0
    ds_read_b128 a[48:51], v54 offset:32768
    ds_read_b128 a[52:55], v54 offset:34816
    v_mfma_f32_16x16x32_bf16 v[220:223], a[212:215], a[12:15], 0
    s_waitcnt lgkmcnt(10)
    v_mfma_f32_16x16x32_bf16 v[224:227], a[216:219], a[0:3], 0
    ds_read_b64_tr_b16 a[200:201], v61 offset:24576
    ds_read_b64_tr_b16 a[202:203], v61 offset:30720
    v_mfma_f32_16x16x32_bf16 v[232:235], a[216:219], a[4:7], 0
    s_mov_b32 s53, 59648
    buffer_load_dwordx4 v51, s[20:23], s53 offen offset:2048 lds
    v_mfma_f32_16x16x32_bf16 v[240:243], a[216:219], a[8:11], 0
    ds_read_b128 a[56:59], v54 offset:36864
    ds_read_b128 a[60:63], v54 offset:38912
    v_mfma_f32_16x16x32_bf16 v[248:251], a[216:219], a[12:15], 0
    v_mfma_f32_16x16x32_bf16 v[228:231], a[220:223], a[0:3], 0
    ds_read_b64_tr_b16 a[204:205], v62 offset:24576
    ds_read_b64_tr_b16 a[206:207], v62 offset:30720
    v_mfma_f32_16x16x32_bf16 v[236:239], a[220:223], a[4:7], 0
    s_mov_b32 s53, 68864
    buffer_load_dwordx4 v52, s[20:23], s53 offen offset:3072 lds
    v_mfma_f32_16x16x32_bf16 v[244:247], a[220:223], a[8:11], 0
    v_mfma_f32_16x16x32_bf16 v[252:255], a[220:223], a[12:15], 0
    s_waitcnt lgkmcnt(8)
    v_mfma_f32_16x16x32_bf16 v[64:67], a[192:195], a[16:19], v[64:67]
    ds_read_b64_tr_b16 a[208:209], v59 offset:24704
    ds_read_b64_tr_b16 a[210:211], v59 offset:30848
    v_mfma_f32_16x16x32_bf16 v[72:75], a[192:195], a[20:23], v[72:75]
    s_add_u32 m0, s41, 36864
    s_mov_b32 s53, 1966080
    v_mfma_f32_16x16x32_bf16 v[80:83], a[192:195], a[24:27], v[80:83]
    buffer_load_dwordx4 v48, s[24:27], s53 offen offset:0 lds
    v_mfma_f32_16x16x32_bf16 v[88:91], a[192:195], a[28:31], v[88:91]
    v_mfma_f32_16x16x32_bf16 v[68:71], a[196:199], a[16:19], v[68:71]
    ds_read_b64_tr_b16 a[212:213], v60 offset:24704
    ds_read_b64_tr_b16 a[214:215], v60 offset:30848
    v_mfma_f32_16x16x32_bf16 v[76:79], a[196:199], a[20:23], v[76:79]
    v_mfma_f32_16x16x32_bf16 v[84:87], a[196:199], a[24:27], v[84:87]
    buffer_load_dwordx4 v49, s[24:27], s53 offen offset:1024 lds
    v_mfma_f32_16x16x32_bf16 v[92:95], a[196:199], a[28:31], v[92:95]
    s_waitcnt lgkmcnt(4)
    v_mfma_f32_16x16x32_bf16 v[96:99], a[200:203], a[16:19], v[96:99]
    ds_read_b64_tr_b16 a[216:217], v61 offset:24704
    ds_read_b64_tr_b16 a[218:219], v61 offset:30848
    v_mfma_f32_16x16x32_bf16 v[104:107], a[200:203], a[20:23], v[104:107]
    v_mfma_f32_16x16x32_bf16 v[112:115], a[200:203], a[24:27], v[112:115]
    buffer_load_dwordx4 v50, s[24:27], s53 offen offset:2048 lds
    v_mfma_f32_16x16x32_bf16 v[120:123], a[200:203], a[28:31], v[120:123]
    v_mfma_f32_16x16x32_bf16 v[100:103], a[204:207], a[16:19], v[100:103]
    ds_read_b64_tr_b16 a[220:221], v62 offset:24704
    ds_read_b64_tr_b16 a[222:223], v62 offset:30848
    v_mfma_f32_16x16x32_bf16 v[108:111], a[204:207], a[20:23], v[108:111]
    s_waitcnt vmcnt(17)
    s_barrier
    v_mfma_f32_16x16x32_bf16 v[116:119], a[204:207], a[24:27], v[116:119]
    s_mov_b32 s53, 0
    s_add_u32 m0, s58, 73728
    v_mfma_f32_16x16x32_bf16 v[124:127], a[204:207], a[28:31], v[124:127]
    s_waitcnt lgkmcnt(4)
    buffer_load_dwordx4 v1, s[28:31], s53 offen nt lds
    v_mfma_f32_16x16x32_bf16 v[128:131], a[208:211], a[16:19], v[128:131]
    ds_read_b64_tr_b16 a[192:193], v59 offset:24832
    ds_read_b64_tr_b16 a[194:195], v59 offset:30976
    v_mfma_f32_16x16x32_bf16 v[136:139], a[208:211], a[20:23], v[136:139]
    v_mfma_f32_16x16x32_bf16 v[144:147], a[208:211], a[24:27], v[144:147]
    v_mfma_f32_16x16x32_bf16 v[152:155], a[208:211], a[28:31], v[152:155]
    s_add_u32 m0, s58, 77824
    s_nop 0
    buffer_load_dwordx4 v2, s[28:31], s53 offen nt lds
    v_mfma_f32_16x16x32_bf16 v[132:135], a[212:215], a[16:19], v[132:135]
    ds_read_b64_tr_b16 a[196:197], v60 offset:24832
    ds_read_b64_tr_b16 a[198:199], v60 offset:30976
    v_mfma_f32_16x16x32_bf16 v[140:143], a[212:215], a[20:23], v[140:143]
    v_mfma_f32_16x16x32_bf16 v[148:151], a[212:215], a[24:27], v[148:151]
    v_mfma_f32_16x16x32_bf16 v[156:159], a[212:215], a[28:31], v[156:159]
    s_waitcnt lgkmcnt(4)
    s_add_u32 m0, s58, 81920
    v_mfma_f32_16x16x32_bf16 v[160:163], a[216:219], a[16:19], v[160:163]
    ds_read_b64_tr_b16 a[200:201], v61 offset:24832
    ds_read_b64_tr_b16 a[202:203], v61 offset:30976
    v_mfma_f32_16x16x32_bf16 v[168:171], a[216:219], a[20:23], v[168:171]
    buffer_load_dwordx4 v3, s[28:31], s53 offen nt lds
    v_mfma_f32_16x16x32_bf16 v[176:179], a[216:219], a[24:27], v[176:179]
    v_mfma_f32_16x16x32_bf16 v[184:187], a[216:219], a[28:31], v[184:187]
    v_mfma_f32_16x16x32_bf16 v[164:167], a[220:223], a[16:19], v[164:167]
    ds_read_b64_tr_b16 a[204:205], v62 offset:24832
    ds_read_b64_tr_b16 a[206:207], v62 offset:30976
    v_mfma_f32_16x16x32_bf16 v[172:175], a[220:223], a[20:23], v[172:175]
    s_add_u32 m0, s42, 32768
    s_mov_b32 s53, 384
    v_mfma_f32_16x16x32_bf16 v[180:183], a[220:223], a[24:27], v[180:183]
    buffer_load_dwordx4 v51, s[20:23], s53 offen offset:0 lds
    v_mfma_f32_16x16x32_bf16 v[188:191], a[220:223], a[28:31], v[188:191]
    s_waitcnt lgkmcnt(4)
    v_mfma_f32_16x16x32_bf16 v[192:195], a[192:195], a[16:19], v[192:195]
    ds_read_b64_tr_b16 a[208:209], v55 offset:0
    ds_read_b64_tr_b16 a[210:211], v55 offset:6144
    v_mfma_f32_16x16x32_bf16 v[200:203], a[192:195], a[20:23], v[200:203]
    v_mfma_f32_16x16x32_bf16 v[208:211], a[192:195], a[24:27], v[208:211]
    s_mov_b32 s53, 9600
    buffer_load_dwordx4 v52, s[20:23], s53 offen offset:1024 lds
    v_mfma_f32_16x16x32_bf16 v[216:219], a[192:195], a[28:31], v[216:219]
    v_mfma_f32_16x16x32_bf16 v[196:199], a[196:199], a[16:19], v[196:199]
    ds_read_b64_tr_b16 a[212:213], v56 offset:0
    ds_read_b64_tr_b16 a[214:215], v56 offset:6144
    v_mfma_f32_16x16x32_bf16 v[204:207], a[196:199], a[20:23], v[204:207]
    v_mfma_f32_16x16x32_bf16 v[212:215], a[196:199], a[24:27], v[212:215]
    s_mov_b32 s53, 18816
    buffer_load_dwordx4 v51, s[20:23], s53 offen offset:2048 lds
    v_mfma_f32_16x16x32_bf16 v[220:223], a[196:199], a[28:31], v[220:223]
    s_waitcnt lgkmcnt(4)
    v_mfma_f32_16x16x32_bf16 v[224:227], a[200:203], a[16:19], v[224:227]
    ds_read_b64_tr_b16 a[216:217], v57 offset:0
    ds_read_b64_tr_b16 a[218:219], v57 offset:6144
    v_mfma_f32_16x16x32_bf16 v[232:235], a[200:203], a[20:23], v[232:235]
    v_mfma_f32_16x16x32_bf16 v[240:243], a[200:203], a[24:27], v[240:243]
    s_mov_b32 s53, 28032
    buffer_load_dwordx4 v52, s[20:23], s53 offen offset:3072 lds
    v_mfma_f32_16x16x32_bf16 v[248:251], a[200:203], a[28:31], v[248:251]
    v_mfma_f32_16x16x32_bf16 v[228:231], a[204:207], a[16:19], v[228:231]
    ds_read_b64_tr_b16 a[220:221], v58 offset:0
    ds_read_b64_tr_b16 a[222:223], v58 offset:6144
    v_mfma_f32_16x16x32_bf16 v[236:239], a[204:207], a[20:23], v[236:239]
    v_mfma_f32_16x16x32_bf16 v[244:247], a[204:207], a[24:27], v[244:247]
    s_add_u32 m0, s41, 49152
    s_mov_b32 s53, 2359296
    v_mfma_f32_16x16x32_bf16 v[252:255], a[204:207], a[28:31], v[252:255]
    s_waitcnt lgkmcnt(4)
    buffer_load_dwordx4 v48, s[24:27], s53 offen offset:0 lds
    v_mfma_f32_16x16x32_bf16 v[64:67], a[208:211], a[32:35], v[64:67]
    s_waitcnt vmcnt(11)
    ds_read_b64_tr_b16 a[192:193], v55 offset:128
    ds_read_b64_tr_b16 a[194:195], v55 offset:6272
    v_mfma_f32_16x16x32_bf16 v[72:75], a[208:211], a[36:39], v[72:75]
    v_lshl_or_b32 v38, v42, 2, v43
    v_and_b32 v39, 2, v38
    v_mfma_f32_16x16x32_bf16 v[80:83], a[208:211], a[40:43], v[80:83]
    ds_read_b128 a[64:67], v53 offset:0
    ds_read_b128 a[68:71], v53 offset:2048
    v_mfma_f32_16x16x32_bf16 v[88:91], a[208:211], a[44:47], v[88:91]
    buffer_load_dwordx4 v49, s[24:27], s53 offen offset:1024 lds
    v_mfma_f32_16x16x32_bf16 v[68:71], a[212:215], a[32:35], v[68:71]
    ds_read_b64_tr_b16 a[196:197], v56 offset:128
    ds_read_b64_tr_b16 a[198:199], v56 offset:6272
    v_mfma_f32_16x16x32_bf16 v[76:79], a[212:215], a[36:39], v[76:79]
    v_lshlrev_b32 v39, 1, v39
    v_bfe_u32 v41, v38, 2, 1
    v_mfma_f32_16x16x32_bf16 v[84:87], a[212:215], a[40:43], v[84:87]
    ds_read_b128 a[72:75], v53 offset:4096
    ds_read_b128 a[76:79], v53 offset:6144
    v_mfma_f32_16x16x32_bf16 v[92:95], a[212:215], a[44:47], v[92:95]
    s_waitcnt lgkmcnt(8)
    buffer_load_dwordx4 v50, s[24:27], s53 offen offset:2048 lds
    v_mfma_f32_16x16x32_bf16 v[96:99], a[216:219], a[32:35], v[96:99]
    ds_read_b64_tr_b16 a[200:201], v57 offset:128
    ds_read_b64_tr_b16 a[202:203], v57 offset:6272
    v_mfma_f32_16x16x32_bf16 v[104:107], a[216:219], a[36:39], v[104:107]
    v_lshl_or_b32 v39, v41, 1, v39
    v_mul_u32_u24 v40, 384, v38
    v_mfma_f32_16x16x32_bf16 v[112:115], a[216:219], a[40:43], v[112:115]
    ds_read_b128 a[80:83], v54 offset:0
    ds_read_b128 a[84:87], v54 offset:2048
    v_mfma_f32_16x16x32_bf16 v[120:123], a[216:219], a[44:47], v[120:123]
    s_mov_b32 s53, 12288
    s_add_u32 m0, s58, 86016
    v_add_u32 v40, v40, v44
    v_mfma_f32_16x16x32_bf16 v[100:103], a[220:223], a[32:35], v[100:103]
    ds_read_b64_tr_b16 a[204:205], v58 offset:128
    ds_read_b64_tr_b16 a[206:207], v58 offset:6272
    v_mfma_f32_16x16x32_bf16 v[108:111], a[220:223], a[36:39], v[108:111]
    s_barrier
    v_xor_b32 v41, 0, v39
    v_mfma_f32_16x16x32_bf16 v[116:119], a[220:223], a[40:43], v[116:119]
    ds_read_b128 a[88:91], v54 offset:4096
    ds_read_b128 a[92:95], v54 offset:6144
    v_mfma_f32_16x16x32_bf16 v[124:127], a[220:223], a[44:47], v[124:127]
    s_waitcnt lgkmcnt(10)
    buffer_load_dwordx4 v1, s[28:31], s53 offen nt lds
    v_mfma_f32_16x16x32_bf16 v[128:131], a[192:195], a[32:35], v[128:131]
    ds_read_b64_tr_b16 a[208:209], v55 offset:256
    ds_read_b64_tr_b16 a[210:211], v55 offset:6400
    v_mfma_f32_16x16x32_bf16 v[136:139], a[192:195], a[36:39], v[136:139]
    v_lshl_add_u32 v4, v41, 4, v40
    v_xor_b32 v41, 2, v39
    v_mfma_f32_16x16x32_bf16 v[144:147], a[192:195], a[40:43], v[144:147]
    v_lshl_add_u32 v5, v41, 4, v40
    v_xor_b32 v41, 4, v39
    v_mfma_f32_16x16x32_bf16 v[152:155], a[192:195], a[44:47], v[152:155]
    s_add_u32 m0, s58, 90112
    s_nop 0
    buffer_load_dwordx4 v2, s[28:31], s53 offen nt lds
    v_mfma_f32_16x16x32_bf16 v[132:135], a[196:199], a[32:35], v[132:135]
    ds_read_b64_tr_b16 a[212:213], v56 offset:256
    ds_read_b64_tr_b16 a[214:215], v56 offset:6400
    v_mfma_f32_16x16x32_bf16 v[140:143], a[196:199], a[36:39], v[140:143]
    v_lshl_add_u32 v6, v41, 4, v40
    v_xor_b32 v41, 6, v39
    v_mfma_f32_16x16x32_bf16 v[148:151], a[196:199], a[40:43], v[148:151]
    v_lshl_add_u32 v7, v41, 4, v40
    v_mfma_f32_16x16x32_bf16 v[156:159], a[196:199], a[44:47], v[156:159]
    s_waitcnt lgkmcnt(6)
    s_add_u32 m0, s58, 94208
    s_mov_b32 vcc_lo, 0xffff0000
    v_mfma_f32_16x16x32_bf16 v[160:163], a[200:203], a[32:35], v[160:163]
    s_mov_b32 vcc_hi, 0xffff0000
    ds_read_b64_tr_b16 a[216:217], v57 offset:256
    ds_read_b64_tr_b16 a[218:219], v57 offset:6400
    v_mfma_f32_16x16x32_bf16 v[168:171], a[200:203], a[36:39], v[168:171]
    buffer_load_dwordx4 v3, s[28:31], s53 offen nt lds
    v_mfma_f32_16x16x32_bf16 v[176:179], a[200:203], a[40:43], v[176:179]
    v_and_b32 v38, 15, v37
    v_mul_u32_u24 v40, 384, v38
    v_mfma_f32_16x16x32_bf16 v[184:187], a[200:203], a[44:47], v[184:187]
    v_add_u32 v40, 86016, v40
    v_and_b32 v39, 2, v38
    v_mfma_f32_16x16x32_bf16 v[164:167], a[204:207], a[32:35], v[164:167]
    ds_read_b64_tr_b16 a[220:221], v58 offset:256
    ds_read_b64_tr_b16 a[222:223], v58 offset:6400
    v_mfma_f32_16x16x32_bf16 v[172:175], a[204:207], a[36:39], v[172:175]
    s_add_u32 m0, s42, 36864
    s_mov_b32 s53, 41344
    v_lshlrev_b32 v39, 1, v39
    v_mfma_f32_16x16x32_bf16 v[180:183], a[204:207], a[40:43], v[180:183]
    buffer_load_dwordx4 v51, s[20:23], s53 offen offset:0 lds
    v_mfma_f32_16x16x32_bf16 v[188:191], a[204:207], a[44:47], v[188:191]
    s_waitcnt lgkmcnt(4)
    v_bfe_u32 v41, v38, 2, 1
    v_lshl_or_b32 v39, v41, 1, v39
    v_mfma_f32_16x16x32_bf16 v[192:195], a[208:211], a[32:35], v[192:195]
    ds_read_b64_tr_b16 a[192:193], v55 offset:12288
    ds_read_b64_tr_b16 a[194:195], v55 offset:18432
    v_mfma_f32_16x16x32_bf16 v[200:203], a[208:211], a[36:39], v[200:203]
    v_xor_b32 v39, v39, v42
    v_lshl_add_u32 v8, v39, 4, v40
    v_mfma_f32_16x16x32_bf16 v[208:211], a[208:211], a[40:43], v[208:211]
    s_mov_b32 s53, 50560
    buffer_load_dwordx4 v52, s[20:23], s53 offen offset:1024 lds
    v_mfma_f32_16x16x32_bf16 v[216:219], a[208:211], a[44:47], v[216:219]
    v_xor_b32 v39, 4, v39
    v_lshl_add_u32 v9, v39, 4, v40
    v_mfma_f32_16x16x32_bf16 v[196:199], a[212:215], a[32:35], v[196:199]
    s_mul_i32 s52, s40, 786432
    ds_read_b64_tr_b16 a[196:197], v56 offset:12288
    ds_read_b64_tr_b16 a[198:199], v56 offset:18432
    v_mfma_f32_16x16x32_bf16 v[204:207], a[212:215], a[36:39], v[204:207]
    v_lshlrev_b32 v11, 4, v37
    v_add_u32 v10, s52, v11
    v_mfma_f32_16x16x32_bf16 v[212:215], a[212:215], a[40:43], v[212:215]
    s_mov_b32 s53, 59776
    buffer_load_dwordx4 v51, s[20:23], s53 offen offset:2048 lds
    v_mfma_f32_16x16x32_bf16 v[220:223], a[212:215], a[44:47], v[220:223]
    s_waitcnt lgkmcnt(4)
    s_mov_b32 s43, 1182793728
    s_mov_b32 s44, 1037384597
    v_mfma_f32_16x16x32_bf16 v[224:227], a[216:219], a[32:35], v[224:227]
    s_and_b32 s52, s40, 1
    ds_read_b64_tr_b16 a[200:201], v57 offset:12288
    ds_read_b64_tr_b16 a[202:203], v57 offset:18432
    v_mfma_f32_16x16x32_bf16 v[232:235], a[216:219], a[36:39], v[232:235]
    s_mul_i32 s52, s52, 20480
    v_add_u32 v38, 0, v37
    v_mul_u32_u24 v39, 3277, v38
    v_mfma_f32_16x16x32_bf16 v[240:243], a[216:219], a[40:43], v[240:243]
    s_mov_b32 s53, 68992
    buffer_load_dwordx4 v52, s[20:23], s53 offen offset:3072 lds
    v_mfma_f32_16x16x32_bf16 v[248:251], a[216:219], a[44:47], v[248:251]
    v_lshrrev_b32 v39, 16, v39
    v_bfe_u32 v40, v39, 2, 1
    v_mfma_f32_16x16x32_bf16 v[228:231], a[220:223], a[32:35], v[228:231]
    ds_read_b64_tr_b16 a[204:205], v58 offset:12288
    ds_read_b64_tr_b16 a[206:207], v58 offset:18432
    v_mfma_f32_16x16x32_bf16 v[236:239], a[220:223], a[36:39], v[236:239]
    v_lshlrev_b32 v40, 1, v40
    v_xor_b32 v38, v38, v40
    v_mfma_f32_16x16x32_bf16 v[244:247], a[220:223], a[40:43], v[244:247]
    s_add_u32 m0, s41, 61440
    s_mov_b32 s53, 2752512
    v_mul_u32_u24 v39, 960, v39
    v_mfma_f32_16x16x32_bf16 v[252:255], a[220:223], a[44:47], v[252:255]
    s_waitcnt lgkmcnt(4)
    buffer_load_dwordx4 v48, s[24:27], s53 offen offset:0 lds
    v_mfma_f32_16x16x32_bf16 v[64:67], a[192:195], a[48:51], v[64:67]
    ds_read_b64_tr_b16 a[208:209], v55 offset:12416
    ds_read_b64_tr_b16 a[210:211], v55 offset:18560
    v_mfma_f32_16x16x32_bf16 v[72:75], a[192:195], a[52:55], v[72:75]
    v_lshl_add_u32 v39, v38, 4, v39
    v_subrev_u32 v39, 0, v39
    v_mfma_f32_16x16x32_bf16 v[80:83], a[192:195], a[56:59], v[80:83]
    v_add_u32 v12, s52, v39
    v_add_u32 v38, 64, v37
    v_mfma_f32_16x16x32_bf16 v[88:91], a[192:195], a[60:63], v[88:91]
    buffer_load_dwordx4 v49, s[24:27], s53 offen offset:1024 lds
    v_mfma_f32_16x16x32_bf16 v[68:71], a[196:199], a[48:51], v[68:71]
    ds_read_b64_tr_b16 a[212:213], v56 offset:12416
    ds_read_b64_tr_b16 a[214:215], v56 offset:18560
    v_mfma_f32_16x16x32_bf16 v[76:79], a[196:199], a[52:55], v[76:79]
    v_mul_u32_u24 v39, 3277, v38
    v_lshrrev_b32 v39, 16, v39
    v_mfma_f32_16x16x32_bf16 v[84:87], a[196:199], a[56:59], v[84:87]
    v_bfe_u32 v40, v39, 2, 1
    v_lshlrev_b32 v40, 1, v40
    v_mfma_f32_16x16x32_bf16 v[92:95], a[196:199], a[60:63], v[92:95]
    s_waitcnt lgkmcnt(4)
    buffer_load_dwordx4 v50, s[24:27], s53 offen offset:2048 lds
    v_mfma_f32_16x16x32_bf16 v[96:99], a[200:203], a[48:51], v[96:99]
    ds_read_b64_tr_b16 a[216:217], v57 offset:12416
    ds_read_b64_tr_b16 a[218:219], v57 offset:18560
    v_mfma_f32_16x16x32_bf16 v[104:107], a[200:203], a[52:55], v[104:107]
    v_xor_b32 v38, v38, v40
    v_mul_u32_u24 v39, 960, v39
    v_mfma_f32_16x16x32_bf16 v[112:115], a[200:203], a[56:59], v[112:115]
    v_lshl_add_u32 v39, v38, 4, v39
    v_subrev_u32 v39, 1024, v39
    v_mfma_f32_16x16x32_bf16 v[120:123], a[200:203], a[60:63], v[120:123]
    s_add_u32 m0, s42, 0
    s_mov_b32 s53, 512
    v_add_u32 v13, s52, v39
    v_mfma_f32_16x16x32_bf16 v[100:103], a[204:207], a[48:51], v[100:103]
    ds_read_b64_tr_b16 a[220:221], v58 offset:12416
    ds_read_b64_tr_b16 a[222:223], v58 offset:18560
    v_mfma_f32_16x16x32_bf16 v[108:111], a[204:207], a[52:55], v[108:111]
    s_barrier
    v_add_u32 v38, 128, v37
    v_mfma_f32_16x16x32_bf16 v[116:119], a[204:207], a[56:59], v[116:119]
    buffer_load_dwordx4 v51, s[20:23], s53 offen offset:0 lds
    v_mfma_f32_16x16x32_bf16 v[124:127], a[204:207], a[60:63], v[124:127]
    s_waitcnt lgkmcnt(4)
    v_mul_u32_u24 v39, 3277, v38
    v_lshrrev_b32 v39, 16, v39
    v_mfma_f32_16x16x32_bf16 v[128:131], a[208:211], a[48:51], v[128:131]
    ds_read_b64_tr_b16 a[192:193], v55 offset:12544
    ds_read_b64_tr_b16 a[194:195], v55 offset:18688
    v_mfma_f32_16x16x32_bf16 v[136:139], a[208:211], a[52:55], v[136:139]
    v_bfe_u32 v40, v39, 2, 1
    v_lshlrev_b32 v40, 1, v40
    v_mfma_f32_16x16x32_bf16 v[144:147], a[208:211], a[56:59], v[144:147]
    s_mov_b32 s53, 9728
    buffer_load_dwordx4 v52, s[20:23], s53 offen offset:1024 lds
    v_mfma_f32_16x16x32_bf16 v[152:155], a[208:211], a[60:63], v[152:155]
    v_xor_b32 v38, v38, v40
    v_mul_u32_u24 v39, 960, v39
    v_mfma_f32_16x16x32_bf16 v[132:135], a[212:215], a[48:51], v[132:135]
    ds_read_b64_tr_b16 a[196:197], v56 offset:12544
    ds_read_b64_tr_b16 a[198:199], v56 offset:18688
    v_mfma_f32_16x16x32_bf16 v[140:143], a[212:215], a[52:55], v[140:143]
    v_lshl_add_u32 v39, v38, 4, v39
    v_subrev_u32 v39, 2048, v39
    v_mfma_f32_16x16x32_bf16 v[148:151], a[212:215], a[56:59], v[148:151]
    s_mov_b32 s53, 18944
    buffer_load_dwordx4 v51, s[20:23], s53 offen offset:2048 lds
    v_mfma_f32_16x16x32_bf16 v[156:159], a[212:215], a[60:63], v[156:159]
    s_waitcnt lgkmcnt(4)
    v_add_u32 v14, s52, v39
    v_add_u32 v38, 192, v37
    v_mfma_f32_16x16x32_bf16 v[160:163], a[216:219], a[48:51], v[160:163]
    ds_read_b64_tr_b16 a[200:201], v57 offset:12544
    ds_read_b64_tr_b16 a[202:203], v57 offset:18688
    v_mfma_f32_16x16x32_bf16 v[168:171], a[216:219], a[52:55], v[168:171]
    v_mul_u32_u24 v39, 3277, v38
    v_lshrrev_b32 v39, 16, v39
    v_mfma_f32_16x16x32_bf16 v[176:179], a[216:219], a[56:59], v[176:179]
    s_mov_b32 s53, 28160
    buffer_load_dwordx4 v52, s[20:23], s53 offen offset:3072 lds
    v_mfma_f32_16x16x32_bf16 v[184:187], a[216:219], a[60:63], v[184:187]
    v_bfe_u32 v40, v39, 2, 1
    v_lshlrev_b32 v40, 1, v40
    v_mfma_f32_16x16x32_bf16 v[164:167], a[220:223], a[48:51], v[164:167]
    ds_read_b64_tr_b16 a[204:205], v58 offset:12544
    ds_read_b64_tr_b16 a[206:207], v58 offset:18688
    v_mfma_f32_16x16x32_bf16 v[172:175], a[220:223], a[52:55], v[172:175]
    v_xor_b32 v38, v38, v40
    v_mul_u32_u24 v39, 960, v39
    v_mfma_f32_16x16x32_bf16 v[180:183], a[220:223], a[56:59], v[180:183]
    s_add_u32 m0, s42, 4096
    s_mov_b32 s53, 41472
    v_lshl_add_u32 v39, v38, 4, v39
    v_mfma_f32_16x16x32_bf16 v[188:191], a[220:223], a[60:63], v[188:191]
    s_waitcnt lgkmcnt(4)
    buffer_load_dwordx4 v51, s[20:23], s53 offen offset:0 lds
    v_mfma_f32_16x16x32_bf16 v[192:195], a[192:195], a[48:51], v[192:195]
    ds_read_b64_tr_b16 a[208:209], v55 offset:24576
    ds_read_b64_tr_b16 a[210:211], v55 offset:30720
    v_mfma_f32_16x16x32_bf16 v[200:203], a[192:195], a[52:55], v[200:203]
    v_subrev_u32 v39, 3072, v39
    v_add_u32 v15, s52, v39
    v_mfma_f32_16x16x32_bf16 v[208:211], a[192:195], a[56:59], v[208:211]
    v_add_u32 v38, 256, v37
    v_mul_u32_u24 v39, 3277, v38
    v_mfma_f32_16x16x32_bf16 v[216:219], a[192:195], a[60:63], v[216:219]
    s_mov_b32 s53, 50688
    buffer_load_dwordx4 v52, s[20:23], s53 offen offset:1024 lds
    v_mfma_f32_16x16x32_bf16 v[196:199], a[196:199], a[48:51], v[196:199]
    ds_read_b64_tr_b16 a[212:213], v56 offset:24576
    ds_read_b64_tr_b16 a[214:215], v56 offset:30720
    v_mfma_f32_16x16x32_bf16 v[204:207], a[196:199], a[52:55], v[204:207]
    v_lshrrev_b32 v39, 16, v39
    v_bfe_u32 v40, v39, 2, 1
    v_mfma_f32_16x16x32_bf16 v[212:215], a[196:199], a[56:59], v[212:215]
    v_lshlrev_b32 v40, 1, v40
    v_xor_b32 v38, v38, v40
    v_mfma_f32_16x16x32_bf16 v[220:223], a[196:199], a[60:63], v[220:223]
    s_waitcnt lgkmcnt(4)
    s_mov_b32 s53, 59904
    v_mul_u32_u24 v39, 960, v39
    v_mfma_f32_16x16x32_bf16 v[224:227], a[200:203], a[48:51], v[224:227]
    ds_read_b64_tr_b16 a[216:217], v57 offset:24576
    ds_read_b64_tr_b16 a[218:219], v57 offset:30720
    v_mfma_f32_16x16x32_bf16 v[232:235], a[200:203], a[52:55], v[232:235]
    buffer_load_dwordx4 v51, s[20:23], s53 offen offset:2048 lds
    v_mfma_f32_16x16x32_bf16 v[240:243], a[200:203], a[56:59], v[240:243]
    v_lshl_add_u32 v39, v38, 4, v39
    v_subrev_u32 v39, 0, v39
    v_mfma_f32_16x16x32_bf16 v[248:251], a[200:203], a[60:63], v[248:251]
    v_add_u32 v16, s52, v39
    v_lshl_or_b32 v38, v42, 2, v43
    v_mfma_f32_16x16x32_bf16 v[228:231], a[204:207], a[48:51], v[228:231]
    ds_read_b64_tr_b16 a[220:221], v58 offset:24576
    ds_read_b64_tr_b16 a[222:223], v58 offset:30720
    v_mfma_f32_16x16x32_bf16 v[236:239], a[204:207], a[52:55], v[236:239]
    s_mov_b32 s53, 69120
    buffer_load_dwordx4 v52, s[20:23], s53 offen offset:3072 lds
    v_mfma_f32_16x16x32_bf16 v[244:247], a[204:207], a[56:59], v[244:247]
    v_mul_u32_u24 v38, 320, v38
    v_and_b32 v39, 1, v42
    v_mfma_f32_16x16x32_bf16 v[252:255], a[204:207], a[60:63], v[252:255]
    s_waitcnt lgkmcnt(4)
    v_lshl_add_u32 v38, v39, 5, v38
    v_add_u32 v18, v38, v44
    v_mfma_f32_16x16x32_bf16 v[64:67], a[208:211], a[64:67], v[64:67]
    s_waitcnt vmcnt(11)
    ds_read_b64_tr_b16 a[192:193], v55 offset:24704
    ds_read_b64_tr_b16 a[194:195], v55 offset:30848
    v_mfma_f32_16x16x32_bf16 v[72:75], a[208:211], a[68:71], v[72:75]
    s_add_u32 m0, s41, 0
    s_mov_b32 s53, 3145728
    v_and_b32 v38, 15, v37
    v_mfma_f32_16x16x32_bf16 v[80:83], a[208:211], a[72:75], v[80:83]
    ds_read_b128 a[96:99], v53 offset:32768
    ds_read_b128 a[100:103], v53 offset:34816
    v_mfma_f32_16x16x32_bf16 v[88:91], a[208:211], a[76:79], v[88:91]
    buffer_load_dwordx4 v48, s[24:27], s53 offen offset:0 lds
    v_mfma_f32_16x16x32_bf16 v[68:71], a[212:215], a[64:67], v[68:71]
    ds_read_b64_tr_b16 a[196:197], v56 offset:24704
    ds_read_b64_tr_b16 a[198:199], v56 offset:30848
    v_mfma_f32_16x16x32_bf16 v[76:79], a[212:215], a[68:71], v[76:79]
    v_mul_u32_u24 v38, 1280, v38
    v_lshl_add_u32 v17, v42, 4, v38
    v_mfma_f32_16x16x32_bf16 v[84:87], a[212:215], a[72:75], v[84:87]
    ds_read_b128 a[104:107], v53 offset:36864
    ds_read_b128 a[108:111], v53 offset:38912
    v_mfma_f32_16x16x32_bf16 v[92:95], a[212:215], a[76:79], v[92:95]
    s_waitcnt lgkmcnt(8)
    buffer_load_dwordx4 v49, s[24:27], s53 offen offset:1024 lds
    v_mfma_f32_16x16x32_bf16 v[96:99], a[216:219], a[64:67], v[96:99]
    ds_read_b64_tr_b16 a[200:201], v57 offset:24704
    ds_read_b64_tr_b16 a[202:203], v57 offset:30848
    v_mfma_f32_16x16x32_bf16 v[104:107], a[216:219], a[68:71], v[104:107]
    v_mov_b32 v20, 0
    v_mov_b32 v21, 0
    v_mfma_f32_16x16x32_bf16 v[112:115], a[216:219], a[72:75], v[112:115]
    ds_read_b128 a[112:115], v54 offset:32768
    ds_read_b128 a[116:119], v54 offset:34816
    v_mfma_f32_16x16x32_bf16 v[120:123], a[216:219], a[76:79], v[120:123]
    buffer_load_dwordx4 v50, s[24:27], s53 offen offset:2048 lds
    v_mfma_f32_16x16x32_bf16 v[100:103], a[220:223], a[64:67], v[100:103]
    ds_read_b64_tr_b16 a[204:205], v58 offset:24704
    ds_read_b64_tr_b16 a[206:207], v58 offset:30848
    v_mfma_f32_16x16x32_bf16 v[108:111], a[220:223], a[68:71], v[108:111]
    s_barrier
    v_mov_b32 v22, 0
    v_mfma_f32_16x16x32_bf16 v[116:119], a[220:223], a[72:75], v[116:119]
    ds_read_b128 a[120:123], v54 offset:36864
    ds_read_b128 a[124:127], v54 offset:38912
    v_mfma_f32_16x16x32_bf16 v[124:127], a[220:223], a[76:79], v[124:127]
    s_waitcnt lgkmcnt(10)
    s_add_u32 m0, s41, 12288
    s_mov_b32 s53, 3538944
    v_mfma_f32_16x16x32_bf16 v[128:131], a[192:195], a[64:67], v[128:131]
    ds_read_b64_tr_b16 a[208:209], v55 offset:24832
    ds_read_b64_tr_b16 a[210:211], v55 offset:30976
    v_mfma_f32_16x16x32_bf16 v[136:139], a[192:195], a[68:71], v[136:139]
    buffer_load_dwordx4 v48, s[24:27], s53 offen offset:0 lds
    v_mfma_f32_16x16x32_bf16 v[144:147], a[192:195], a[72:75], v[144:147]
    v_mov_b32 v23, 0
    v_subrev_u32 v8, 12288, v8
    v_mfma_f32_16x16x32_bf16 v[152:155], a[192:195], a[76:79], v[152:155]
    v_subrev_u32 v9, 12288, v9
    v_mfma_f32_16x16x32_bf16 v[132:135], a[196:199], a[64:67], v[132:135]
    s_mov_b32 s45, 49152
    ds_read_b64_tr_b16 a[212:213], v56 offset:24832
    ds_read_b64_tr_b16 a[214:215], v56 offset:30976
    v_mfma_f32_16x16x32_bf16 v[140:143], a[196:199], a[68:71], v[140:143]
    s_mov_b32 s49, 1
    buffer_load_dwordx4 v49, s[24:27], s53 offen offset:1024 lds
    v_mfma_f32_16x16x32_bf16 v[148:151], a[196:199], a[72:75], v[148:151]
    s_mov_b32 s55, 4294918144
    s_mov_b32 s54, 0
    s_add_u32 s48, s58, 49152
    v_mfma_f32_16x16x32_bf16 v[156:159], a[196:199], a[76:79], v[156:159]
    s_waitcnt lgkmcnt(6)
    s_mov_b32 s47, s58
    v_mfma_f32_16x16x32_bf16 v[160:163], a[200:203], a[64:67], v[160:163]
    ds_read_b64_tr_b16 a[216:217], v57 offset:24832
    ds_read_b64_tr_b16 a[218:219], v57 offset:30976
    v_mfma_f32_16x16x32_bf16 v[168:171], a[200:203], a[68:71], v[168:171]
    buffer_load_dwordx4 v50, s[24:27], s53 offen offset:2048 lds
    v_mfma_f32_16x16x32_bf16 v[176:179], a[200:203], a[72:75], v[176:179]
    v_mfma_f32_16x16x32_bf16 v[184:187], a[200:203], a[76:79], v[184:187]
    v_mfma_f32_16x16x32_bf16 v[164:167], a[204:207], a[64:67], v[164:167]
    ds_read_b64_tr_b16 a[220:221], v58 offset:24832
    ds_read_b64_tr_b16 a[222:223], v58 offset:30976
    v_mfma_f32_16x16x32_bf16 v[172:175], a[204:207], a[68:71], v[172:175]
    v_mfma_f32_16x16x32_bf16 v[180:183], a[204:207], a[72:75], v[180:183]
    v_mfma_f32_16x16x32_bf16 v[188:191], a[204:207], a[76:79], v[188:191]
    s_waitcnt lgkmcnt(4)
    v_mfma_f32_16x16x32_bf16 v[192:195], a[208:211], a[64:67], v[192:195]
    ds_read_b64_tr_b16 a[192:193], v59 offset:0
    ds_read_b64_tr_b16 a[194:195], v59 offset:6144
    v_mfma_f32_16x16x32_bf16 v[200:203], a[208:211], a[68:71], v[200:203]
    v_mfma_f32_16x16x32_bf16 v[208:211], a[208:211], a[72:75], v[208:211]
    s_add_u32 m0, s42, 32768
    s_mov_b32 s53, 640
    v_mfma_f32_16x16x32_bf16 v[216:219], a[208:211], a[76:79], v[216:219]
    buffer_load_dwordx4 v51, s[20:23], s53 offen offset:0 lds
    v_mfma_f32_16x16x32_bf16 v[196:199], a[212:215], a[64:67], v[196:199]
    ds_read_b64_tr_b16 a[196:197], v60 offset:0
    ds_read_b64_tr_b16 a[198:199], v60 offset:6144
    v_mfma_f32_16x16x32_bf16 v[204:207], a[212:215], a[68:71], v[204:207]
    v_mfma_f32_16x16x32_bf16 v[212:215], a[212:215], a[72:75], v[212:215]
    v_mfma_f32_16x16x32_bf16 v[220:223], a[212:215], a[76:79], v[220:223]
    s_waitcnt lgkmcnt(4)
    s_mov_b32 s53, 9856
    v_mfma_f32_16x16x32_bf16 v[224:227], a[216:219], a[64:67], v[224:227]
    ds_read_b64_tr_b16 a[200:201], v61 offset:0
    ds_read_b64_tr_b16 a[202:203], v61 offset:6144
    v_mfma_f32_16x16x32_bf16 v[232:235], a[216:219], a[68:71], v[232:235]
    buffer_load_dwordx4 v52, s[20:23], s53 offen offset:1024 lds
    v_mfma_f32_16x16x32_bf16 v[240:243], a[216:219], a[72:75], v[240:243]
    v_mfma_f32_16x16x32_bf16 v[248:251], a[216:219], a[76:79], v[248:251]
    v_mfma_f32_16x16x32_bf16 v[228:231], a[220:223], a[64:67], v[228:231]
    ds_read_b64_tr_b16 a[204:205], v62 offset:0
    ds_read_b64_tr_b16 a[206:207], v62 offset:6144
    v_mfma_f32_16x16x32_bf16 v[236:239], a[220:223], a[68:71], v[236:239]
    s_mov_b32 s53, 19072
    buffer_load_dwordx4 v51, s[20:23], s53 offen offset:2048 lds
    v_mfma_f32_16x16x32_bf16 v[244:247], a[220:223], a[72:75], v[244:247]
    v_mfma_f32_16x16x32_bf16 v[252:255], a[220:223], a[76:79], v[252:255]
    s_waitcnt lgkmcnt(4)
    v_mfma_f32_16x16x32_bf16 v[64:67], a[192:195], a[80:83], v[64:67]
    ds_read_b64_tr_b16 a[208:209], v59 offset:128
    ds_read_b64_tr_b16 a[210:211], v59 offset:6272
    v_mfma_f32_16x16x32_bf16 v[72:75], a[192:195], a[84:87], v[72:75]
    s_mov_b32 s53, 28288
    buffer_load_dwordx4 v52, s[20:23], s53 offen offset:3072 lds
    v_mfma_f32_16x16x32_bf16 v[80:83], a[192:195], a[88:91], v[80:83]
    v_mfma_f32_16x16x32_bf16 v[88:91], a[192:195], a[92:95], v[88:91]
    v_mfma_f32_16x16x32_bf16 v[68:71], a[196:199], a[80:83], v[68:71]
    ds_read_b64_tr_b16 a[212:213], v60 offset:128
    ds_read_b64_tr_b16 a[214:215], v60 offset:6272
    v_mfma_f32_16x16x32_bf16 v[76:79], a[196:199], a[84:87], v[76:79]
    v_mfma_f32_16x16x32_bf16 v[84:87], a[196:199], a[88:91], v[84:87]
    v_mfma_f32_16x16x32_bf16 v[92:95], a[196:199], a[92:95], v[92:95]
    s_waitcnt lgkmcnt(4)
    v_mfma_f32_16x16x32_bf16 v[96:99], a[200:203], a[80:83], v[96:99]
    ds_read_b64_tr_b16 a[216:217], v61 offset:128
    ds_read_b64_tr_b16 a[218:219], v61 offset:6272
    v_mfma_f32_16x16x32_bf16 v[104:107], a[200:203], a[84:87], v[104:107]
    v_mfma_f32_16x16x32_bf16 v[112:115], a[200:203], a[88:91], v[112:115]
    s_add_u32 m0, s42, 36864
    s_mov_b32 s53, 41600
    v_mfma_f32_16x16x32_bf16 v[120:123], a[200:203], a[92:95], v[120:123]
    buffer_load_dwordx4 v51, s[20:23], s53 offen offset:0 lds
    v_mfma_f32_16x16x32_bf16 v[100:103], a[204:207], a[80:83], v[100:103]
    ds_read_b64_tr_b16 a[220:221], v62 offset:128
    ds_read_b64_tr_b16 a[222:223], v62 offset:6272
    v_mfma_f32_16x16x32_bf16 v[108:111], a[204:207], a[84:87], v[108:111]
    s_barrier
    v_mfma_f32_16x16x32_bf16 v[116:119], a[204:207], a[88:91], v[116:119]
    v_mfma_f32_16x16x32_bf16 v[124:127], a[204:207], a[92:95], v[124:127]
    s_waitcnt lgkmcnt(4)
    s_mov_b32 s53, 50816
    v_mfma_f32_16x16x32_bf16 v[128:131], a[208:211], a[80:83], v[128:131]
    ds_read_b64_tr_b16 a[192:193], v59 offset:256
    ds_read_b64_tr_b16 a[194:195], v59 offset:6400
    v_mfma_f32_16x16x32_bf16 v[136:139], a[208:211], a[84:87], v[136:139]
    buffer_load_dwordx4 v52, s[20:23], s53 offen offset:1024 lds
    v_mfma_f32_16x16x32_bf16 v[144:147], a[208:211], a[88:91], v[144:147]
    v_mfma_f32_16x16x32_bf16 v[152:155], a[208:211], a[92:95], v[152:155]
    v_mfma_f32_16x16x32_bf16 v[132:135], a[212:215], a[80:83], v[132:135]
    ds_read_b64_tr_b16 a[196:197], v60 offset:256
    ds_read_b64_tr_b16 a[198:199], v60 offset:6400
    v_mfma_f32_16x16x32_bf16 v[140:143], a[212:215], a[84:87], v[140:143]
    s_mov_b32 s53, 60032
    buffer_load_dwordx4 v51, s[20:23], s53 offen offset:2048 lds
    v_mfma_f32_16x16x32_bf16 v[148:151], a[212:215], a[88:91], v[148:151]
    v_mfma_f32_16x16x32_bf16 v[156:159], a[212:215], a[92:95], v[156:159]
    s_waitcnt lgkmcnt(4)
    v_mfma_f32_16x16x32_bf16 v[160:163], a[216:219], a[80:83], v[160:163]
    ds_read_b64_tr_b16 a[200:201], v61 offset:256
    ds_read_b64_tr_b16 a[202:203], v61 offset:6400
    v_mfma_f32_16x16x32_bf16 v[168:171], a[216:219], a[84:87], v[168:171]
    s_mov_b32 s53, 69248
    buffer_load_dwordx4 v52, s[20:23], s53 offen offset:3072 lds
    v_mfma_f32_16x16x32_bf16 v[176:179], a[216:219], a[88:91], v[176:179]
    v_mfma_f32_16x16x32_bf16 v[184:187], a[216:219], a[92:95], v[184:187]
    v_mfma_f32_16x16x32_bf16 v[164:167], a[220:223], a[80:83], v[164:167]
    ds_read_b64_tr_b16 a[204:205], v62 offset:256
    ds_read_b64_tr_b16 a[206:207], v62 offset:6400
    v_mfma_f32_16x16x32_bf16 v[172:175], a[220:223], a[84:87], v[172:175]
    s_add_u32 m0, s41, 24576
    s_mov_b32 s53, 3932160
    v_mfma_f32_16x16x32_bf16 v[180:183], a[220:223], a[88:91], v[180:183]
    buffer_load_dwordx4 v48, s[24:27], s53 offen offset:0 lds
    v_mfma_f32_16x16x32_bf16 v[188:191], a[220:223], a[92:95], v[188:191]
    s_waitcnt lgkmcnt(4)
    v_mfma_f32_16x16x32_bf16 v[192:195], a[192:195], a[80:83], v[192:195]
    ds_read_b64_tr_b16 a[208:209], v59 offset:12288
    ds_read_b64_tr_b16 a[210:211], v59 offset:18432
    v_mfma_f32_16x16x32_bf16 v[200:203], a[192:195], a[84:87], v[200:203]
    v_mfma_f32_16x16x32_bf16 v[208:211], a[192:195], a[88:91], v[208:211]
    buffer_load_dwordx4 v49, s[24:27], s53 offen offset:1024 lds
    v_mfma_f32_16x16x32_bf16 v[216:219], a[192:195], a[92:95], v[216:219]
    v_mfma_f32_16x16x32_bf16 v[196:199], a[196:199], a[80:83], v[196:199]
    ds_read_b64_tr_b16 a[212:213], v60 offset:12288
    ds_read_b64_tr_b16 a[214:215], v60 offset:18432
    v_mfma_f32_16x16x32_bf16 v[204:207], a[196:199], a[84:87], v[204:207]
    v_mfma_f32_16x16x32_bf16 v[212:215], a[196:199], a[88:91], v[212:215]
    buffer_load_dwordx4 v50, s[24:27], s53 offen offset:2048 lds
    v_mfma_f32_16x16x32_bf16 v[220:223], a[196:199], a[92:95], v[220:223]
    s_waitcnt lgkmcnt(4)
    v_mfma_f32_16x16x32_bf16 v[224:227], a[200:203], a[80:83], v[224:227]
    ds_read_b64_tr_b16 a[216:217], v61 offset:12288
    ds_read_b64_tr_b16 a[218:219], v61 offset:18432
    v_mfma_f32_16x16x32_bf16 v[232:235], a[200:203], a[84:87], v[232:235]
    v_mfma_f32_16x16x32_bf16 v[240:243], a[200:203], a[88:91], v[240:243]
    v_mfma_f32_16x16x32_bf16 v[248:251], a[200:203], a[92:95], v[248:251]
    v_mfma_f32_16x16x32_bf16 v[228:231], a[204:207], a[80:83], v[228:231]
    ds_read_b64_tr_b16 a[220:221], v62 offset:12288
    ds_read_b64_tr_b16 a[222:223], v62 offset:18432
    v_mfma_f32_16x16x32_bf16 v[236:239], a[204:207], a[84:87], v[236:239]
    v_mfma_f32_16x16x32_bf16 v[244:247], a[204:207], a[88:91], v[244:247]
    v_mfma_f32_16x16x32_bf16 v[252:255], a[204:207], a[92:95], v[252:255]
    s_waitcnt lgkmcnt(4)
    v_mfma_f32_16x16x32_bf16 v[64:67], a[208:211], a[96:99], v[64:67]
    s_waitcnt vmcnt(17)
    ds_read_b64_tr_b16 a[192:193], v59 offset:12416
    ds_read_b64_tr_b16 a[194:195], v59 offset:18560
    v_mfma_f32_16x16x32_bf16 v[72:75], a[208:211], a[100:103], v[72:75]
    v_mfma_f32_16x16x32_bf16 v[80:83], a[208:211], a[104:107], v[80:83]
    ds_read_b128 a[0:3], v53 offset:0
    ds_read_b128 a[4:7], v53 offset:2048
    v_mfma_f32_16x16x32_bf16 v[88:91], a[208:211], a[108:111], v[88:91]
    v_mfma_f32_16x16x32_bf16 v[68:71], a[212:215], a[96:99], v[68:71]
    ds_read_b64_tr_b16 a[196:197], v60 offset:12416
    ds_read_b64_tr_b16 a[198:199], v60 offset:18560
    v_mfma_f32_16x16x32_bf16 v[76:79], a[212:215], a[100:103], v[76:79]
    v_mfma_f32_16x16x32_bf16 v[84:87], a[212:215], a[104:107], v[84:87]
    ds_read_b128 a[8:11], v53 offset:4096
    ds_read_b128 a[12:15], v53 offset:6144
    v_mfma_f32_16x16x32_bf16 v[92:95], a[212:215], a[108:111], v[92:95]
    s_waitcnt lgkmcnt(8)
    v_mfma_f32_16x16x32_bf16 v[96:99], a[216:219], a[96:99], v[96:99]
    ds_read_b64_tr_b16 a[200:201], v61 offset:12416
    ds_read_b64_tr_b16 a[202:203], v61 offset:18560
    v_mfma_f32_16x16x32_bf16 v[104:107], a[216:219], a[100:103], v[104:107]
    v_mfma_f32_16x16x32_bf16 v[112:115], a[216:219], a[104:107], v[112:115]
    ds_read_b128 a[16:19], v54 offset:0
    ds_read_b128 a[20:23], v54 offset:2048
    v_mfma_f32_16x16x32_bf16 v[120:123], a[216:219], a[108:111], v[120:123]
    v_mfma_f32_16x16x32_bf16 v[100:103], a[220:223], a[96:99], v[100:103]
    ds_read_b64_tr_b16 a[204:205], v62 offset:12416
    ds_read_b64_tr_b16 a[206:207], v62 offset:18560
    v_mfma_f32_16x16x32_bf16 v[108:111], a[220:223], a[100:103], v[108:111]
    s_barrier
    v_mfma_f32_16x16x32_bf16 v[116:119], a[220:223], a[104:107], v[116:119]
    s_add_u32 m0, s41, 36864
    ds_read_b128 a[24:27], v54 offset:4096
    ds_read_b128 a[28:31], v54 offset:6144
    v_mfma_f32_16x16x32_bf16 v[124:127], a[220:223], a[108:111], v[124:127]
    s_waitcnt lgkmcnt(10)
    s_mov_b32 s53, 4325376
    v_mfma_f32_16x16x32_bf16 v[128:131], a[192:195], a[96:99], v[128:131]
    ds_read_b64_tr_b16 a[208:209], v59 offset:12544
    ds_read_b64_tr_b16 a[210:211], v59 offset:18688
    v_mfma_f32_16x16x32_bf16 v[136:139], a[192:195], a[100:103], v[136:139]
    buffer_load_dwordx4 v48, s[24:27], s53 offen offset:0 lds
    v_mfma_f32_16x16x32_bf16 v[144:147], a[192:195], a[104:107], v[144:147]
    v_mfma_f32_16x16x32_bf16 v[152:155], a[192:195], a[108:111], v[152:155]
    v_mfma_f32_16x16x32_bf16 v[132:135], a[196:199], a[96:99], v[132:135]
    ds_read_b64_tr_b16 a[212:213], v60 offset:12544
    ds_read_b64_tr_b16 a[214:215], v60 offset:18688
    v_mfma_f32_16x16x32_bf16 v[140:143], a[196:199], a[100:103], v[140:143]
    buffer_load_dwordx4 v49, s[24:27], s53 offen offset:1024 lds
    v_mfma_f32_16x16x32_bf16 v[148:151], a[196:199], a[104:107], v[148:151]
    v_mfma_f32_16x16x32_bf16 v[156:159], a[196:199], a[108:111], v[156:159]
    s_waitcnt lgkmcnt(6)
    v_mfma_f32_16x16x32_bf16 v[160:163], a[200:203], a[96:99], v[160:163]
    ds_read_b64_tr_b16 a[216:217], v61 offset:12544
    ds_read_b64_tr_b16 a[218:219], v61 offset:18688
    v_mfma_f32_16x16x32_bf16 v[168:171], a[200:203], a[100:103], v[168:171]
    buffer_load_dwordx4 v50, s[24:27], s53 offen offset:2048 lds
    v_mfma_f32_16x16x32_bf16 v[176:179], a[200:203], a[104:107], v[176:179]
    v_mfma_f32_16x16x32_bf16 v[184:187], a[200:203], a[108:111], v[184:187]
    v_mfma_f32_16x16x32_bf16 v[164:167], a[204:207], a[96:99], v[164:167]
    ds_read_b64_tr_b16 a[220:221], v62 offset:12544
    ds_read_b64_tr_b16 a[222:223], v62 offset:18688
    v_mfma_f32_16x16x32_bf16 v[172:175], a[204:207], a[100:103], v[172:175]
    v_mfma_f32_16x16x32_bf16 v[180:183], a[204:207], a[104:107], v[180:183]
    v_mfma_f32_16x16x32_bf16 v[188:191], a[204:207], a[108:111], v[188:191]
    s_waitcnt lgkmcnt(4)
    v_mfma_f32_16x16x32_bf16 v[192:195], a[208:211], a[96:99], v[192:195]
    ds_read_b64_tr_b16 a[192:193], v59 offset:24576
    ds_read_b64_tr_b16 a[194:195], v59 offset:30720
    v_mfma_f32_16x16x32_bf16 v[200:203], a[208:211], a[100:103], v[200:203]
    v_mfma_f32_16x16x32_bf16 v[208:211], a[208:211], a[104:107], v[208:211]
    s_add_u32 m0, s42, 0
    s_mov_b32 s53, 768
    v_mfma_f32_16x16x32_bf16 v[216:219], a[208:211], a[108:111], v[216:219]
    buffer_load_dwordx4 v51, s[20:23], s53 offen offset:0 lds
    v_mfma_f32_16x16x32_bf16 v[196:199], a[212:215], a[96:99], v[196:199]
    ds_read_b64_tr_b16 a[196:197], v60 offset:24576
    ds_read_b64_tr_b16 a[198:199], v60 offset:30720
    v_mfma_f32_16x16x32_bf16 v[204:207], a[212:215], a[100:103], v[204:207]
    v_mfma_f32_16x16x32_bf16 v[212:215], a[212:215], a[104:107], v[212:215]
    v_mfma_f32_16x16x32_bf16 v[220:223], a[212:215], a[108:111], v[220:223]
    s_waitcnt lgkmcnt(4)
    s_mov_b32 s53, 9984
    v_mfma_f32_16x16x32_bf16 v[224:227], a[216:219], a[96:99], v[224:227]
    ds_read_b64_tr_b16 a[200:201], v61 offset:24576
    ds_read_b64_tr_b16 a[202:203], v61 offset:30720
    v_mfma_f32_16x16x32_bf16 v[232:235], a[216:219], a[100:103], v[232:235]
    buffer_load_dwordx4 v52, s[20:23], s53 offen offset:1024 lds
    v_mfma_f32_16x16x32_bf16 v[240:243], a[216:219], a[104:107], v[240:243]
    v_mfma_f32_16x16x32_bf16 v[248:251], a[216:219], a[108:111], v[248:251]
    v_mfma_f32_16x16x32_bf16 v[228:231], a[220:223], a[96:99], v[228:231]
    ds_read_b64_tr_b16 a[204:205], v62 offset:24576
    ds_read_b64_tr_b16 a[206:207], v62 offset:30720
    v_mfma_f32_16x16x32_bf16 v[236:239], a[220:223], a[100:103], v[236:239]
    s_mov_b32 s53, 19200
    buffer_load_dwordx4 v51, s[20:23], s53 offen offset:2048 lds
    v_mfma_f32_16x16x32_bf16 v[244:247], a[220:223], a[104:107], v[244:247]
    v_mfma_f32_16x16x32_bf16 v[252:255], a[220:223], a[108:111], v[252:255]
    s_waitcnt lgkmcnt(4)
    v_mfma_f32_16x16x32_bf16 v[64:67], a[192:195], a[112:115], v[64:67]
    ds_read_b64_tr_b16 a[208:209], v59 offset:24704
    ds_read_b64_tr_b16 a[210:211], v59 offset:30848
    v_mfma_f32_16x16x32_bf16 v[72:75], a[192:195], a[116:119], v[72:75]
    s_mov_b32 s53, 28416
    buffer_load_dwordx4 v52, s[20:23], s53 offen offset:3072 lds
    v_mfma_f32_16x16x32_bf16 v[80:83], a[192:195], a[120:123], v[80:83]
    v_mfma_f32_16x16x32_bf16 v[88:91], a[192:195], a[124:127], v[88:91]
    v_mfma_f32_16x16x32_bf16 v[68:71], a[196:199], a[112:115], v[68:71]
    ds_read_b64_tr_b16 a[212:213], v60 offset:24704
    ds_read_b64_tr_b16 a[214:215], v60 offset:30848
    v_mfma_f32_16x16x32_bf16 v[76:79], a[196:199], a[116:119], v[76:79]
    v_mfma_f32_16x16x32_bf16 v[84:87], a[196:199], a[120:123], v[84:87]
    v_mfma_f32_16x16x32_bf16 v[92:95], a[196:199], a[124:127], v[92:95]
    s_waitcnt lgkmcnt(4)
    v_mfma_f32_16x16x32_bf16 v[96:99], a[200:203], a[112:115], v[96:99]
    ds_read_b64_tr_b16 a[216:217], v61 offset:24704
    ds_read_b64_tr_b16 a[218:219], v61 offset:30848
    v_mfma_f32_16x16x32_bf16 v[104:107], a[200:203], a[116:119], v[104:107]
    v_mfma_f32_16x16x32_bf16 v[112:115], a[200:203], a[120:123], v[112:115]
    s_add_u32 m0, s42, 4096
    s_mov_b32 s53, 41728
    v_mfma_f32_16x16x32_bf16 v[120:123], a[200:203], a[124:127], v[120:123]
    buffer_load_dwordx4 v51, s[20:23], s53 offen offset:0 lds
    v_mfma_f32_16x16x32_bf16 v[100:103], a[204:207], a[112:115], v[100:103]
    ds_read_b64_tr_b16 a[220:221], v62 offset:24704
    ds_read_b64_tr_b16 a[222:223], v62 offset:30848
    v_mfma_f32_16x16x32_bf16 v[108:111], a[204:207], a[116:119], v[108:111]
    s_waitcnt vmcnt(22)
    s_barrier
    v_mfma_f32_16x16x32_bf16 v[116:119], a[204:207], a[120:123], v[116:119]
    v_mfma_f32_16x16x32_bf16 v[124:127], a[204:207], a[124:127], v[124:127]
    s_waitcnt lgkmcnt(4)
    s_mov_b32 s53, 50944
    v_mfma_f32_16x16x32_bf16 v[128:131], a[208:211], a[112:115], v[128:131]
    ds_read_b64_tr_b16 a[192:193], v59 offset:24832
    ds_read_b64_tr_b16 a[194:195], v59 offset:30976
    v_mfma_f32_16x16x32_bf16 v[136:139], a[208:211], a[116:119], v[136:139]
    buffer_load_dwordx4 v52, s[20:23], s53 offen offset:1024 lds
    v_mfma_f32_16x16x32_bf16 v[144:147], a[208:211], a[120:123], v[144:147]
    v_mfma_f32_16x16x32_bf16 v[152:155], a[208:211], a[124:127], v[152:155]
    v_mfma_f32_16x16x32_bf16 v[132:135], a[212:215], a[112:115], v[132:135]
    ds_read_b64_tr_b16 a[196:197], v60 offset:24832
    ds_read_b64_tr_b16 a[198:199], v60 offset:30976
    v_mfma_f32_16x16x32_bf16 v[140:143], a[212:215], a[116:119], v[140:143]
    s_mov_b32 s53, 60160
    buffer_load_dwordx4 v51, s[20:23], s53 offen offset:2048 lds
    v_mfma_f32_16x16x32_bf16 v[148:151], a[212:215], a[120:123], v[148:151]
    v_mfma_f32_16x16x32_bf16 v[156:159], a[212:215], a[124:127], v[156:159]
    s_waitcnt lgkmcnt(4)
    v_mfma_f32_16x16x32_bf16 v[160:163], a[216:219], a[112:115], v[160:163]
    ds_read_b64_tr_b16 a[200:201], v61 offset:24832
    ds_read_b64_tr_b16 a[202:203], v61 offset:30976
    v_mfma_f32_16x16x32_bf16 v[168:171], a[216:219], a[116:119], v[168:171]
    s_mov_b32 s53, 69376
    buffer_load_dwordx4 v52, s[20:23], s53 offen offset:3072 lds
    v_mfma_f32_16x16x32_bf16 v[176:179], a[216:219], a[120:123], v[176:179]
    v_mfma_f32_16x16x32_bf16 v[184:187], a[216:219], a[124:127], v[184:187]
    v_mfma_f32_16x16x32_bf16 v[164:167], a[220:223], a[112:115], v[164:167]
    ds_read_b64_tr_b16 a[204:205], v62 offset:24832
    ds_read_b64_tr_b16 a[206:207], v62 offset:30976
    v_mfma_f32_16x16x32_bf16 v[172:175], a[220:223], a[116:119], v[172:175]
    s_add_u32 m0, s41, 49152
    s_mov_b32 s53, 4718592
    v_mfma_f32_16x16x32_bf16 v[180:183], a[220:223], a[120:123], v[180:183]
    buffer_load_dwordx4 v48, s[24:27], s53 offen offset:0 lds
    v_mfma_f32_16x16x32_bf16 v[188:191], a[220:223], a[124:127], v[188:191]
    s_waitcnt lgkmcnt(4)
    v_mfma_f32_16x16x32_bf16 v[192:195], a[192:195], a[112:115], v[192:195]
    ds_read_b64_tr_b16 a[208:209], v55 offset:0
    ds_read_b64_tr_b16 a[210:211], v55 offset:6144
    v_mfma_f32_16x16x32_bf16 v[200:203], a[192:195], a[116:119], v[200:203]
    v_mfma_f32_16x16x32_bf16 v[208:211], a[192:195], a[120:123], v[208:211]
    buffer_load_dwordx4 v49, s[24:27], s53 offen offset:1024 lds
    v_mfma_f32_16x16x32_bf16 v[216:219], a[192:195], a[124:127], v[216:219]
    v_mfma_f32_16x16x32_bf16 v[196:199], a[196:199], a[112:115], v[196:199]
    ds_read_b64_tr_b16 a[212:213], v56 offset:0
    ds_read_b64_tr_b16 a[214:215], v56 offset:6144
    v_mfma_f32_16x16x32_bf16 v[204:207], a[196:199], a[116:119], v[204:207]
    v_mfma_f32_16x16x32_bf16 v[212:215], a[196:199], a[120:123], v[212:215]
    buffer_load_dwordx4 v50, s[24:27], s53 offen offset:2048 lds
    v_mfma_f32_16x16x32_bf16 v[220:223], a[196:199], a[124:127], v[220:223]
    s_waitcnt lgkmcnt(4)
    v_mfma_f32_16x16x32_bf16 v[224:227], a[200:203], a[112:115], v[224:227]
    ds_read_b64_tr_b16 a[216:217], v57 offset:0
    ds_read_b64_tr_b16 a[218:219], v57 offset:6144
    v_mfma_f32_16x16x32_bf16 v[232:235], a[200:203], a[116:119], v[232:235]
    v_mfma_f32_16x16x32_bf16 v[240:243], a[200:203], a[120:123], v[240:243]
    v_mfma_f32_16x16x32_bf16 v[248:251], a[200:203], a[124:127], v[248:251]
    v_mfma_f32_16x16x32_bf16 v[228:231], a[204:207], a[112:115], v[228:231]
    ds_read_b64_tr_b16 a[220:221], v58 offset:0
    ds_read_b64_tr_b16 a[222:223], v58 offset:6144
    v_mfma_f32_16x16x32_bf16 v[236:239], a[204:207], a[116:119], v[236:239]
    v_mfma_f32_16x16x32_bf16 v[244:247], a[204:207], a[120:123], v[244:247]
    v_mfma_f32_16x16x32_bf16 v[252:255], a[204:207], a[124:127], v[252:255]
    s_waitcnt lgkmcnt(4)
    v_mfma_f32_16x16x32_bf16 v[64:67], a[208:211], a[0:3], v[64:67]
    s_waitcnt vmcnt(17)
    ds_read_b64_tr_b16 a[192:193], v55 offset:128
    ds_read_b64_tr_b16 a[194:195], v55 offset:6272
    v_mfma_f32_16x16x32_bf16 v[72:75], a[208:211], a[4:7], v[72:75]
    v_mfma_f32_16x16x32_bf16 v[80:83], a[208:211], a[8:11], v[80:83]
    ds_read_b128 a[32:35], v53 offset:32768
    ds_read_b128 a[36:39], v53 offset:34816
    v_mfma_f32_16x16x32_bf16 v[88:91], a[208:211], a[12:15], v[88:91]
    v_mfma_f32_16x16x32_bf16 v[68:71], a[212:215], a[0:3], v[68:71]
    ds_read_b64_tr_b16 a[196:197], v56 offset:128
    ds_read_b64_tr_b16 a[198:199], v56 offset:6272
    v_mfma_f32_16x16x32_bf16 v[76:79], a[212:215], a[4:7], v[76:79]
    v_mfma_f32_16x16x32_bf16 v[84:87], a[212:215], a[8:11], v[84:87]
    ds_read_b128 a[40:43], v53 offset:36864
    ds_read_b128 a[44:47], v53 offset:38912
    v_mfma_f32_16x16x32_bf16 v[92:95], a[212:215], a[12:15], v[92:95]
    s_waitcnt lgkmcnt(8)
    v_mfma_f32_16x16x32_bf16 v[96:99], a[216:219], a[0:3], v[96:99]
    ds_read_b64_tr_b16 a[200:201], v57 offset:128
    ds_read_b64_tr_b16 a[202:203], v57 offset:6272
    v_mfma_f32_16x16x32_bf16 v[104:107], a[216:219], a[4:7], v[104:107]
    v_mfma_f32_16x16x32_bf16 v[112:115], a[216:219], a[8:11], v[112:115]
    ds_read_b128 a[48:51], v54 offset:32768
    ds_read_b128 a[52:55], v54 offset:34816
    v_mfma_f32_16x16x32_bf16 v[120:123], a[216:219], a[12:15], v[120:123]
    v_mfma_f32_16x16x32_bf16 v[100:103], a[220:223], a[0:3], v[100:103]
    ds_read_b64_tr_b16 a[204:205], v58 offset:128
    ds_read_b64_tr_b16 a[206:207], v58 offset:6272
    v_mfma_f32_16x16x32_bf16 v[108:111], a[220:223], a[4:7], v[108:111]
    s_barrier
    v_mfma_f32_16x16x32_bf16 v[116:119], a[220:223], a[8:11], v[116:119]
    s_add_u32 m0, s41, 61440
    ds_read_b128 a[56:59], v54 offset:36864
    ds_read_b128 a[60:63], v54 offset:38912
    v_mfma_f32_16x16x32_bf16 v[124:127], a[220:223], a[12:15], v[124:127]
    s_waitcnt lgkmcnt(10)
    s_mov_b32 s53, 5111808
    v_mfma_f32_16x16x32_bf16 v[128:131], a[192:195], a[0:3], v[128:131]
    ds_read_b64_tr_b16 a[208:209], v55 offset:256
    ds_read_b64_tr_b16 a[210:211], v55 offset:6400
    v_mfma_f32_16x16x32_bf16 v[136:139], a[192:195], a[4:7], v[136:139]
    buffer_load_dwordx4 v48, s[24:27], s53 offen offset:0 lds
    v_mfma_f32_16x16x32_bf16 v[144:147], a[192:195], a[8:11], v[144:147]
    v_mfma_f32_16x16x32_bf16 v[152:155], a[192:195], a[12:15], v[152:155]
    v_mfma_f32_16x16x32_bf16 v[132:135], a[196:199], a[0:3], v[132:135]
    ds_read_b64_tr_b16 a[212:213], v56 offset:256
    ds_read_b64_tr_b16 a[214:215], v56 offset:6400
    v_mfma_f32_16x16x32_bf16 v[140:143], a[196:199], a[4:7], v[140:143]
    buffer_load_dwordx4 v49, s[24:27], s53 offen offset:1024 lds
    v_mfma_f32_16x16x32_bf16 v[148:151], a[196:199], a[8:11], v[148:151]
    v_mfma_f32_16x16x32_bf16 v[156:159], a[196:199], a[12:15], v[156:159]
    s_waitcnt lgkmcnt(6)
    v_mfma_f32_16x16x32_bf16 v[160:163], a[200:203], a[0:3], v[160:163]
    ds_read_b64_tr_b16 a[216:217], v57 offset:256
    ds_read_b64_tr_b16 a[218:219], v57 offset:6400
    v_mfma_f32_16x16x32_bf16 v[168:171], a[200:203], a[4:7], v[168:171]
    buffer_load_dwordx4 v50, s[24:27], s53 offen offset:2048 lds
    v_mfma_f32_16x16x32_bf16 v[176:179], a[200:203], a[8:11], v[176:179]
    v_mfma_f32_16x16x32_bf16 v[184:187], a[200:203], a[12:15], v[184:187]
    v_mfma_f32_16x16x32_bf16 v[164:167], a[204:207], a[0:3], v[164:167]
    ds_read_b64_tr_b16 a[220:221], v58 offset:256
    ds_read_b64_tr_b16 a[222:223], v58 offset:6400
    v_mfma_f32_16x16x32_bf16 v[172:175], a[204:207], a[4:7], v[172:175]
    v_mfma_f32_16x16x32_bf16 v[180:183], a[204:207], a[8:11], v[180:183]
    v_mfma_f32_16x16x32_bf16 v[188:191], a[204:207], a[12:15], v[188:191]
    s_waitcnt lgkmcnt(4)
    v_mfma_f32_16x16x32_bf16 v[192:195], a[208:211], a[0:3], v[192:195]
    ds_read_b64_tr_b16 a[192:193], v55 offset:12288
    ds_read_b64_tr_b16 a[194:195], v55 offset:18432
    v_mfma_f32_16x16x32_bf16 v[200:203], a[208:211], a[4:7], v[200:203]
    v_mfma_f32_16x16x32_bf16 v[208:211], a[208:211], a[8:11], v[208:211]
    s_add_u32 m0, s42, 32768
    s_mov_b32 s53, 896
    v_mfma_f32_16x16x32_bf16 v[216:219], a[208:211], a[12:15], v[216:219]
    buffer_load_dwordx4 v51, s[20:23], s53 offen offset:0 lds
    v_mfma_f32_16x16x32_bf16 v[196:199], a[212:215], a[0:3], v[196:199]
    ds_read_b64_tr_b16 a[196:197], v56 offset:12288
    ds_read_b64_tr_b16 a[198:199], v56 offset:18432
    v_mfma_f32_16x16x32_bf16 v[204:207], a[212:215], a[4:7], v[204:207]
    v_mfma_f32_16x16x32_bf16 v[212:215], a[212:215], a[8:11], v[212:215]
    v_mfma_f32_16x16x32_bf16 v[220:223], a[212:215], a[12:15], v[220:223]
    s_waitcnt lgkmcnt(4)
    s_mov_b32 s53, 10112
    v_mfma_f32_16x16x32_bf16 v[224:227], a[216:219], a[0:3], v[224:227]
    ds_read_b64_tr_b16 a[200:201], v57 offset:12288
    ds_read_b64_tr_b16 a[202:203], v57 offset:18432
    v_mfma_f32_16x16x32_bf16 v[232:235], a[216:219], a[4:7], v[232:235]
    buffer_load_dwordx4 v52, s[20:23], s53 offen offset:1024 lds
    v_mfma_f32_16x16x32_bf16 v[240:243], a[216:219], a[8:11], v[240:243]
    v_mfma_f32_16x16x32_bf16 v[248:251], a[216:219], a[12:15], v[248:251]
    v_mfma_f32_16x16x32_bf16 v[228:231], a[220:223], a[0:3], v[228:231]
    ds_read_b64_tr_b16 a[204:205], v58 offset:12288
    ds_read_b64_tr_b16 a[206:207], v58 offset:18432
    v_mfma_f32_16x16x32_bf16 v[236:239], a[220:223], a[4:7], v[236:239]
    s_mov_b32 s53, 19328
    buffer_load_dwordx4 v51, s[20:23], s53 offen offset:2048 lds
    v_mfma_f32_16x16x32_bf16 v[244:247], a[220:223], a[8:11], v[244:247]
    v_mfma_f32_16x16x32_bf16 v[252:255], a[220:223], a[12:15], v[252:255]
    s_waitcnt lgkmcnt(4)
    v_mfma_f32_16x16x32_bf16 v[64:67], a[192:195], a[16:19], v[64:67]
    ds_read_b64_tr_b16 a[208:209], v55 offset:12416
    ds_read_b64_tr_b16 a[210:211], v55 offset:18560
    v_mfma_f32_16x16x32_bf16 v[72:75], a[192:195], a[20:23], v[72:75]
    s_mov_b32 s53, 28544
    buffer_load_dwordx4 v52, s[20:23], s53 offen offset:3072 lds
    v_mfma_f32_16x16x32_bf16 v[80:83], a[192:195], a[24:27], v[80:83]
    v_mfma_f32_16x16x32_bf16 v[88:91], a[192:195], a[28:31], v[88:91]
    v_mfma_f32_16x16x32_bf16 v[68:71], a[196:199], a[16:19], v[68:71]
    ds_read_b64_tr_b16 a[212:213], v56 offset:12416
    ds_read_b64_tr_b16 a[214:215], v56 offset:18560
    v_mfma_f32_16x16x32_bf16 v[76:79], a[196:199], a[20:23], v[76:79]
    v_mfma_f32_16x16x32_bf16 v[84:87], a[196:199], a[24:27], v[84:87]
    v_mfma_f32_16x16x32_bf16 v[92:95], a[196:199], a[28:31], v[92:95]
    s_waitcnt lgkmcnt(4)
    v_mfma_f32_16x16x32_bf16 v[96:99], a[200:203], a[16:19], v[96:99]
    ds_read_b64_tr_b16 a[216:217], v57 offset:12416
    ds_read_b64_tr_b16 a[218:219], v57 offset:18560
    v_mfma_f32_16x16x32_bf16 v[104:107], a[200:203], a[20:23], v[104:107]
    v_mfma_f32_16x16x32_bf16 v[112:115], a[200:203], a[24:27], v[112:115]
    s_add_u32 m0, s42, 36864
    s_mov_b32 s53, 41856
    v_mfma_f32_16x16x32_bf16 v[120:123], a[200:203], a[28:31], v[120:123]
    buffer_load_dwordx4 v51, s[20:23], s53 offen offset:0 lds
    v_mfma_f32_16x16x32_bf16 v[100:103], a[204:207], a[16:19], v[100:103]
    ds_read_b64_tr_b16 a[220:221], v58 offset:12416
    ds_read_b64_tr_b16 a[222:223], v58 offset:18560
    v_mfma_f32_16x16x32_bf16 v[108:111], a[204:207], a[20:23], v[108:111]
    s_waitcnt vmcnt(22)
    s_barrier
    v_mfma_f32_16x16x32_bf16 v[116:119], a[204:207], a[24:27], v[116:119]
    v_mfma_f32_16x16x32_bf16 v[124:127], a[204:207], a[28:31], v[124:127]
    s_waitcnt lgkmcnt(4)
    s_mov_b32 s53, 51072
    v_mfma_f32_16x16x32_bf16 v[128:131], a[208:211], a[16:19], v[128:131]
    ds_read_b64_tr_b16 a[192:193], v55 offset:12544
    ds_read_b64_tr_b16 a[194:195], v55 offset:18688
    v_mfma_f32_16x16x32_bf16 v[136:139], a[208:211], a[20:23], v[136:139]
    buffer_load_dwordx4 v52, s[20:23], s53 offen offset:1024 lds
    v_mfma_f32_16x16x32_bf16 v[144:147], a[208:211], a[24:27], v[144:147]
    v_mfma_f32_16x16x32_bf16 v[152:155], a[208:211], a[28:31], v[152:155]
    v_mfma_f32_16x16x32_bf16 v[132:135], a[212:215], a[16:19], v[132:135]
    ds_read_b64_tr_b16 a[196:197], v56 offset:12544
    ds_read_b64_tr_b16 a[198:199], v56 offset:18688
    v_mfma_f32_16x16x32_bf16 v[140:143], a[212:215], a[20:23], v[140:143]
    s_mov_b32 s53, 60288
    buffer_load_dwordx4 v51, s[20:23], s53 offen offset:2048 lds
    v_mfma_f32_16x16x32_bf16 v[148:151], a[212:215], a[24:27], v[148:151]
    v_mfma_f32_16x16x32_bf16 v[156:159], a[212:215], a[28:31], v[156:159]
    s_waitcnt lgkmcnt(4)
    v_mfma_f32_16x16x32_bf16 v[160:163], a[216:219], a[16:19], v[160:163]
    ds_read_b64_tr_b16 a[200:201], v57 offset:12544
    ds_read_b64_tr_b16 a[202:203], v57 offset:18688
    v_mfma_f32_16x16x32_bf16 v[168:171], a[216:219], a[20:23], v[168:171]
    s_mov_b32 s53, 69504
    buffer_load_dwordx4 v52, s[20:23], s53 offen offset:3072 lds
    v_mfma_f32_16x16x32_bf16 v[176:179], a[216:219], a[24:27], v[176:179]
    v_mfma_f32_16x16x32_bf16 v[184:187], a[216:219], a[28:31], v[184:187]
    v_mfma_f32_16x16x32_bf16 v[164:167], a[220:223], a[16:19], v[164:167]
    ds_read_b64_tr_b16 a[204:205], v58 offset:12544
    ds_read_b64_tr_b16 a[206:207], v58 offset:18688
    v_mfma_f32_16x16x32_bf16 v[172:175], a[220:223], a[20:23], v[172:175]
    s_add_u32 m0, s41, 0
    s_mov_b32 s53, 5505024
    v_mfma_f32_16x16x32_bf16 v[180:183], a[220:223], a[24:27], v[180:183]
    buffer_load_dwordx4 v48, s[24:27], s53 offen offset:0 lds
    v_mfma_f32_16x16x32_bf16 v[188:191], a[220:223], a[28:31], v[188:191]
    s_waitcnt lgkmcnt(4)
    v_mfma_f32_16x16x32_bf16 v[192:195], a[192:195], a[16:19], v[192:195]
    ds_read_b64_tr_b16 a[208:209], v55 offset:24576
    ds_read_b64_tr_b16 a[210:211], v55 offset:30720
    v_mfma_f32_16x16x32_bf16 v[200:203], a[192:195], a[20:23], v[200:203]
    v_mfma_f32_16x16x32_bf16 v[208:211], a[192:195], a[24:27], v[208:211]
    buffer_load_dwordx4 v49, s[24:27], s53 offen offset:1024 lds
    v_mfma_f32_16x16x32_bf16 v[216:219], a[192:195], a[28:31], v[216:219]
    v_mfma_f32_16x16x32_bf16 v[196:199], a[196:199], a[16:19], v[196:199]
    ds_read_b64_tr_b16 a[212:213], v56 offset:24576
    ds_read_b64_tr_b16 a[214:215], v56 offset:30720
    v_mfma_f32_16x16x32_bf16 v[204:207], a[196:199], a[20:23], v[204:207]
    v_mfma_f32_16x16x32_bf16 v[212:215], a[196:199], a[24:27], v[212:215]
    buffer_load_dwordx4 v50, s[24:27], s53 offen offset:2048 lds
    v_mfma_f32_16x16x32_bf16 v[220:223], a[196:199], a[28:31], v[220:223]
    s_waitcnt lgkmcnt(4)
    v_mfma_f32_16x16x32_bf16 v[224:227], a[200:203], a[16:19], v[224:227]
    ds_read_b64_tr_b16 a[216:217], v57 offset:24576
    ds_read_b64_tr_b16 a[218:219], v57 offset:30720
    v_mfma_f32_16x16x32_bf16 v[232:235], a[200:203], a[20:23], v[232:235]
    v_mfma_f32_16x16x32_bf16 v[240:243], a[200:203], a[24:27], v[240:243]
    v_mfma_f32_16x16x32_bf16 v[248:251], a[200:203], a[28:31], v[248:251]
    v_mfma_f32_16x16x32_bf16 v[228:231], a[204:207], a[16:19], v[228:231]
    ds_read_b64_tr_b16 a[220:221], v58 offset:24576
    ds_read_b64_tr_b16 a[222:223], v58 offset:30720
    v_mfma_f32_16x16x32_bf16 v[236:239], a[204:207], a[20:23], v[236:239]
    v_mfma_f32_16x16x32_bf16 v[244:247], a[204:207], a[24:27], v[244:247]
    v_mfma_f32_16x16x32_bf16 v[252:255], a[204:207], a[28:31], v[252:255]
    s_waitcnt lgkmcnt(4)
    v_mfma_f32_16x16x32_bf16 v[64:67], a[208:211], a[32:35], v[64:67]
    s_waitcnt vmcnt(17)
    ds_read_b64_tr_b16 a[192:193], v55 offset:24704
    ds_read_b64_tr_b16 a[194:195], v55 offset:30848
    v_mfma_f32_16x16x32_bf16 v[72:75], a[208:211], a[36:39], v[72:75]
    v_mfma_f32_16x16x32_bf16 v[80:83], a[208:211], a[40:43], v[80:83]
    ds_read_b128 a[64:67], v53 offset:0
    ds_read_b128 a[68:71], v53 offset:2048
    v_mfma_f32_16x16x32_bf16 v[88:91], a[208:211], a[44:47], v[88:91]
    v_mfma_f32_16x16x32_bf16 v[68:71], a[212:215], a[32:35], v[68:71]
    ds_read_b64_tr_b16 a[196:197], v56 offset:24704
    ds_read_b64_tr_b16 a[198:199], v56 offset:30848
    v_mfma_f32_16x16x32_bf16 v[76:79], a[212:215], a[36:39], v[76:79]
    v_mfma_f32_16x16x32_bf16 v[84:87], a[212:215], a[40:43], v[84:87]
    ds_read_b128 a[72:75], v53 offset:4096
    ds_read_b128 a[76:79], v53 offset:6144
    v_mfma_f32_16x16x32_bf16 v[92:95], a[212:215], a[44:47], v[92:95]
    s_waitcnt lgkmcnt(8)
    v_mfma_f32_16x16x32_bf16 v[96:99], a[216:219], a[32:35], v[96:99]
    ds_read_b64_tr_b16 a[200:201], v57 offset:24704
    ds_read_b64_tr_b16 a[202:203], v57 offset:30848
    v_mfma_f32_16x16x32_bf16 v[104:107], a[216:219], a[36:39], v[104:107]
    v_mfma_f32_16x16x32_bf16 v[112:115], a[216:219], a[40:43], v[112:115]
    ds_read_b128 a[80:83], v54 offset:0
    ds_read_b128 a[84:87], v54 offset:2048
    v_mfma_f32_16x16x32_bf16 v[120:123], a[216:219], a[44:47], v[120:123]
    v_mfma_f32_16x16x32_bf16 v[100:103], a[220:223], a[32:35], v[100:103]
    ds_read_b64_tr_b16 a[204:205], v58 offset:24704
    ds_read_b64_tr_b16 a[206:207], v58 offset:30848
    v_mfma_f32_16x16x32_bf16 v[108:111], a[220:223], a[36:39], v[108:111]
    s_barrier
    v_mfma_f32_16x16x32_bf16 v[116:119], a[220:223], a[40:43], v[116:119]
    s_add_u32 m0, s41, 12288
    ds_read_b128 a[88:91], v54 offset:4096
    ds_read_b128 a[92:95], v54 offset:6144
    v_mfma_f32_16x16x32_bf16 v[124:127], a[220:223], a[44:47], v[124:127]
    s_waitcnt lgkmcnt(10)
    s_mov_b32 s53, 5898240
    v_mfma_f32_16x16x32_bf16 v[128:131], a[192:195], a[32:35], v[128:131]
    ds_read_b64_tr_b16 a[208:209], v55 offset:24832
    ds_read_b64_tr_b16 a[210:211], v55 offset:30976
    v_mfma_f32_16x16x32_bf16 v[136:139], a[192:195], a[36:39], v[136:139]
    buffer_load_dwordx4 v48, s[24:27], s53 offen offset:0 lds
    v_mfma_f32_16x16x32_bf16 v[144:147], a[192:195], a[40:43], v[144:147]
    v_mfma_f32_16x16x32_bf16 v[152:155], a[192:195], a[44:47], v[152:155]
    v_mfma_f32_16x16x32_bf16 v[132:135], a[196:199], a[32:35], v[132:135]
    ds_read_b64_tr_b16 a[212:213], v56 offset:24832
    ds_read_b64_tr_b16 a[214:215], v56 offset:30976
    v_mfma_f32_16x16x32_bf16 v[140:143], a[196:199], a[36:39], v[140:143]
    buffer_load_dwordx4 v49, s[24:27], s53 offen offset:1024 lds
    v_mfma_f32_16x16x32_bf16 v[148:151], a[196:199], a[40:43], v[148:151]
    v_mfma_f32_16x16x32_bf16 v[156:159], a[196:199], a[44:47], v[156:159]
    s_waitcnt lgkmcnt(6)
    v_mfma_f32_16x16x32_bf16 v[160:163], a[200:203], a[32:35], v[160:163]
    ds_read_b64_tr_b16 a[216:217], v57 offset:24832
    ds_read_b64_tr_b16 a[218:219], v57 offset:30976
    v_mfma_f32_16x16x32_bf16 v[168:171], a[200:203], a[36:39], v[168:171]
    buffer_load_dwordx4 v50, s[24:27], s53 offen offset:2048 lds
    v_mfma_f32_16x16x32_bf16 v[176:179], a[200:203], a[40:43], v[176:179]
    v_mfma_f32_16x16x32_bf16 v[184:187], a[200:203], a[44:47], v[184:187]
    v_mfma_f32_16x16x32_bf16 v[164:167], a[204:207], a[32:35], v[164:167]
    ds_read_b64_tr_b16 a[220:221], v58 offset:24832
    ds_read_b64_tr_b16 a[222:223], v58 offset:30976
    v_mfma_f32_16x16x32_bf16 v[172:175], a[204:207], a[36:39], v[172:175]
    v_mfma_f32_16x16x32_bf16 v[180:183], a[204:207], a[40:43], v[180:183]
    v_mfma_f32_16x16x32_bf16 v[188:191], a[204:207], a[44:47], v[188:191]
    s_waitcnt lgkmcnt(4)
    v_mfma_f32_16x16x32_bf16 v[192:195], a[208:211], a[32:35], v[192:195]
    ds_read_b64_tr_b16 a[192:193], v59 offset:0
    ds_read_b64_tr_b16 a[194:195], v59 offset:6144
    v_mfma_f32_16x16x32_bf16 v[200:203], a[208:211], a[36:39], v[200:203]
    v_mfma_f32_16x16x32_bf16 v[208:211], a[208:211], a[40:43], v[208:211]
    s_add_u32 m0, s42, 0
    s_mov_b32 s53, 1024
    v_mfma_f32_16x16x32_bf16 v[216:219], a[208:211], a[44:47], v[216:219]
    buffer_load_dwordx4 v51, s[20:23], s53 offen offset:0 lds
    v_mfma_f32_16x16x32_bf16 v[196:199], a[212:215], a[32:35], v[196:199]
    ds_read_b64_tr_b16 a[196:197], v60 offset:0
    ds_read_b64_tr_b16 a[198:199], v60 offset:6144
    v_mfma_f32_16x16x32_bf16 v[204:207], a[212:215], a[36:39], v[204:207]
    v_mfma_f32_16x16x32_bf16 v[212:215], a[212:215], a[40:43], v[212:215]
    v_mfma_f32_16x16x32_bf16 v[220:223], a[212:215], a[44:47], v[220:223]
    s_waitcnt lgkmcnt(4)
    s_mov_b32 s53, 10240
    v_mfma_f32_16x16x32_bf16 v[224:227], a[216:219], a[32:35], v[224:227]
    ds_read_b64_tr_b16 a[200:201], v61 offset:0
    ds_read_b64_tr_b16 a[202:203], v61 offset:6144
    v_mfma_f32_16x16x32_bf16 v[232:235], a[216:219], a[36:39], v[232:235]
    buffer_load_dwordx4 v52, s[20:23], s53 offen offset:1024 lds
    v_mfma_f32_16x16x32_bf16 v[240:243], a[216:219], a[40:43], v[240:243]
    v_mfma_f32_16x16x32_bf16 v[248:251], a[216:219], a[44:47], v[248:251]
    v_mfma_f32_16x16x32_bf16 v[228:231], a[220:223], a[32:35], v[228:231]
    ds_read_b64_tr_b16 a[204:205], v62 offset:0
    ds_read_b64_tr_b16 a[206:207], v62 offset:6144
    v_mfma_f32_16x16x32_bf16 v[236:239], a[220:223], a[36:39], v[236:239]
    s_mov_b32 s53, 19456
    buffer_load_dwordx4 v51, s[20:23], s53 offen offset:2048 lds
    v_mfma_f32_16x16x32_bf16 v[244:247], a[220:223], a[40:43], v[244:247]
    v_mfma_f32_16x16x32_bf16 v[252:255], a[220:223], a[44:47], v[252:255]
    s_waitcnt lgkmcnt(4)
    v_mfma_f32_16x16x32_bf16 v[64:67], a[192:195], a[48:51], v[64:67]
    ds_read_b64_tr_b16 a[208:209], v59 offset:128
    ds_read_b64_tr_b16 a[210:211], v59 offset:6272
    v_mfma_f32_16x16x32_bf16 v[72:75], a[192:195], a[52:55], v[72:75]
    s_mov_b32 s53, 28672
    buffer_load_dwordx4 v52, s[20:23], s53 offen offset:3072 lds
    v_mfma_f32_16x16x32_bf16 v[80:83], a[192:195], a[56:59], v[80:83]
    v_mfma_f32_16x16x32_bf16 v[88:91], a[192:195], a[60:63], v[88:91]
    v_mfma_f32_16x16x32_bf16 v[68:71], a[196:199], a[48:51], v[68:71]
    ds_read_b64_tr_b16 a[212:213], v60 offset:128
    ds_read_b64_tr_b16 a[214:215], v60 offset:6272
    v_mfma_f32_16x16x32_bf16 v[76:79], a[196:199], a[52:55], v[76:79]
    v_mfma_f32_16x16x32_bf16 v[84:87], a[196:199], a[56:59], v[84:87]
    v_mfma_f32_16x16x32_bf16 v[92:95], a[196:199], a[60:63], v[92:95]
    s_waitcnt lgkmcnt(4)
    v_mfma_f32_16x16x32_bf16 v[96:99], a[200:203], a[48:51], v[96:99]
    ds_read_b64_tr_b16 a[216:217], v61 offset:128
    ds_read_b64_tr_b16 a[218:219], v61 offset:6272
    v_mfma_f32_16x16x32_bf16 v[104:107], a[200:203], a[52:55], v[104:107]
    v_mfma_f32_16x16x32_bf16 v[112:115], a[200:203], a[56:59], v[112:115]
    s_add_u32 m0, s42, 4096
    s_mov_b32 s53, 41984
    v_mfma_f32_16x16x32_bf16 v[120:123], a[200:203], a[60:63], v[120:123]
    buffer_load_dwordx4 v51, s[20:23], s53 offen offset:0 lds
    v_mfma_f32_16x16x32_bf16 v[100:103], a[204:207], a[48:51], v[100:103]
    ds_read_b64_tr_b16 a[220:221], v62 offset:128
    ds_read_b64_tr_b16 a[222:223], v62 offset:6272
    v_mfma_f32_16x16x32_bf16 v[108:111], a[204:207], a[52:55], v[108:111]
    s_waitcnt vmcnt(22)
    s_barrier
    v_mfma_f32_16x16x32_bf16 v[116:119], a[204:207], a[56:59], v[116:119]
    v_mfma_f32_16x16x32_bf16 v[124:127], a[204:207], a[60:63], v[124:127]
    s_waitcnt lgkmcnt(4)
    s_mov_b32 s53, 51200
    v_mfma_f32_16x16x32_bf16 v[128:131], a[208:211], a[48:51], v[128:131]
    ds_read_b64_tr_b16 a[192:193], v59 offset:256
    ds_read_b64_tr_b16 a[194:195], v59 offset:6400
    v_mfma_f32_16x16x32_bf16 v[136:139], a[208:211], a[52:55], v[136:139]
    buffer_load_dwordx4 v52, s[20:23], s53 offen offset:1024 lds
    v_mfma_f32_16x16x32_bf16 v[144:147], a[208:211], a[56:59], v[144:147]
    v_mfma_f32_16x16x32_bf16 v[152:155], a[208:211], a[60:63], v[152:155]
    v_mfma_f32_16x16x32_bf16 v[132:135], a[212:215], a[48:51], v[132:135]
    ds_read_b64_tr_b16 a[196:197], v60 offset:256
    ds_read_b64_tr_b16 a[198:199], v60 offset:6400
    v_mfma_f32_16x16x32_bf16 v[140:143], a[212:215], a[52:55], v[140:143]
    s_mov_b32 s53, 60416
    buffer_load_dwordx4 v51, s[20:23], s53 offen offset:2048 lds
    v_mfma_f32_16x16x32_bf16 v[148:151], a[212:215], a[56:59], v[148:151]
    v_mfma_f32_16x16x32_bf16 v[156:159], a[212:215], a[60:63], v[156:159]
    s_waitcnt lgkmcnt(4)
    v_mfma_f32_16x16x32_bf16 v[160:163], a[216:219], a[48:51], v[160:163]
    ds_read_b64_tr_b16 a[200:201], v61 offset:256
    ds_read_b64_tr_b16 a[202:203], v61 offset:6400
    v_mfma_f32_16x16x32_bf16 v[168:171], a[216:219], a[52:55], v[168:171]
    s_mov_b32 s53, 69632
    buffer_load_dwordx4 v52, s[20:23], s53 offen offset:3072 lds
    v_mfma_f32_16x16x32_bf16 v[176:179], a[216:219], a[56:59], v[176:179]
    v_mfma_f32_16x16x32_bf16 v[184:187], a[216:219], a[60:63], v[184:187]
    v_mfma_f32_16x16x32_bf16 v[164:167], a[220:223], a[48:51], v[164:167]
    ds_read_b64_tr_b16 a[204:205], v62 offset:256
    ds_read_b64_tr_b16 a[206:207], v62 offset:6400
    v_mfma_f32_16x16x32_bf16 v[172:175], a[220:223], a[52:55], v[172:175]
    s_add_u32 m0, s41, 24576
    s_mov_b32 s53, 6291456
    v_mfma_f32_16x16x32_bf16 v[180:183], a[220:223], a[56:59], v[180:183]
    buffer_load_dwordx4 v48, s[24:27], s53 offen offset:0 lds
    v_mfma_f32_16x16x32_bf16 v[188:191], a[220:223], a[60:63], v[188:191]
    s_waitcnt lgkmcnt(4)
    v_mfma_f32_16x16x32_bf16 v[192:195], a[192:195], a[48:51], v[192:195]
    ds_read_b64_tr_b16 a[208:209], v59 offset:12288
    ds_read_b64_tr_b16 a[210:211], v59 offset:18432
    v_mfma_f32_16x16x32_bf16 v[200:203], a[192:195], a[52:55], v[200:203]
    v_mfma_f32_16x16x32_bf16 v[208:211], a[192:195], a[56:59], v[208:211]
    buffer_load_dwordx4 v49, s[24:27], s53 offen offset:1024 lds
    v_mfma_f32_16x16x32_bf16 v[216:219], a[192:195], a[60:63], v[216:219]
    v_mfma_f32_16x16x32_bf16 v[196:199], a[196:199], a[48:51], v[196:199]
    ds_read_b64_tr_b16 a[212:213], v60 offset:12288
    ds_read_b64_tr_b16 a[214:215], v60 offset:18432
    v_mfma_f32_16x16x32_bf16 v[204:207], a[196:199], a[52:55], v[204:207]
    v_mfma_f32_16x16x32_bf16 v[212:215], a[196:199], a[56:59], v[212:215]
    buffer_load_dwordx4 v50, s[24:27], s53 offen offset:2048 lds
    v_mfma_f32_16x16x32_bf16 v[220:223], a[196:199], a[60:63], v[220:223]
    s_waitcnt lgkmcnt(4)
    v_mfma_f32_16x16x32_bf16 v[224:227], a[200:203], a[48:51], v[224:227]
    ds_read_b64_tr_b16 a[216:217], v61 offset:12288
    ds_read_b64_tr_b16 a[218:219], v61 offset:18432
    v_mfma_f32_16x16x32_bf16 v[232:235], a[200:203], a[52:55], v[232:235]
    v_mfma_f32_16x16x32_bf16 v[240:243], a[200:203], a[56:59], v[240:243]
    v_mfma_f32_16x16x32_bf16 v[248:251], a[200:203], a[60:63], v[248:251]
    v_mfma_f32_16x16x32_bf16 v[228:231], a[204:207], a[48:51], v[228:231]
    ds_read_b64_tr_b16 a[220:221], v62 offset:12288
    ds_read_b64_tr_b16 a[222:223], v62 offset:18432
    v_mfma_f32_16x16x32_bf16 v[236:239], a[204:207], a[52:55], v[236:239]
    v_mfma_f32_16x16x32_bf16 v[244:247], a[204:207], a[56:59], v[244:247]
    v_mfma_f32_16x16x32_bf16 v[252:255], a[204:207], a[60:63], v[252:255]
    s_waitcnt lgkmcnt(4)
    v_mfma_f32_16x16x32_bf16 v[64:67], a[208:211], a[64:67], v[64:67]
    s_waitcnt vmcnt(17)
    ds_read_b64_tr_b16 a[192:193], v59 offset:12416
    ds_read_b64_tr_b16 a[194:195], v59 offset:18560
    v_mfma_f32_16x16x32_bf16 v[72:75], a[208:211], a[68:71], v[72:75]
    v_mfma_f32_16x16x32_bf16 v[80:83], a[208:211], a[72:75], v[80:83]
    ds_read_b128 a[96:99], v53 offset:32768
    ds_read_b128 a[100:103], v53 offset:34816
    v_mfma_f32_16x16x32_bf16 v[88:91], a[208:211], a[76:79], v[88:91]
    v_mfma_f32_16x16x32_bf16 v[68:71], a[212:215], a[64:67], v[68:71]
    ds_read_b64_tr_b16 a[196:197], v60 offset:12416
    ds_read_b64_tr_b16 a[198:199], v60 offset:18560
    v_mfma_f32_16x16x32_bf16 v[76:79], a[212:215], a[68:71], v[76:79]
    v_mfma_f32_16x16x32_bf16 v[84:87], a[212:215], a[72:75], v[84:87]
    ds_read_b128 a[104:107], v53 offset:36864
    ds_read_b128 a[108:111], v53 offset:38912
    v_mfma_f32_16x16x32_bf16 v[92:95], a[212:215], a[76:79], v[92:95]
    s_waitcnt lgkmcnt(8)
    v_mfma_f32_16x16x32_bf16 v[96:99], a[216:219], a[64:67], v[96:99]
    ds_read_b64_tr_b16 a[200:201], v61 offset:12416
    ds_read_b64_tr_b16 a[202:203], v61 offset:18560
    v_mfma_f32_16x16x32_bf16 v[104:107], a[216:219], a[68:71], v[104:107]
    v_mfma_f32_16x16x32_bf16 v[112:115], a[216:219], a[72:75], v[112:115]
    ds_read_b128 a[112:115], v54 offset:32768
    ds_read_b128 a[116:119], v54 offset:34816
    v_mfma_f32_16x16x32_bf16 v[120:123], a[216:219], a[76:79], v[120:123]
    v_mfma_f32_16x16x32_bf16 v[100:103], a[220:223], a[64:67], v[100:103]
    ds_read_b64_tr_b16 a[204:205], v62 offset:12416
    ds_read_b64_tr_b16 a[206:207], v62 offset:18560
    v_mfma_f32_16x16x32_bf16 v[108:111], a[220:223], a[68:71], v[108:111]
    s_barrier
    v_mfma_f32_16x16x32_bf16 v[116:119], a[220:223], a[72:75], v[116:119]
    s_add_u32 m0, s41, 36864
    ds_read_b128 a[120:123], v54 offset:36864
    ds_read_b128 a[124:127], v54 offset:38912
    v_mfma_f32_16x16x32_bf16 v[124:127], a[220:223], a[76:79], v[124:127]
    s_waitcnt lgkmcnt(10)
    s_mov_b32 s53, 6684672
    v_mfma_f32_16x16x32_bf16 v[128:131], a[192:195], a[64:67], v[128:131]
    ds_read_b64_tr_b16 a[208:209], v59 offset:12544
    ds_read_b64_tr_b16 a[210:211], v59 offset:18688
    v_mfma_f32_16x16x32_bf16 v[136:139], a[192:195], a[68:71], v[136:139]
    buffer_load_dwordx4 v48, s[24:27], s53 offen offset:0 lds
    v_mfma_f32_16x16x32_bf16 v[144:147], a[192:195], a[72:75], v[144:147]
    v_mfma_f32_16x16x32_bf16 v[152:155], a[192:195], a[76:79], v[152:155]
    v_mfma_f32_16x16x32_bf16 v[132:135], a[196:199], a[64:67], v[132:135]
    ds_read_b64_tr_b16 a[212:213], v60 offset:12544
    ds_read_b64_tr_b16 a[214:215], v60 offset:18688
    v_mfma_f32_16x16x32_bf16 v[140:143], a[196:199], a[68:71], v[140:143]
    buffer_load_dwordx4 v49, s[24:27], s53 offen offset:1024 lds
    v_mfma_f32_16x16x32_bf16 v[148:151], a[196:199], a[72:75], v[148:151]
    v_mfma_f32_16x16x32_bf16 v[156:159], a[196:199], a[76:79], v[156:159]
    s_waitcnt lgkmcnt(6)
    v_mfma_f32_16x16x32_bf16 v[160:163], a[200:203], a[64:67], v[160:163]
    ds_read_b64_tr_b16 a[216:217], v61 offset:12544
    ds_read_b64_tr_b16 a[218:219], v61 offset:18688
    v_mfma_f32_16x16x32_bf16 v[168:171], a[200:203], a[68:71], v[168:171]
    buffer_load_dwordx4 v50, s[24:27], s53 offen offset:2048 lds
    v_mfma_f32_16x16x32_bf16 v[176:179], a[200:203], a[72:75], v[176:179]
    v_mfma_f32_16x16x32_bf16 v[184:187], a[200:203], a[76:79], v[184:187]
    v_mfma_f32_16x16x32_bf16 v[164:167], a[204:207], a[64:67], v[164:167]
    ds_read_b64_tr_b16 a[220:221], v62 offset:12544
    ds_read_b64_tr_b16 a[222:223], v62 offset:18688
    v_mfma_f32_16x16x32_bf16 v[172:175], a[204:207], a[68:71], v[172:175]
    v_mfma_f32_16x16x32_bf16 v[180:183], a[204:207], a[72:75], v[180:183]
    v_mfma_f32_16x16x32_bf16 v[188:191], a[204:207], a[76:79], v[188:191]
    s_waitcnt lgkmcnt(4)
    v_mfma_f32_16x16x32_bf16 v[192:195], a[208:211], a[64:67], v[192:195]
    ds_read_b64_tr_b16 a[192:193], v59 offset:24576
    ds_read_b64_tr_b16 a[194:195], v59 offset:30720
    v_mfma_f32_16x16x32_bf16 v[200:203], a[208:211], a[68:71], v[200:203]
    v_mfma_f32_16x16x32_bf16 v[208:211], a[208:211], a[72:75], v[208:211]
    s_add_u32 m0, s42, 32768
    s_mov_b32 s53, 1152
    v_mfma_f32_16x16x32_bf16 v[216:219], a[208:211], a[76:79], v[216:219]
    buffer_load_dwordx4 v51, s[20:23], s53 offen offset:0 lds
    v_mfma_f32_16x16x32_bf16 v[196:199], a[212:215], a[64:67], v[196:199]
    ds_read_b64_tr_b16 a[196:197], v60 offset:24576
    ds_read_b64_tr_b16 a[198:199], v60 offset:30720
    v_mfma_f32_16x16x32_bf16 v[204:207], a[212:215], a[68:71], v[204:207]
    v_mfma_f32_16x16x32_bf16 v[212:215], a[212:215], a[72:75], v[212:215]
    v_mfma_f32_16x16x32_bf16 v[220:223], a[212:215], a[76:79], v[220:223]
    s_waitcnt lgkmcnt(4)
    s_mov_b32 s53, 10368
    v_mfma_f32_16x16x32_bf16 v[224:227], a[216:219], a[64:67], v[224:227]
    ds_read_b64_tr_b16 a[200:201], v61 offset:24576
    ds_read_b64_tr_b16 a[202:203], v61 offset:30720
    v_mfma_f32_16x16x32_bf16 v[232:235], a[216:219], a[68:71], v[232:235]
    buffer_load_dwordx4 v52, s[20:23], s53 offen offset:1024 lds
    v_mfma_f32_16x16x32_bf16 v[240:243], a[216:219], a[72:75], v[240:243]
    v_mfma_f32_16x16x32_bf16 v[248:251], a[216:219], a[76:79], v[248:251]
    v_mfma_f32_16x16x32_bf16 v[228:231], a[220:223], a[64:67], v[228:231]
    ds_read_b64_tr_b16 a[204:205], v62 offset:24576
    ds_read_b64_tr_b16 a[206:207], v62 offset:30720
    v_mfma_f32_16x16x32_bf16 v[236:239], a[220:223], a[68:71], v[236:239]
    s_mov_b32 s53, 19584
    buffer_load_dwordx4 v51, s[20:23], s53 offen offset:2048 lds
    v_mfma_f32_16x16x32_bf16 v[244:247], a[220:223], a[72:75], v[244:247]
    v_mfma_f32_16x16x32_bf16 v[252:255], a[220:223], a[76:79], v[252:255]
    s_waitcnt lgkmcnt(4)
    v_mfma_f32_16x16x32_bf16 v[64:67], a[192:195], a[80:83], v[64:67]
    ds_read_b64_tr_b16 a[208:209], v59 offset:24704
    ds_read_b64_tr_b16 a[210:211], v59 offset:30848
    v_mfma_f32_16x16x32_bf16 v[72:75], a[192:195], a[84:87], v[72:75]
    s_mov_b32 s53, 28800
    buffer_load_dwordx4 v52, s[20:23], s53 offen offset:3072 lds
    v_mfma_f32_16x16x32_bf16 v[80:83], a[192:195], a[88:91], v[80:83]
    v_mfma_f32_16x16x32_bf16 v[88:91], a[192:195], a[92:95], v[88:91]
    v_mfma_f32_16x16x32_bf16 v[68:71], a[196:199], a[80:83], v[68:71]
    ds_read_b64_tr_b16 a[212:213], v60 offset:24704
    ds_read_b64_tr_b16 a[214:215], v60 offset:30848
    v_mfma_f32_16x16x32_bf16 v[76:79], a[196:199], a[84:87], v[76:79]
    v_mfma_f32_16x16x32_bf16 v[84:87], a[196:199], a[88:91], v[84:87]
    v_mfma_f32_16x16x32_bf16 v[92:95], a[196:199], a[92:95], v[92:95]
    s_waitcnt lgkmcnt(4)
    v_mfma_f32_16x16x32_bf16 v[96:99], a[200:203], a[80:83], v[96:99]
    ds_read_b64_tr_b16 a[216:217], v61 offset:24704
    ds_read_b64_tr_b16 a[218:219], v61 offset:30848
    v_mfma_f32_16x16x32_bf16 v[104:107], a[200:203], a[84:87], v[104:107]
    v_mfma_f32_16x16x32_bf16 v[112:115], a[200:203], a[88:91], v[112:115]
    s_add_u32 m0, s42, 36864
    s_mov_b32 s53, 42112
    v_mfma_f32_16x16x32_bf16 v[120:123], a[200:203], a[92:95], v[120:123]
    buffer_load_dwordx4 v51, s[20:23], s53 offen offset:0 lds
    v_mfma_f32_16x16x32_bf16 v[100:103], a[204:207], a[80:83], v[100:103]
    ds_read_b64_tr_b16 a[220:221], v62 offset:24704
    ds_read_b64_tr_b16 a[222:223], v62 offset:30848
    v_mfma_f32_16x16x32_bf16 v[108:111], a[204:207], a[84:87], v[108:111]
    s_waitcnt vmcnt(22)
    s_barrier
    v_mfma_f32_16x16x32_bf16 v[116:119], a[204:207], a[88:91], v[116:119]
    v_mfma_f32_16x16x32_bf16 v[124:127], a[204:207], a[92:95], v[124:127]
    s_waitcnt lgkmcnt(4)
    s_mov_b32 s53, 51328
    v_mfma_f32_16x16x32_bf16 v[128:131], a[208:211], a[80:83], v[128:131]
    ds_read_b64_tr_b16 a[192:193], v59 offset:24832
    ds_read_b64_tr_b16 a[194:195], v59 offset:30976
    v_mfma_f32_16x16x32_bf16 v[136:139], a[208:211], a[84:87], v[136:139]
    buffer_load_dwordx4 v52, s[20:23], s53 offen offset:1024 lds
    v_mfma_f32_16x16x32_bf16 v[144:147], a[208:211], a[88:91], v[144:147]
    v_mfma_f32_16x16x32_bf16 v[152:155], a[208:211], a[92:95], v[152:155]
    v_mfma_f32_16x16x32_bf16 v[132:135], a[212:215], a[80:83], v[132:135]
    ds_read_b64_tr_b16 a[196:197], v60 offset:24832
    ds_read_b64_tr_b16 a[198:199], v60 offset:30976
    v_mfma_f32_16x16x32_bf16 v[140:143], a[212:215], a[84:87], v[140:143]
    s_mov_b32 s53, 60544
    buffer_load_dwordx4 v51, s[20:23], s53 offen offset:2048 lds
    v_mfma_f32_16x16x32_bf16 v[148:151], a[212:215], a[88:91], v[148:151]
    v_mfma_f32_16x16x32_bf16 v[156:159], a[212:215], a[92:95], v[156:159]
    s_waitcnt lgkmcnt(4)
    v_mfma_f32_16x16x32_bf16 v[160:163], a[216:219], a[80:83], v[160:163]
    ds_read_b64_tr_b16 a[200:201], v61 offset:24832
    ds_read_b64_tr_b16 a[202:203], v61 offset:30976
    v_mfma_f32_16x16x32_bf16 v[168:171], a[216:219], a[84:87], v[168:171]
    s_mov_b32 s53, 69760
    buffer_load_dwordx4 v52, s[20:23], s53 offen offset:3072 lds
    v_mfma_f32_16x16x32_bf16 v[176:179], a[216:219], a[88:91], v[176:179]
    v_mfma_f32_16x16x32_bf16 v[184:187], a[216:219], a[92:95], v[184:187]
    v_mfma_f32_16x16x32_bf16 v[164:167], a[220:223], a[80:83], v[164:167]
    ds_read_b64_tr_b16 a[204:205], v62 offset:24832
    ds_read_b64_tr_b16 a[206:207], v62 offset:30976
    v_mfma_f32_16x16x32_bf16 v[172:175], a[220:223], a[84:87], v[172:175]
    s_add_u32 m0, s41, 49152
    s_mov_b32 s53, 7077888
    v_mfma_f32_16x16x32_bf16 v[180:183], a[220:223], a[88:91], v[180:183]
    buffer_load_dwordx4 v48, s[24:27], s53 offen offset:0 lds
    v_mfma_f32_16x16x32_bf16 v[188:191], a[220:223], a[92:95], v[188:191]
    s_waitcnt lgkmcnt(4)
    v_mfma_f32_16x16x32_bf16 v[192:195], a[192:195], a[80:83], v[192:195]
    ds_read_b64_tr_b16 a[208:209], v55 offset:0
    ds_read_b64_tr_b16 a[210:211], v55 offset:6144
    v_mfma_f32_16x16x32_bf16 v[200:203], a[192:195], a[84:87], v[200:203]
    v_mfma_f32_16x16x32_bf16 v[208:211], a[192:195], a[88:91], v[208:211]
    buffer_load_dwordx4 v49, s[24:27], s53 offen offset:1024 lds
    v_mfma_f32_16x16x32_bf16 v[216:219], a[192:195], a[92:95], v[216:219]
    v_mfma_f32_16x16x32_bf16 v[196:199], a[196:199], a[80:83], v[196:199]
    ds_read_b64_tr_b16 a[212:213], v56 offset:0
    ds_read_b64_tr_b16 a[214:215], v56 offset:6144
    v_mfma_f32_16x16x32_bf16 v[204:207], a[196:199], a[84:87], v[204:207]
    v_mfma_f32_16x16x32_bf16 v[212:215], a[196:199], a[88:91], v[212:215]
    buffer_load_dwordx4 v50, s[24:27], s53 offen offset:2048 lds
    v_mfma_f32_16x16x32_bf16 v[220:223], a[196:199], a[92:95], v[220:223]
    s_waitcnt lgkmcnt(4)
    v_mfma_f32_16x16x32_bf16 v[224:227], a[200:203], a[80:83], v[224:227]
    ds_read_b64_tr_b16 a[216:217], v57 offset:0
    ds_read_b64_tr_b16 a[218:219], v57 offset:6144
    v_mfma_f32_16x16x32_bf16 v[232:235], a[200:203], a[84:87], v[232:235]
    v_mfma_f32_16x16x32_bf16 v[240:243], a[200:203], a[88:91], v[240:243]
    v_mfma_f32_16x16x32_bf16 v[248:251], a[200:203], a[92:95], v[248:251]
    v_mfma_f32_16x16x32_bf16 v[228:231], a[204:207], a[80:83], v[228:231]
    ds_read_b64_tr_b16 a[220:221], v58 offset:0
    ds_read_b64_tr_b16 a[222:223], v58 offset:6144
    v_mfma_f32_16x16x32_bf16 v[236:239], a[204:207], a[84:87], v[236:239]
    v_mfma_f32_16x16x32_bf16 v[244:247], a[204:207], a[88:91], v[244:247]
    v_mfma_f32_16x16x32_bf16 v[252:255], a[204:207], a[92:95], v[252:255]
    s_waitcnt lgkmcnt(4)
    v_mfma_f32_16x16x32_bf16 v[64:67], a[208:211], a[96:99], v[64:67]
    s_waitcnt vmcnt(17)
    ds_read_b64_tr_b16 a[192:193], v55 offset:128
    ds_read_b64_tr_b16 a[194:195], v55 offset:6272
    v_mfma_f32_16x16x32_bf16 v[72:75], a[208:211], a[100:103], v[72:75]
    v_mfma_f32_16x16x32_bf16 v[80:83], a[208:211], a[104:107], v[80:83]
    ds_read_b128 a[0:3], v53 offset:0
    ds_read_b128 a[4:7], v53 offset:2048
    v_mfma_f32_16x16x32_bf16 v[88:91], a[208:211], a[108:111], v[88:91]
    v_mfma_f32_16x16x32_bf16 v[68:71], a[212:215], a[96:99], v[68:71]
    ds_read_b64_tr_b16 a[196:197], v56 offset:128
    ds_read_b64_tr_b16 a[198:199], v56 offset:6272
    v_mfma_f32_16x16x32_bf16 v[76:79], a[212:215], a[100:103], v[76:79]
    v_mfma_f32_16x16x32_bf16 v[84:87], a[212:215], a[104:107], v[84:87]
    ds_read_b128 a[8:11], v53 offset:4096
    ds_read_b128 a[12:15], v53 offset:6144
    v_mfma_f32_16x16x32_bf16 v[92:95], a[212:215], a[108:111], v[92:95]
    s_waitcnt lgkmcnt(8)
    v_mfma_f32_16x16x32_bf16 v[96:99], a[216:219], a[96:99], v[96:99]
    ds_read_b64_tr_b16 a[200:201], v57 offset:128
    ds_read_b64_tr_b16 a[202:203], v57 offset:6272
    v_mfma_f32_16x16x32_bf16 v[104:107], a[216:219], a[100:103], v[104:107]
    v_mfma_f32_16x16x32_bf16 v[112:115], a[216:219], a[104:107], v[112:115]
    ds_read_b128 a[16:19], v54 offset:0
    ds_read_b128 a[20:23], v54 offset:2048
    v_mfma_f32_16x16x32_bf16 v[120:123], a[216:219], a[108:111], v[120:123]
    v_mfma_f32_16x16x32_bf16 v[100:103], a[220:223], a[96:99], v[100:103]
    ds_read_b64_tr_b16 a[204:205], v58 offset:128
    ds_read_b64_tr_b16 a[206:207], v58 offset:6272
    v_mfma_f32_16x16x32_bf16 v[108:111], a[220:223], a[100:103], v[108:111]
    s_barrier
    v_mfma_f32_16x16x32_bf16 v[116:119], a[220:223], a[104:107], v[116:119]
    s_add_u32 m0, s41, 61440
    ds_read_b128 a[24:27], v54 offset:4096
    ds_read_b128 a[28:31], v54 offset:6144
    v_mfma_f32_16x16x32_bf16 v[124:127], a[220:223], a[108:111], v[124:127]
    s_waitcnt lgkmcnt(10)
    s_mov_b32 s53, 7471104
    v_mfma_f32_16x16x32_bf16 v[128:131], a[192:195], a[96:99], v[128:131]
    ds_read_b64_tr_b16 a[208:209], v55 offset:256
    ds_read_b64_tr_b16 a[210:211], v55 offset:6400
    v_mfma_f32_16x16x32_bf16 v[136:139], a[192:195], a[100:103], v[136:139]
    buffer_load_dwordx4 v48, s[24:27], s53 offen offset:0 lds
    v_mfma_f32_16x16x32_bf16 v[144:147], a[192:195], a[104:107], v[144:147]
    v_mfma_f32_16x16x32_bf16 v[152:155], a[192:195], a[108:111], v[152:155]
    v_mfma_f32_16x16x32_bf16 v[132:135], a[196:199], a[96:99], v[132:135]
    ds_read_b64_tr_b16 a[212:213], v56 offset:256
    ds_read_b64_tr_b16 a[214:215], v56 offset:6400
    v_mfma_f32_16x16x32_bf16 v[140:143], a[196:199], a[100:103], v[140:143]
    buffer_load_dwordx4 v49, s[24:27], s53 offen offset:1024 lds
    v_mfma_f32_16x16x32_bf16 v[148:151], a[196:199], a[104:107], v[148:151]
    v_mfma_f32_16x16x32_bf16 v[156:159], a[196:199], a[108:111], v[156:159]
    s_waitcnt lgkmcnt(6)
    v_mfma_f32_16x16x32_bf16 v[160:163], a[200:203], a[96:99], v[160:163]
    ds_read_b64_tr_b16 a[216:217], v57 offset:256
    ds_read_b64_tr_b16 a[218:219], v57 offset:6400
    v_mfma_f32_16x16x32_bf16 v[168:171], a[200:203], a[100:103], v[168:171]
    buffer_load_dwordx4 v50, s[24:27], s53 offen offset:2048 lds
    v_mfma_f32_16x16x32_bf16 v[176:179], a[200:203], a[104:107], v[176:179]
    v_mfma_f32_16x16x32_bf16 v[184:187], a[200:203], a[108:111], v[184:187]
    v_mfma_f32_16x16x32_bf16 v[164:167], a[204:207], a[96:99], v[164:167]
    ds_read_b64_tr_b16 a[220:221], v58 offset:256
    ds_read_b64_tr_b16 a[222:223], v58 offset:6400
    v_mfma_f32_16x16x32_bf16 v[172:175], a[204:207], a[100:103], v[172:175]
    v_mfma_f32_16x16x32_bf16 v[180:183], a[204:207], a[104:107], v[180:183]
    v_mfma_f32_16x16x32_bf16 v[188:191], a[204:207], a[108:111], v[188:191]
    s_waitcnt lgkmcnt(4)
    v_mfma_f32_16x16x32_bf16 v[192:195], a[208:211], a[96:99], v[192:195]
    ds_read_b64_tr_b16 a[192:193], v55 offset:12288
    ds_read_b64_tr_b16 a[194:195], v55 offset:18432
    v_mfma_f32_16x16x32_bf16 v[200:203], a[208:211], a[100:103], v[200:203]
    v_mfma_f32_16x16x32_bf16 v[208:211], a[208:211], a[104:107], v[208:211]
    v_mfma_f32_16x16x32_bf16 v[216:219], a[208:211], a[108:111], v[216:219]
    v_mfma_f32_16x16x32_bf16 v[196:199], a[212:215], a[96:99], v[196:199]
    ds_read_b64_tr_b16 a[196:197], v56 offset:12288
    ds_read_b64_tr_b16 a[198:199], v56 offset:18432
    v_mfma_f32_16x16x32_bf16 v[204:207], a[212:215], a[100:103], v[204:207]
    v_mfma_f32_16x16x32_bf16 v[212:215], a[212:215], a[104:107], v[212:215]
    v_mfma_f32_16x16x32_bf16 v[220:223], a[212:215], a[108:111], v[220:223]
    s_waitcnt lgkmcnt(4)
    v_mfma_f32_16x16x32_bf16 v[224:227], a[216:219], a[96:99], v[224:227]
    ds_read_b64_tr_b16 a[200:201], v57 offset:12288
    ds_read_b64_tr_b16 a[202:203], v57 offset:18432
    v_mfma_f32_16x16x32_bf16 v[232:235], a[216:219], a[100:103], v[232:235]
    v_mfma_f32_16x16x32_bf16 v[240:243], a[216:219], a[104:107], v[240:243]
    v_mfma_f32_16x16x32_bf16 v[248:251], a[216:219], a[108:111], v[248:251]
    v_mfma_f32_16x16x32_bf16 v[228:231], a[220:223], a[96:99], v[228:231]
    ds_read_b64_tr_b16 a[204:205], v58 offset:12288
    ds_read_b64_tr_b16 a[206:207], v58 offset:18432
    v_mfma_f32_16x16x32_bf16 v[236:239], a[220:223], a[100:103], v[236:239]
    v_mfma_f32_16x16x32_bf16 v[244:247], a[220:223], a[104:107], v[244:247]
    v_mfma_f32_16x16x32_bf16 v[252:255], a[220:223], a[108:111], v[252:255]
    s_waitcnt lgkmcnt(4)
    v_mfma_f32_16x16x32_bf16 v[64:67], a[192:195], a[112:115], v[64:67]
    ds_read_b64_tr_b16 a[208:209], v55 offset:12416
    ds_read_b64_tr_b16 a[210:211], v55 offset:18560
    v_mfma_f32_16x16x32_bf16 v[72:75], a[192:195], a[116:119], v[72:75]
    v_mfma_f32_16x16x32_bf16 v[80:83], a[192:195], a[120:123], v[80:83]
    v_mfma_f32_16x16x32_bf16 v[88:91], a[192:195], a[124:127], v[88:91]
    v_mfma_f32_16x16x32_bf16 v[68:71], a[196:199], a[112:115], v[68:71]
    ds_read_b64_tr_b16 a[212:213], v56 offset:12416
    ds_read_b64_tr_b16 a[214:215], v56 offset:18560
    v_mfma_f32_16x16x32_bf16 v[76:79], a[196:199], a[116:119], v[76:79]
    v_mfma_f32_16x16x32_bf16 v[84:87], a[196:199], a[120:123], v[84:87]
    v_mfma_f32_16x16x32_bf16 v[92:95], a[196:199], a[124:127], v[92:95]
    s_waitcnt lgkmcnt(4)
    v_mfma_f32_16x16x32_bf16 v[96:99], a[200:203], a[112:115], v[96:99]
    ds_read_b64_tr_b16 a[216:217], v57 offset:12416
    ds_read_b64_tr_b16 a[218:219], v57 offset:18560
    v_mfma_f32_16x16x32_bf16 v[104:107], a[200:203], a[116:119], v[104:107]
    v_mfma_f32_16x16x32_bf16 v[112:115], a[200:203], a[120:123], v[112:115]
    v_mfma_f32_16x16x32_bf16 v[120:123], a[200:203], a[124:127], v[120:123]
    v_mfma_f32_16x16x32_bf16 v[100:103], a[204:207], a[112:115], v[100:103]
    ds_read_b64_tr_b16 a[220:221], v58 offset:12416
    ds_read_b64_tr_b16 a[222:223], v58 offset:18560
    v_mfma_f32_16x16x32_bf16 v[108:111], a[204:207], a[116:119], v[108:111]
    s_waitcnt vmcnt(17)
    s_barrier
    v_mfma_f32_16x16x32_bf16 v[116:119], a[204:207], a[120:123], v[116:119]
    s_mov_b32 s53, 0
    s_add_u32 m0, s58, 0
    v_mfma_f32_16x16x32_bf16 v[124:127], a[204:207], a[124:127], v[124:127]
    s_waitcnt lgkmcnt(4)
    buffer_load_dwordx4 v1, s[32:35], s53 offen nt lds
    v_mfma_f32_16x16x32_bf16 v[128:131], a[208:211], a[112:115], v[128:131]
    ds_read_b64_tr_b16 a[192:193], v55 offset:12544
    ds_read_b64_tr_b16 a[194:195], v55 offset:18688
    v_mfma_f32_16x16x32_bf16 v[136:139], a[208:211], a[116:119], v[136:139]
    v_mfma_f32_16x16x32_bf16 v[144:147], a[208:211], a[120:123], v[144:147]
    v_mfma_f32_16x16x32_bf16 v[152:155], a[208:211], a[124:127], v[152:155]
    s_add_u32 m0, s58, 4096
    s_nop 0
    buffer_load_dwordx4 v2, s[32:35], s53 offen nt lds
    v_mfma_f32_16x16x32_bf16 v[132:135], a[212:215], a[112:115], v[132:135]
    ds_read_b64_tr_b16 a[196:197], v56 offset:12544
    ds_read_b64_tr_b16 a[198:199], v56 offset:18688
    v_mfma_f32_16x16x32_bf16 v[140:143], a[212:215], a[116:119], v[140:143]
    v_mfma_f32_16x16x32_bf16 v[148:151], a[212:215], a[120:123], v[148:151]
    v_mfma_f32_16x16x32_bf16 v[156:159], a[212:215], a[124:127], v[156:159]
    s_waitcnt lgkmcnt(4)
    s_add_u32 m0, s58, 8192
    v_mfma_f32_16x16x32_bf16 v[160:163], a[216:219], a[112:115], v[160:163]
    ds_read_b64_tr_b16 a[200:201], v57 offset:12544
    ds_read_b64_tr_b16 a[202:203], v57 offset:18688
    v_mfma_f32_16x16x32_bf16 v[168:171], a[216:219], a[116:119], v[168:171]
    buffer_load_dwordx4 v3, s[32:35], s53 offen nt lds
    v_mfma_f32_16x16x32_bf16 v[176:179], a[216:219], a[120:123], v[176:179]
    v_mfma_f32_16x16x32_bf16 v[184:187], a[216:219], a[124:127], v[184:187]
    v_mfma_f32_16x16x32_bf16 v[164:167], a[220:223], a[112:115], v[164:167]
    ds_read_b64_tr_b16 a[204:205], v58 offset:12544
    ds_read_b64_tr_b16 a[206:207], v58 offset:18688
    v_mfma_f32_16x16x32_bf16 v[172:175], a[220:223], a[116:119], v[172:175]
    v_mfma_f32_16x16x32_bf16 v[180:183], a[220:223], a[120:123], v[180:183]
    v_mfma_f32_16x16x32_bf16 v[188:191], a[220:223], a[124:127], v[188:191]
    s_waitcnt lgkmcnt(4)
    v_mfma_f32_16x16x32_bf16 v[192:195], a[192:195], a[112:115], v[192:195]
    ds_read_b64_tr_b16 a[208:209], v55 offset:24576
    ds_read_b64_tr_b16 a[210:211], v55 offset:30720
    v_mfma_f32_16x16x32_bf16 v[200:203], a[192:195], a[116:119], v[200:203]
    v_mfma_f32_16x16x32_bf16 v[208:211], a[192:195], a[120:123], v[208:211]
    v_mfma_f32_16x16x32_bf16 v[216:219], a[192:195], a[124:127], v[216:219]
    v_mfma_f32_16x16x32_bf16 v[196:199], a[196:199], a[112:115], v[196:199]
    ds_read_b64_tr_b16 a[212:213], v56 offset:24576
    ds_read_b64_tr_b16 a[214:215], v56 offset:30720
    v_mfma_f32_16x16x32_bf16 v[204:207], a[196:199], a[116:119], v[204:207]
    v_mfma_f32_16x16x32_bf16 v[212:215], a[196:199], a[120:123], v[212:215]
    v_mfma_f32_16x16x32_bf16 v[220:223], a[196:199], a[124:127], v[220:223]
    s_waitcnt lgkmcnt(4)
    v_mfma_f32_16x16x32_bf16 v[224:227], a[200:203], a[112:115], v[224:227]
    ds_read_b64_tr_b16 a[216:217], v57 offset:24576
    ds_read_b64_tr_b16 a[218:219], v57 offset:30720
    v_mfma_f32_16x16x32_bf16 v[232:235], a[200:203], a[116:119], v[232:235]
    v_mfma_f32_16x16x32_bf16 v[240:243], a[200:203], a[120:123], v[240:243]
    v_mfma_f32_16x16x32_bf16 v[248:251], a[200:203], a[124:127], v[248:251]
    v_mfma_f32_16x16x32_bf16 v[228:231], a[204:207], a[112:115], v[228:231]
    ds_read_b64_tr_b16 a[220:221], v58 offset:24576
    ds_read_b64_tr_b16 a[222:223], v58 offset:30720
    v_mfma_f32_16x16x32_bf16 v[236:239], a[204:207], a[116:119], v[236:239]
    v_mfma_f32_16x16x32_bf16 v[244:247], a[204:207], a[120:123], v[244:247]
    v_mfma_f32_16x16x32_bf16 v[252:255], a[204:207], a[124:127], v[252:255]
    s_waitcnt lgkmcnt(4)
    v_mfma_f32_16x16x32_bf16 v[64:67], a[208:211], a[0:3], v[64:67]
    s_waitcnt vmcnt(9)
    ds_read_b64_tr_b16 a[192:193], v55 offset:24704
    ds_read_b64_tr_b16 a[194:195], v55 offset:30848
    v_mfma_f32_16x16x32_bf16 v[72:75], a[208:211], a[4:7], v[72:75]
    v_mfma_f32_16x16x32_bf16 v[80:83], a[208:211], a[8:11], v[80:83]
    ds_read_b128 a[32:35], v53 offset:32768
    ds_read_b128 a[36:39], v53 offset:34816
    v_mfma_f32_16x16x32_bf16 v[88:91], a[208:211], a[12:15], v[88:91]
    v_mfma_f32_16x16x32_bf16 v[68:71], a[212:215], a[0:3], v[68:71]
    ds_read_b64_tr_b16 a[196:197], v56 offset:24704
    ds_read_b64_tr_b16 a[198:199], v56 offset:30848
    v_mfma_f32_16x16x32_bf16 v[76:79], a[212:215], a[4:7], v[76:79]
    v_mfma_f32_16x16x32_bf16 v[84:87], a[212:215], a[8:11], v[84:87]
    ds_read_b128 a[40:43], v53 offset:36864
    ds_read_b128 a[44:47], v53 offset:38912
    v_mfma_f32_16x16x32_bf16 v[92:95], a[212:215], a[12:15], v[92:95]
    s_waitcnt lgkmcnt(8)
    v_mfma_f32_16x16x32_bf16 v[96:99], a[216:219], a[0:3], v[96:99]
    ds_read_b64_tr_b16 a[200:201], v57 offset:24704
    ds_read_b64_tr_b16 a[202:203], v57 offset:30848
    v_mfma_f32_16x16x32_bf16 v[104:107], a[216:219], a[4:7], v[104:107]
    v_mfma_f32_16x16x32_bf16 v[112:115], a[216:219], a[8:11], v[112:115]
    s_mov_b32 s53, 24576
    ds_read_b128 a[48:51], v54 offset:32768
    ds_read_b128 a[52:55], v54 offset:34816
    v_mfma_f32_16x16x32_bf16 v[120:123], a[216:219], a[12:15], v[120:123]
    s_add_u32 m0, s58, 98304
    s_nop 0
    buffer_load_dwordx4 v1, s[28:31], s53 offen nt lds
    v_mfma_f32_16x16x32_bf16 v[100:103], a[220:223], a[0:3], v[100:103]
    ds_read_b64_tr_b16 a[204:205], v58 offset:24704
    ds_read_b64_tr_b16 a[206:207], v58 offset:30848
    v_mfma_f32_16x16x32_bf16 v[108:111], a[220:223], a[4:7], v[108:111]
    s_barrier
    v_mfma_f32_16x16x32_bf16 v[116:119], a[220:223], a[8:11], v[116:119]
    ds_read_b128 a[56:59], v54 offset:36864
    ds_read_b128 a[60:63], v54 offset:38912
    v_mfma_f32_16x16x32_bf16 v[124:127], a[220:223], a[12:15], v[124:127]
    s_waitcnt lgkmcnt(10)
    s_add_u32 m0, s58, 102400
    v_mfma_f32_16x16x32_bf16 v[128:131], a[192:195], a[0:3], v[128:131]
    ds_read_b64_tr_b16 a[208:209], v55 offset:24832
    ds_read_b64_tr_b16 a[210:211], v55 offset:30976
    v_mfma_f32_16x16x32_bf16 v[136:139], a[192:195], a[4:7], v[136:139]
    buffer_load_dwordx4 v2, s[28:31], s53 offen nt lds
    v_mfma_f32_16x16x32_bf16 v[144:147], a[192:195], a[8:11], v[144:147]
    v_mfma_f32_16x16x32_bf16 v[152:155], a[192:195], a[12:15], v[152:155]
    v_mfma_f32_16x16x32_bf16 v[132:135], a[196:199], a[0:3], v[132:135]
    ds_read_b64_tr_b16 a[212:213], v56 offset:24832
    ds_read_b64_tr_b16 a[214:215], v56 offset:30976
    v_mfma_f32_16x16x32_bf16 v[140:143], a[196:199], a[4:7], v[140:143]
    s_add_u32 m0, s58, 106496
    s_nop 0
    buffer_load_dwordx4 v3, s[28:31], s53 offen nt lds
    v_mfma_f32_16x16x32_bf16 v[148:151], a[196:199], a[8:11], v[148:151]
    v_mfma_f32_16x16x32_bf16 v[156:159], a[196:199], a[12:15], v[156:159]
    s_waitcnt lgkmcnt(6)
    v_mfma_f32_16x16x32_bf16 v[160:163], a[200:203], a[0:3], v[160:163]
    ds_read_b64_tr_b16 a[216:217], v57 offset:24832
    ds_read_b64_tr_b16 a[218:219], v57 offset:30976
    v_mfma_f32_16x16x32_bf16 v[168:171], a[200:203], a[4:7], v[168:171]
    v_mfma_f32_16x16x32_bf16 v[176:179], a[200:203], a[8:11], v[176:179]
    v_mfma_f32_16x16x32_bf16 v[184:187], a[200:203], a[12:15], v[184:187]
    v_mfma_f32_16x16x32_bf16 v[164:167], a[204:207], a[0:3], v[164:167]
    ds_read_b64_tr_b16 a[220:221], v58 offset:24832
    ds_read_b64_tr_b16 a[222:223], v58 offset:30976
    v_mfma_f32_16x16x32_bf16 v[172:175], a[204:207], a[4:7], v[172:175]
    s_waitcnt vmcnt(6)
    s_barrier
    v_mfma_f32_16x16x32_bf16 v[180:183], a[204:207], a[8:11], v[180:183]
    v_mfma_f32_16x16x32_bf16 v[188:191], a[204:207], a[12:15], v[188:191]
    s_waitcnt lgkmcnt(4)
    v_mfma_f32_16x16x32_bf16 v[192:195], a[208:211], a[0:3], v[192:195]
    ds_read_b64_tr_b16 a[192:193], v59 offset:0
    ds_read_b64_tr_b16 a[194:195], v59 offset:6144
    v_mfma_f32_16x16x32_bf16 v[200:203], a[208:211], a[4:7], v[200:203]
    v_mfma_f32_16x16x32_bf16 v[208:211], a[208:211], a[8:11], v[208:211]
    v_mfma_f32_16x16x32_bf16 v[216:219], a[208:211], a[12:15], v[216:219]
    v_mfma_f32_16x16x32_bf16 v[196:199], a[212:215], a[0:3], v[196:199]
    ds_read_b64_tr_b16 a[196:197], v60 offset:0
    ds_read_b64_tr_b16 a[198:199], v60 offset:6144
    v_mfma_f32_16x16x32_bf16 v[204:207], a[212:215], a[4:7], v[204:207]
    v_mfma_f32_16x16x32_bf16 v[212:215], a[212:215], a[8:11], v[212:215]
    v_mfma_f32_16x16x32_bf16 v[220:223], a[212:215], a[12:15], v[220:223]
    s_waitcnt lgkmcnt(4)
    v_mfma_f32_16x16x32_bf16 v[224:227], a[216:219], a[0:3], v[224:227]
    ds_read_b64_tr_b16 a[200:201], v59 offset:12288
    ds_read_b64_tr_b16 a[202:203], v59 offset:18432
    v_mfma_f32_16x16x32_bf16 v[232:235], a[216:219], a[4:7], v[232:235]
    v_mfma_f32_16x16x32_bf16 v[240:243], a[216:219], a[8:11], v[240:243]
    v_mfma_f32_16x16x32_bf16 v[248:251], a[216:219], a[12:15], v[248:251]
    v_mfma_f32_16x16x32_bf16 v[228:231], a[220:223], a[0:3], v[228:231]
    ds_read_b64_tr_b16 a[204:205], v60 offset:12288
    ds_read_b64_tr_b16 a[206:207], v60 offset:18432
    v_mfma_f32_16x16x32_bf16 v[236:239], a[220:223], a[4:7], v[236:239]
    v_mfma_f32_16x16x32_bf16 v[244:247], a[220:223], a[8:11], v[244:247]
    v_mfma_f32_16x16x32_bf16 v[252:255], a[220:223], a[12:15], v[252:255]
    s_waitcnt lgkmcnt(4)
    v_mfma_f32_16x16x32_bf16 v[64:67], a[192:195], a[16:19], v[64:67]
    ds_read_b64_tr_b16 a[208:209], v59 offset:24576
    ds_read_b64_tr_b16 a[210:211], v59 offset:30720
    v_mfma_f32_16x16x32_bf16 v[72:75], a[192:195], a[20:23], v[72:75]
    v_mfma_f32_16x16x32_bf16 v[80:83], a[192:195], a[24:27], v[80:83]
    v_mfma_f32_16x16x32_bf16 v[88:91], a[192:195], a[28:31], v[88:91]
    v_mfma_f32_16x16x32_bf16 v[68:71], a[196:199], a[16:19], v[68:71]
    ds_read_b64_tr_b16 a[212:213], v60 offset:24576
    ds_read_b64_tr_b16 a[214:215], v60 offset:30720
    v_mfma_f32_16x16x32_bf16 v[76:79], a[196:199], a[20:23], v[76:79]
    v_mfma_f32_16x16x32_bf16 v[84:87], a[196:199], a[24:27], v[84:87]
    s_mov_b32 s53, 12288
    s_add_u32 m0, s58, 12288
    v_mfma_f32_16x16x32_bf16 v[92:95], a[196:199], a[28:31], v[92:95]
    s_waitcnt lgkmcnt(4)
    buffer_load_dwordx4 v1, s[32:35], s53 offen nt lds
    v_mfma_f32_16x16x32_bf16 v[64:67], a[200:203], a[32:35], v[64:67]
    ds_read_b64_tr_b16 a[216:217], v61 offset:0
    ds_read_b64_tr_b16 a[218:219], v61 offset:6144
    v_mfma_f32_16x16x32_bf16 v[72:75], a[200:203], a[36:39], v[72:75]
    v_mfma_f32_16x16x32_bf16 v[80:83], a[200:203], a[40:43], v[80:83]
    v_mfma_f32_16x16x32_bf16 v[88:91], a[200:203], a[44:47], v[88:91]
    s_add_u32 m0, s58, 16384
    s_nop 0
    buffer_load_dwordx4 v2, s[32:35], s53 offen nt lds
    v_mfma_f32_16x16x32_bf16 v[68:71], a[204:207], a[32:35], v[68:71]
    ds_read_b64_tr_b16 a[220:221], v62 offset:0
    ds_read_b64_tr_b16 a[222:223], v62 offset:6144
    v_mfma_f32_16x16x32_bf16 v[76:79], a[204:207], a[36:39], v[76:79]
    s_barrier
    v_mfma_f32_16x16x32_bf16 v[84:87], a[204:207], a[40:43], v[84:87]
    v_mfma_f32_16x16x32_bf16 v[92:95], a[204:207], a[44:47], v[92:95]
    s_waitcnt lgkmcnt(4)
    s_add_u32 m0, s58, 20480
    v_mfma_f32_16x16x32_bf16 v[64:67], a[208:211], a[48:51], v[64:67]
    ds_read_b64_tr_b16 a[192:193], v61 offset:12288
    ds_read_b64_tr_b16 a[194:195], v61 offset:18432
    v_mfma_f32_16x16x32_bf16 v[72:75], a[208:211], a[52:55], v[72:75]
    buffer_load_dwordx4 v3, s[32:35], s53 offen nt lds
    v_mfma_f32_16x16x32_bf16 v[80:83], a[208:211], a[56:59], v[80:83]
    v_mfma_f32_16x16x32_bf16 v[88:91], a[208:211], a[60:63], v[88:91]
    v_mfma_f32_16x16x32_bf16 v[68:71], a[212:215], a[48:51], v[68:71]
    ds_read_b64_tr_b16 a[196:197], v62 offset:12288
    ds_read_b64_tr_b16 a[198:199], v62 offset:18432
    v_mfma_f32_16x16x32_bf16 v[76:79], a[212:215], a[52:55], v[76:79]
    v_mfma_f32_16x16x32_bf16 v[84:87], a[212:215], a[56:59], v[84:87]
    v_mfma_f32_16x16x32_bf16 v[92:95], a[212:215], a[60:63], v[92:95]
    s_waitcnt lgkmcnt(4)
    v_mfma_f32_16x16x32_bf16 v[96:99], a[216:219], a[16:19], v[96:99]
    ds_read_b64_tr_b16 a[200:201], v61 offset:24576
    ds_read_b64_tr_b16 a[202:203], v61 offset:30720
    v_mfma_f32_16x16x32_bf16 v[104:107], a[216:219], a[20:23], v[104:107]
    v_mfma_f32_16x16x32_bf16 v[112:115], a[216:219], a[24:27], v[112:115]
    v_mfma_f32_16x16x32_bf16 v[120:123], a[216:219], a[28:31], v[120:123]
    v_mul_f32 v64, s44, v64
    v_mul_f32 v65, s44, v65
    v_mul_f32 v66, s44, v66
    v_mfma_f32_16x16x32_bf16 v[100:103], a[220:223], a[16:19], v[100:103]
    ds_read_b64_tr_b16 a[204:205], v62 offset:24576
    ds_read_b64_tr_b16 a[206:207], v62 offset:30720
    v_mul_f32 v67, s44, v67
    v_mfma_f32_16x16x32_bf16 v[108:111], a[220:223], a[20:23], v[108:111]
    v_mul_f32 v68, s44, v68
    v_mul_f32 v69, s44, v69
    v_mul_f32 v70, s44, v70
    v_mfma_f32_16x16x32_bf16 v[116:119], a[220:223], a[24:27], v[116:119]
    v_mul_f32 v71, s44, v71
    v_cvt_pk_bf16_f32 v28, v64, v65
    v_cvt_pk_bf16_f32 v29, v66, v67
    v_mfma_f32_16x16x32_bf16 v[124:127], a[220:223], a[28:31], v[124:127]
    s_waitcnt lgkmcnt(4)
    v_cvt_pk_bf16_f32 v30, v68, v69
    v_cvt_pk_bf16_f32 v31, v70, v71
    v_cndmask_b32 v64, v28, v30, vcc
    v_mfma_f32_16x16x32_bf16 v[96:99], a[192:195], a[32:35], v[96:99]
    ds_read_b64_tr_b16 a[208:209], v59 offset:128
    ds_read_b64_tr_b16 a[210:211], v59 offset:6272
    v_cndmask_b32 v65, v29, v31, vcc
    v_mfma_f32_16x16x32_bf16 v[104:107], a[192:195], a[36:39], v[104:107]
    v_cndmask_b32 v66, v30, v28, vcc
    v_cndmask_b32 v67, v31, v29, vcc
    v_mul_f32 v72, s44, v72
    v_mfma_f32_16x16x32_bf16 v[112:115], a[192:195], a[40:43], v[112:115]
    v_mul_f32 v73, s44, v73
    v_mul_f32 v74, s44, v74
    v_mul_f32 v75, s44, v75
    v_mfma_f32_16x16x32_bf16 v[120:123], a[192:195], a[44:47], v[120:123]
    v_mul_f32 v76, s44, v76
    v_mul_f32 v77, s44, v77
    v_mul_f32 v78, s44, v78
    v_mfma_f32_16x16x32_bf16 v[100:103], a[196:199], a[32:35], v[100:103]
    ds_read_b64_tr_b16 a[212:213], v60 offset:128
    ds_read_b64_tr_b16 a[214:215], v60 offset:6272
    v_mul_f32 v79, s44, v79
    v_mfma_f32_16x16x32_bf16 v[108:111], a[196:199], a[36:39], v[108:111]
    v_cvt_pk_bf16_f32 v32, v72, v73
    v_cvt_pk_bf16_f32 v33, v74, v75
    v_cvt_pk_bf16_f32 v34, v76, v77
    v_mfma_f32_16x16x32_bf16 v[116:119], a[196:199], a[40:43], v[116:119]
    v_cvt_pk_bf16_f32 v35, v78, v79
    v_cndmask_b32 v68, v32, v34, vcc
    v_cndmask_b32 v69, v33, v35, vcc
    v_mfma_f32_16x16x32_bf16 v[124:127], a[196:199], a[44:47], v[124:127]
    s_waitcnt lgkmcnt(4)
    v_cndmask_b32 v70, v34, v32, vcc
    v_cndmask_b32 v71, v35, v33, vcc
    v_mul_f32 v80, s44, v80
    v_mfma_f32_16x16x32_bf16 v[96:99], a[200:203], a[48:51], v[96:99]
    ds_read_b64_tr_b16 a[216:217], v59 offset:12416
    ds_read_b64_tr_b16 a[218:219], v59 offset:18560
    v_mul_f32 v81, s44, v81
    v_mfma_f32_16x16x32_bf16 v[104:107], a[200:203], a[52:55], v[104:107]
    v_mul_f32 v82, s44, v82
    v_mul_f32 v83, s44, v83
    v_mul_f32 v84, s44, v84
    v_mfma_f32_16x16x32_bf16 v[112:115], a[200:203], a[56:59], v[112:115]
    v_mul_f32 v85, s44, v85
    v_mul_f32 v86, s44, v86
    v_mul_f32 v87, s44, v87
    v_mfma_f32_16x16x32_bf16 v[120:123], a[200:203], a[60:63], v[120:123]
    v_cvt_pk_bf16_f32 v28, v80, v81
    v_cvt_pk_bf16_f32 v29, v82, v83
    v_cvt_pk_bf16_f32 v30, v84, v85
    v_mfma_f32_16x16x32_bf16 v[100:103], a[204:207], a[48:51], v[100:103]
    ds_read_b64_tr_b16 a[220:221], v60 offset:12416
    ds_read_b64_tr_b16 a[222:223], v60 offset:18560
    v_cvt_pk_bf16_f32 v31, v86, v87
    v_mfma_f32_16x16x32_bf16 v[108:111], a[204:207], a[52:55], v[108:111]
    v_cndmask_b32 v72, v28, v30, vcc
    v_cndmask_b32 v73, v29, v31, vcc
    v_cndmask_b32 v74, v30, v28, vcc
    v_mfma_f32_16x16x32_bf16 v[116:119], a[204:207], a[56:59], v[116:119]
    v_cndmask_b32 v75, v31, v29, vcc
    v_mul_f32 v88, s44, v88
    v_mul_f32 v89, s44, v89
    v_mfma_f32_16x16x32_bf16 v[124:127], a[204:207], a[60:63], v[124:127]
    s_waitcnt lgkmcnt(4)
    v_mul_f32 v90, s44, v90
    v_mul_f32 v91, s44, v91
    v_mul_f32 v92, s44, v92
    v_mfma_f32_16x16x32_bf16 v[128:131], a[208:211], a[16:19], v[128:131]
    ds_read_b64_tr_b16 a[192:193], v59 offset:24704
    ds_read_b64_tr_b16 a[194:195], v59 offset:30848
    v_mul_f32 v93, s44, v93
    v_mfma_f32_16x16x32_bf16 v[136:139], a[208:211], a[20:23], v[136:139]
    v_mul_f32 v94, s44, v94
    v_mul_f32 v95, s44, v95
    v_cvt_pk_bf16_f32 v32, v88, v89
    v_mfma_f32_16x16x32_bf16 v[144:147], a[208:211], a[24:27], v[144:147]
    s_mov_b32 s53, 36864
    s_add_u32 m0, s58, 110592
    v_cvt_pk_bf16_f32 v33, v90, v91
    v_cvt_pk_bf16_f32 v34, v92, v93
    v_mfma_f32_16x16x32_bf16 v[152:155], a[208:211], a[28:31], v[152:155]
    buffer_load_dwordx4 v1, s[28:31], s53 offen nt lds
    v_cvt_pk_bf16_f32 v35, v94, v95
    v_mfma_f32_16x16x32_bf16 v[132:135], a[212:215], a[16:19], v[132:135]
    ds_read_b64_tr_b16 a[196:197], v60 offset:24704
    ds_read_b64_tr_b16 a[198:199], v60 offset:30848
    v_cndmask_b32 v76, v32, v34, vcc
    v_mfma_f32_16x16x32_bf16 v[140:143], a[212:215], a[20:23], v[140:143]
    v_cndmask_b32 v77, v33, v35, vcc
    v_cndmask_b32 v78, v34, v32, vcc
    v_cndmask_b32 v79, v35, v33, vcc
    v_mfma_f32_16x16x32_bf16 v[148:151], a[212:215], a[24:27], v[148:151]
    v_mul_f32 v96, s44, v96
    v_mul_f32 v97, s44, v97
    v_mul_f32 v98, s44, v98
    v_mfma_f32_16x16x32_bf16 v[156:159], a[212:215], a[28:31], v[156:159]
    s_waitcnt lgkmcnt(4)
    s_add_u32 m0, s58, 114688
    v_mul_f32 v99, s44, v99
    v_mul_f32 v100, s44, v100
    v_mfma_f32_16x16x32_bf16 v[128:131], a[216:219], a[32:35], v[128:131]
    ds_read_b64_tr_b16 a[200:201], v61 offset:128
    ds_read_b64_tr_b16 a[202:203], v61 offset:6272
    v_mul_f32 v101, s44, v101
    v_mfma_f32_16x16x32_bf16 v[136:139], a[216:219], a[36:39], v[136:139]
    buffer_load_dwordx4 v2, s[28:31], s53 offen nt lds
    v_mul_f32 v102, s44, v102
    v_mfma_f32_16x16x32_bf16 v[144:147], a[216:219], a[40:43], v[144:147]
    v_mul_f32 v103, s44, v103
    v_cvt_pk_bf16_f32 v28, v96, v97
    v_cvt_pk_bf16_f32 v29, v98, v99
    v_mfma_f32_16x16x32_bf16 v[152:155], a[216:219], a[44:47], v[152:155]
    v_cvt_pk_bf16_f32 v30, v100, v101
    v_cvt_pk_bf16_f32 v31, v102, v103
    v_cndmask_b32 v80, v28, v30, vcc
    v_mfma_f32_16x16x32_bf16 v[132:135], a[220:223], a[32:35], v[132:135]
    ds_read_b64_tr_b16 a[204:205], v62 offset:128
    ds_read_b64_tr_b16 a[206:207], v62 offset:6272
    v_cndmask_b32 v81, v29, v31, vcc
    v_mfma_f32_16x16x32_bf16 v[140:143], a[220:223], a[36:39], v[140:143]
    s_add_u32 m0, s58, 118784
    s_nop 0
    buffer_load_dwordx4 v3, s[28:31], s53 offen nt lds
    v_cndmask_b32 v82, v30, v28, vcc
    v_mfma_f32_16x16x32_bf16 v[148:151], a[220:223], a[40:43], v[148:151]
    v_cndmask_b32 v83, v31, v29, vcc
    v_mul_f32 v104, s44, v104
    v_mul_f32 v105, s44, v105
    v_mfma_f32_16x16x32_bf16 v[156:159], a[220:223], a[44:47], v[156:159]
    s_waitcnt lgkmcnt(4)
    v_mul_f32 v106, s44, v106
    v_mul_f32 v107, s44, v107
    v_mul_f32 v108, s44, v108
    v_mfma_f32_16x16x32_bf16 v[128:131], a[192:195], a[48:51], v[128:131]
    ds_read_b64_tr_b16 a[208:209], v61 offset:12416
    ds_read_b64_tr_b16 a[210:211], v61 offset:18560
    v_mul_f32 v109, s44, v109
    v_mfma_f32_16x16x32_bf16 v[136:139], a[192:195], a[52:55], v[136:139]
    v_mul_f32 v110, s44, v110
    v_mul_f32 v111, s44, v111
    v_cvt_pk_bf16_f32 v32, v104, v105
    v_mfma_f32_16x16x32_bf16 v[144:147], a[192:195], a[56:59], v[144:147]
    v_cvt_pk_bf16_f32 v33, v106, v107
    v_cvt_pk_bf16_f32 v34, v108, v109
    v_cvt_pk_bf16_f32 v35, v110, v111
    v_mfma_f32_16x16x32_bf16 v[152:155], a[192:195], a[60:63], v[152:155]
    v_cndmask_b32 v84, v32, v34, vcc
    v_cndmask_b32 v85, v33, v35, vcc
    v_cndmask_b32 v86, v34, v32, vcc
    v_mfma_f32_16x16x32_bf16 v[132:135], a[196:199], a[48:51], v[132:135]
    ds_read_b64_tr_b16 a[212:213], v62 offset:12416
    ds_read_b64_tr_b16 a[214:215], v62 offset:18560
    v_cndmask_b32 v87, v35, v33, vcc
    v_mfma_f32_16x16x32_bf16 v[140:143], a[196:199], a[52:55], v[140:143]
    v_mul_f32 v112, s44, v112
    v_mul_f32 v113, s44, v113
    v_mul_f32 v114, s44, v114
    v_mfma_f32_16x16x32_bf16 v[148:151], a[196:199], a[56:59], v[148:151]
    v_mul_f32 v115, s44, v115
    v_mul_f32 v116, s44, v116
    v_mul_f32 v117, s44, v117
    v_mfma_f32_16x16x32_bf16 v[156:159], a[196:199], a[60:63], v[156:159]
    s_waitcnt lgkmcnt(4)
    v_mul_f32 v118, s44, v118
    v_mul_f32 v119, s44, v119
    v_cvt_pk_bf16_f32 v28, v112, v113
    v_mfma_f32_16x16x32_bf16 v[160:163], a[200:203], a[16:19], v[160:163]
    ds_read_b64_tr_b16 a[216:217], v61 offset:24704
    ds_read_b64_tr_b16 a[218:219], v61 offset:30848
    v_cvt_pk_bf16_f32 v29, v114, v115
    v_mfma_f32_16x16x32_bf16 v[168:171], a[200:203], a[20:23], v[168:171]
    v_cvt_pk_bf16_f32 v30, v116, v117
    v_cvt_pk_bf16_f32 v31, v118, v119
    v_cndmask_b32 v88, v28, v30, vcc
    v_mfma_f32_16x16x32_bf16 v[176:179], a[200:203], a[24:27], v[176:179]
    v_cndmask_b32 v89, v29, v31, vcc
    v_cndmask_b32 v90, v30, v28, vcc
    v_cndmask_b32 v91, v31, v29, vcc
    v_mfma_f32_16x16x32_bf16 v[184:187], a[200:203], a[28:31], v[184:187]
    v_mul_f32 v120, s44, v120
    v_mul_f32 v121, s44, v121
    v_mul_f32 v122, s44, v122
    v_mfma_f32_16x16x32_bf16 v[164:167], a[204:207], a[16:19], v[164:167]
    ds_read_b64_tr_b16 a[220:221], v62 offset:24704
    ds_read_b64_tr_b16 a[222:223], v62 offset:30848
    v_mul_f32 v123, s44, v123
    v_mfma_f32_16x16x32_bf16 v[172:175], a[204:207], a[20:23], v[172:175]
    v_mul_f32 v124, s44, v124
    v_mul_f32 v125, s44, v125
    v_mul_f32 v126, s44, v126
    v_mfma_f32_16x16x32_bf16 v[180:183], a[204:207], a[24:27], v[180:183]
    v_mul_f32 v127, s44, v127
    v_cvt_pk_bf16_f32 v32, v120, v121
    v_cvt_pk_bf16_f32 v33, v122, v123
    v_mfma_f32_16x16x32_bf16 v[188:191], a[204:207], a[28:31], v[188:191]
    s_waitcnt lgkmcnt(4)
    v_cvt_pk_bf16_f32 v34, v124, v125
    v_cvt_pk_bf16_f32 v35, v126, v127
    v_cndmask_b32 v92, v32, v34, vcc
    v_mfma_f32_16x16x32_bf16 v[160:163], a[208:211], a[32:35], v[160:163]
    ds_read_b64_tr_b16 a[192:193], v59 offset:256
    ds_read_b64_tr_b16 a[194:195], v59 offset:6400
    v_cndmask_b32 v93, v33, v35, vcc
    v_mfma_f32_16x16x32_bf16 v[168:171], a[208:211], a[36:39], v[168:171]
    v_cndmask_b32 v94, v34, v32, vcc
    v_cndmask_b32 v95, v35, v33, vcc
    v_mul_f32 v128, s44, v128
    v_mfma_f32_16x16x32_bf16 v[176:179], a[208:211], a[40:43], v[176:179]
    v_mul_f32 v129, s44, v129
    v_mul_f32 v130, s44, v130
    v_mul_f32 v131, s44, v131
    v_mfma_f32_16x16x32_bf16 v[184:187], a[208:211], a[44:47], v[184:187]
    v_mul_f32 v132, s44, v132
    v_mul_f32 v133, s44, v133
    v_mul_f32 v134, s44, v134
    v_mfma_f32_16x16x32_bf16 v[164:167], a[212:215], a[32:35], v[164:167]
    ds_read_b64_tr_b16 a[196:197], v60 offset:256
    ds_read_b64_tr_b16 a[198:199], v60 offset:6400
    v_mul_f32 v135, s44, v135
    v_mfma_f32_16x16x32_bf16 v[172:175], a[212:215], a[36:39], v[172:175]
    v_cvt_pk_bf16_f32 v28, v128, v129
    v_cvt_pk_bf16_f32 v29, v130, v131
    v_cvt_pk_bf16_f32 v30, v132, v133
    v_mfma_f32_16x16x32_bf16 v[180:183], a[212:215], a[40:43], v[180:183]
    v_cvt_pk_bf16_f32 v31, v134, v135
    v_cndmask_b32 v128, v28, v30, vcc
    v_cndmask_b32 v129, v29, v31, vcc
    v_mfma_f32_16x16x32_bf16 v[188:191], a[212:215], a[44:47], v[188:191]
    s_waitcnt lgkmcnt(4)
    v_cndmask_b32 v130, v30, v28, vcc
    v_cndmask_b32 v131, v31, v29, vcc
    v_mul_f32 v136, s44, v136
    v_mfma_f32_16x16x32_bf16 v[160:163], a[216:219], a[48:51], v[160:163]
    ds_read_b64_tr_b16 a[200:201], v59 offset:12544
    ds_read_b64_tr_b16 a[202:203], v59 offset:18688
    v_mul_f32 v137, s44, v137
    v_mfma_f32_16x16x32_bf16 v[168:171], a[216:219], a[52:55], v[168:171]
    v_mul_f32 v138, s44, v138
    v_mul_f32 v139, s44, v139
    v_mul_f32 v140, s44, v140
    v_mfma_f32_16x16x32_bf16 v[176:179], a[216:219], a[56:59], v[176:179]
    v_mul_f32 v141, s44, v141
    v_mul_f32 v142, s44, v142
    v_mul_f32 v143, s44, v143
    v_mfma_f32_16x16x32_bf16 v[184:187], a[216:219], a[60:63], v[184:187]
    v_cvt_pk_bf16_f32 v32, v136, v137
    v_cvt_pk_bf16_f32 v33, v138, v139
    v_cvt_pk_bf16_f32 v34, v140, v141
    v_mfma_f32_16x16x32_bf16 v[164:167], a[220:223], a[48:51], v[164:167]
    ds_read_b64_tr_b16 a[204:205], v60 offset:12544
    ds_read_b64_tr_b16 a[206:207], v60 offset:18688
    v_cvt_pk_bf16_f32 v35, v142, v143
    v_mfma_f32_16x16x32_bf16 v[172:175], a[220:223], a[52:55], v[172:175]
    v_cndmask_b32 v132, v32, v34, vcc
    v_cndmask_b32 v133, v33, v35, vcc
    v_cndmask_b32 v134, v34, v32, vcc
    v_mfma_f32_16x16x32_bf16 v[180:183], a[220:223], a[56:59], v[180:183]
    s_mov_b32 s53, 24576
    s_add_u32 m0, s58, 24576
    v_cndmask_b32 v135, v35, v33, vcc
    v_mul_f32 v144, s44, v144
    v_mfma_f32_16x16x32_bf16 v[188:191], a[220:223], a[60:63], v[188:191]
    s_waitcnt lgkmcnt(4)
    buffer_load_dwordx4 v1, s[32:35], s53 offen nt lds
    v_mul_f32 v145, s44, v145
    v_mfma_f32_16x16x32_bf16 v[192:195], a[192:195], a[16:19], v[192:195]
    ds_read_b64_tr_b16 a[208:209], v59 offset:24832
    ds_read_b64_tr_b16 a[210:211], v59 offset:30976
    v_mul_f32 v146, s44, v146
    v_mfma_f32_16x16x32_bf16 v[200:203], a[192:195], a[20:23], v[200:203]
    v_mul_f32 v147, s44, v147
    v_mul_f32 v148, s44, v148
    v_mul_f32 v149, s44, v149
    v_mfma_f32_16x16x32_bf16 v[208:211], a[192:195], a[24:27], v[208:211]
    v_mul_f32 v150, s44, v150
    v_mul_f32 v151, s44, v151
    v_cvt_pk_bf16_f32 v28, v144, v145
    v_mfma_f32_16x16x32_bf16 v[216:219], a[192:195], a[28:31], v[216:219]
    s_add_u32 m0, s58, 28672
    s_nop 0
    buffer_load_dwordx4 v2, s[32:35], s53 offen nt lds
    v_cvt_pk_bf16_f32 v29, v146, v147
    v_mfma_f32_16x16x32_bf16 v[196:199], a[196:199], a[16:19], v[196:199]
    ds_read_b64_tr_b16 a[212:213], v60 offset:24832
    ds_read_b64_tr_b16 a[214:215], v60 offset:30976
    v_cvt_pk_bf16_f32 v30, v148, v149
    v_mfma_f32_16x16x32_bf16 v[204:207], a[196:199], a[20:23], v[204:207]
    v_cvt_pk_bf16_f32 v31, v150, v151
    v_cndmask_b32 v136, v28, v30, vcc
    v_cndmask_b32 v137, v29, v31, vcc
    v_mfma_f32_16x16x32_bf16 v[212:215], a[196:199], a[24:27], v[212:215]
    v_cndmask_b32 v138, v30, v28, vcc
    v_cndmask_b32 v139, v31, v29, vcc
    v_mul_f32 v152, s44, v152
    v_mfma_f32_16x16x32_bf16 v[220:223], a[196:199], a[28:31], v[220:223]
    s_waitcnt lgkmcnt(4)
    s_add_u32 m0, s58, 32768
    v_mul_f32 v153, s44, v153
    v_mul_f32 v154, s44, v154
    v_mfma_f32_16x16x32_bf16 v[192:195], a[200:203], a[32:35], v[192:195]
    ds_read_b64_tr_b16 a[216:217], v61 offset:256
    ds_read_b64_tr_b16 a[218:219], v61 offset:6400
    v_mul_f32 v155, s44, v155
    v_mfma_f32_16x16x32_bf16 v[200:203], a[200:203], a[36:39], v[200:203]
    buffer_load_dwordx4 v3, s[32:35], s53 offen nt lds
    v_mul_f32 v156, s44, v156
    v_mfma_f32_16x16x32_bf16 v[208:211], a[200:203], a[40:43], v[208:211]
    v_mul_f32 v157, s44, v157
    v_mul_f32 v158, s44, v158
    v_mul_f32 v159, s44, v159
    v_mfma_f32_16x16x32_bf16 v[216:219], a[200:203], a[44:47], v[216:219]
    v_cvt_pk_bf16_f32 v32, v152, v153
    v_cvt_pk_bf16_f32 v33, v154, v155
    v_cvt_pk_bf16_f32 v34, v156, v157
    v_mfma_f32_16x16x32_bf16 v[196:199], a[204:207], a[32:35], v[196:199]
    ds_read_b64_tr_b16 a[220:221], v62 offset:256
    ds_read_b64_tr_b16 a[222:223], v62 offset:6400
    v_cvt_pk_bf16_f32 v35, v158, v159
    v_mfma_f32_16x16x32_bf16 v[204:207], a[204:207], a[36:39], v[204:207]
    v_cndmask_b32 v140, v32, v34, vcc
    v_cndmask_b32 v141, v33, v35, vcc
    v_cndmask_b32 v142, v34, v32, vcc
    v_mfma_f32_16x16x32_bf16 v[212:215], a[204:207], a[40:43], v[212:215]
    v_cndmask_b32 v143, v35, v33, vcc
    v_mul_f32 v160, s44, v160
    v_mul_f32 v161, s44, v161
    v_mfma_f32_16x16x32_bf16 v[220:223], a[204:207], a[44:47], v[220:223]
    s_waitcnt lgkmcnt(4)
    v_mul_f32 v162, s44, v162
    v_mul_f32 v163, s44, v163
    v_mul_f32 v164, s44, v164
    v_mfma_f32_16x16x32_bf16 v[192:195], a[208:211], a[48:51], v[192:195]
    ds_read_b64_tr_b16 a[192:193], v61 offset:12544
    ds_read_b64_tr_b16 a[194:195], v61 offset:18688
    v_mul_f32 v165, s44, v165
    v_mfma_f32_16x16x32_bf16 v[200:203], a[208:211], a[52:55], v[200:203]
    v_mul_f32 v166, s44, v166
    v_mul_f32 v167, s44, v167
    v_cvt_pk_bf16_f32 v28, v160, v161
    v_mfma_f32_16x16x32_bf16 v[208:211], a[208:211], a[56:59], v[208:211]
    v_cvt_pk_bf16_f32 v29, v162, v163
    v_cvt_pk_bf16_f32 v30, v164, v165
    v_cvt_pk_bf16_f32 v31, v166, v167
    v_mfma_f32_16x16x32_bf16 v[216:219], a[208:211], a[60:63], v[216:219]
    v_cndmask_b32 v144, v28, v30, vcc
    v_cndmask_b32 v145, v29, v31, vcc
    v_cndmask_b32 v146, v30, v28, vcc
    v_mfma_f32_16x16x32_bf16 v[196:199], a[212:215], a[48:51], v[196:199]
    ds_read_b64_tr_b16 a[196:197], v62 offset:12544
    ds_read_b64_tr_b16 a[198:199], v62 offset:18688
    v_cndmask_b32 v147, v31, v29, vcc
    v_mfma_f32_16x16x32_bf16 v[204:207], a[212:215], a[52:55], v[204:207]
    v_mul_f32 v168, s44, v168
    v_mul_f32 v169, s44, v169
    v_mul_f32 v170, s44, v170
    v_mfma_f32_16x16x32_bf16 v[212:215], a[212:215], a[56:59], v[212:215]
    v_mul_f32 v171, s44, v171
    v_mul_f32 v172, s44, v172
    v_mul_f32 v173, s44, v173
    v_mfma_f32_16x16x32_bf16 v[220:223], a[212:215], a[60:63], v[220:223]
    s_waitcnt lgkmcnt(4)
    v_mul_f32 v174, s44, v174
    v_mul_f32 v175, s44, v175
    v_cvt_pk_bf16_f32 v32, v168, v169
    v_mfma_f32_16x16x32_bf16 v[224:227], a[216:219], a[16:19], v[224:227]
    ds_read_b64_tr_b16 a[200:201], v61 offset:24832
    ds_read_b64_tr_b16 a[202:203], v61 offset:30976
    v_cvt_pk_bf16_f32 v33, v170, v171
    v_mfma_f32_16x16x32_bf16 v[232:235], a[216:219], a[20:23], v[232:235]
    v_cvt_pk_bf16_f32 v34, v172, v173
    v_cvt_pk_bf16_f32 v35, v174, v175
    v_cndmask_b32 v148, v32, v34, vcc
    v_mfma_f32_16x16x32_bf16 v[240:243], a[216:219], a[24:27], v[240:243]
    v_cndmask_b32 v149, v33, v35, vcc
    v_cndmask_b32 v150, v34, v32, vcc
    v_cndmask_b32 v151, v35, v33, vcc
    v_mfma_f32_16x16x32_bf16 v[248:251], a[216:219], a[28:31], v[248:251]
    v_mul_f32 v176, s44, v176
    v_mul_f32 v177, s44, v177
    v_mul_f32 v178, s44, v178
    v_mfma_f32_16x16x32_bf16 v[228:231], a[220:223], a[16:19], v[228:231]
    ds_read_b64_tr_b16 a[204:205], v62 offset:24832
    ds_read_b64_tr_b16 a[206:207], v62 offset:30976
    v_mul_f32 v179, s44, v179
    v_mfma_f32_16x16x32_bf16 v[236:239], a[220:223], a[20:23], v[236:239]
    s_barrier
    v_mul_f32 v180, s44, v180
    v_mul_f32 v181, s44, v181
    v_mfma_f32_16x16x32_bf16 v[244:247], a[220:223], a[24:27], v[244:247]
    v_mul_f32 v182, s44, v182
    v_mul_f32 v183, s44, v183
    v_cvt_pk_bf16_f32 v28, v176, v177
    v_mfma_f32_16x16x32_bf16 v[252:255], a[220:223], a[28:31], v[252:255]
    s_waitcnt lgkmcnt(4)
    v_cvt_pk_bf16_f32 v29, v178, v179
    v_cvt_pk_bf16_f32 v30, v180, v181
    v_cvt_pk_bf16_f32 v31, v182, v183
    v_mfma_f32_16x16x32_bf16 v[224:227], a[192:195], a[32:35], v[224:227]
    ds_read_b128 a[208:211], v8 offset:0
    v_cndmask_b32 v152, v28, v30, vcc
    v_cndmask_b32 v153, v29, v31, vcc
    v_mfma_f32_16x16x32_bf16 v[232:235], a[192:195], a[36:39], v[232:235]
    v_cndmask_b32 v154, v30, v28, vcc
    v_cndmask_b32 v155, v31, v29, vcc
    v_mul_f32 v184, s44, v184
    v_mfma_f32_16x16x32_bf16 v[240:243], a[192:195], a[40:43], v[240:243]
    v_mul_f32 v185, s44, v185
    v_mul_f32 v186, s44, v186
    v_mul_f32 v187, s44, v187
    v_mfma_f32_16x16x32_bf16 v[248:251], a[192:195], a[44:47], v[248:251]
    v_mul_f32 v188, s44, v188
    v_mul_f32 v189, s44, v189
    v_mul_f32 v190, s44, v190
    v_mfma_f32_16x16x32_bf16 v[228:231], a[196:199], a[32:35], v[228:231]
    ds_read_b128 a[212:215], v9 offset:0
    v_mul_f32 v191, s44, v191
    v_cvt_pk_bf16_f32 v32, v184, v185
    v_mfma_f32_16x16x32_bf16 v[236:239], a[196:199], a[36:39], v[236:239]
    v_cvt_pk_bf16_f32 v33, v186, v187
    v_cvt_pk_bf16_f32 v34, v188, v189
    v_cvt_pk_bf16_f32 v35, v190, v191
    v_mfma_f32_16x16x32_bf16 v[244:247], a[196:199], a[40:43], v[244:247]
    v_cndmask_b32 v156, v32, v34, vcc
    v_cndmask_b32 v157, v33, v35, vcc
    v_cndmask_b32 v158, v34, v32, vcc
    v_mfma_f32_16x16x32_bf16 v[252:255], a[196:199], a[44:47], v[252:255]
    s_waitcnt lgkmcnt(2)
    v_cndmask_b32 v159, v35, v33, vcc
    v_mul_f32 v192, s44, v192
    v_mul_f32 v193, s44, v193
    v_mfma_f32_16x16x32_bf16 v[224:227], a[200:203], a[48:51], v[224:227]
    ds_read_b128 a[216:219], v8 offset:128
    v_mul_f32 v194, s44, v194
    v_mul_f32 v195, s44, v195
    v_mfma_f32_16x16x32_bf16 v[232:235], a[200:203], a[52:55], v[232:235]
    v_mul_f32 v196, s44, v196
    v_mul_f32 v197, s44, v197
    v_mul_f32 v198, s44, v198
    v_mfma_f32_16x16x32_bf16 v[240:243], a[200:203], a[56:59], v[240:243]
    s_mov_b32 s53, 49152
    s_add_u32 m0, s58, 122880
    v_mul_f32 v199, s44, v199
    v_cvt_pk_bf16_f32 v28, v192, v193
    v_mfma_f32_16x16x32_bf16 v[248:251], a[200:203], a[60:63], v[248:251]
    buffer_load_dwordx4 v1, s[28:31], s53 offen nt lds
    v_cvt_pk_bf16_f32 v29, v194, v195
    v_mfma_f32_16x16x32_bf16 v[228:231], a[204:207], a[48:51], v[228:231]
    ds_read_b128 a[220:223], v9 offset:128
    v_cvt_pk_bf16_f32 v30, v196, v197
    v_cvt_pk_bf16_f32 v31, v198, v199
    v_mfma_f32_16x16x32_bf16 v[236:239], a[204:207], a[52:55], v[236:239]
    v_cndmask_b32 v192, v28, v30, vcc
    v_cndmask_b32 v193, v29, v31, vcc
    v_cndmask_b32 v194, v30, v28, vcc
    v_mfma_f32_16x16x32_bf16 v[244:247], a[204:207], a[56:59], v[244:247]
    v_cndmask_b32 v195, v31, v29, vcc
    v_mul_f32 v200, s44, v200
    v_mul_f32 v201, s44, v201
    v_mfma_f32_16x16x32_bf16 v[252:255], a[204:207], a[60:63], v[252:255]
    s_waitcnt lgkmcnt(2)
    s_add_u32 m0, s58, 126976
    v_mul_f32 v202, s44, v202
    v_mul_f32 v203, s44, v203
    v_mfma_f32_16x16x32_bf16 v[96:99], a[208:211], v[64:67], 0
    ds_read_b128 a[192:195], v8 offset:256
    v_mul_f32 v204, s44, v204
    v_mul_f32 v205, s44, v205
    v_mfma_f32_16x16x32_bf16 v[104:107], a[208:211], v[68:71], 0
    buffer_load_dwordx4 v2, s[28:31], s53 offen nt lds
    v_mul_f32 v206, s44, v206
    v_mfma_f32_16x16x32_bf16 v[112:115], a[208:211], v[72:75], 0
    v_mul_f32 v207, s44, v207
    v_cvt_pk_bf16_f32 v32, v200, v201
    v_cvt_pk_bf16_f32 v33, v202, v203
    v_mfma_f32_16x16x32_bf16 v[120:123], a[208:211], v[76:79], 0
    v_cvt_pk_bf16_f32 v34, v204, v205
    v_cvt_pk_bf16_f32 v35, v206, v207
    v_cndmask_b32 v196, v32, v34, vcc
    v_mfma_f32_16x16x32_bf16 v[96:99], a[212:215], v[80:83], v[96:99]
    ds_read_b128 a[196:199], v9 offset:256
    v_cndmask_b32 v197, v33, v35, vcc
    v_cndmask_b32 v198, v34, v32, vcc
    v_mfma_f32_16x16x32_bf16 v[104:107], a[212:215], v[84:87], v[104:107]
    s_add_u32 m0, s58, 131072
    s_nop 0
    buffer_load_dwordx4 v3, s[28:31], s53 offen nt lds
    v_cndmask_b32 v199, v35, v33, vcc
    v_mfma_f32_16x16x32_bf16 v[112:115], a[212:215], v[88:91], v[112:115]
    v_mul_f32 v208, s44, v208
    v_mul_f32 v209, s44, v209
    v_mul_f32 v210, s44, v210
    v_mfma_f32_16x16x32_bf16 v[120:123], a[212:215], v[92:95], v[120:123]
    s_waitcnt lgkmcnt(2)
    v_mul_f32 v211, s44, v211
    v_mul_f32 v212, s44, v212
    v_mul_f32 v213, s44, v213
    v_mfma_f32_16x16x32_bf16 v[96:99], a[216:219], v[128:131], v[96:99]
    ds_read_b128 a[200:203], v8 offset:6144
    v_mul_f32 v214, s44, v214
    v_mul_f32 v215, s44, v215
    v_mfma_f32_16x16x32_bf16 v[104:107], a[216:219], v[132:135], v[104:107]
    v_cvt_pk_bf16_f32 v28, v208, v209
    v_cvt_pk_bf16_f32 v29, v210, v211
    v_cvt_pk_bf16_f32 v30, v212, v213
    v_mfma_f32_16x16x32_bf16 v[112:115], a[216:219], v[136:139], v[112:115]
    v_cvt_pk_bf16_f32 v31, v214, v215
    v_cndmask_b32 v200, v28, v30, vcc
    v_cndmask_b32 v201, v29, v31, vcc
    v_mfma_f32_16x16x32_bf16 v[120:123], a[216:219], v[140:143], v[120:123]
    v_cndmask_b32 v202, v30, v28, vcc
    v_cndmask_b32 v203, v31, v29, vcc
    v_mul_f32 v216, s44, v216
    v_mfma_f32_16x16x32_bf16 v[96:99], a[220:223], v[144:147], v[96:99]
    ds_read_b128 a[204:207], v9 offset:6144
    v_mul_f32 v217, s44, v217
    v_mul_f32 v218, s44, v218
    v_mfma_f32_16x16x32_bf16 v[104:107], a[220:223], v[148:151], v[104:107]
    s_waitcnt vmcnt(15)
    s_barrier
    v_mul_f32 v219, s44, v219
    v_mul_f32 v220, s44, v220
    v_mfma_f32_16x16x32_bf16 v[112:115], a[220:223], v[152:155], v[112:115]
    v_mul_f32 v221, s44, v221
    v_mul_f32 v222, s44, v222
    v_mul_f32 v223, s44, v223
    v_cvt_pk_bf16_f32 v32, v216, v217
    v_cvt_pk_bf16_f32 v33, v218, v219
    v_cvt_pk_bf16_f32 v34, v220, v221
    v_cvt_pk_bf16_f32 v35, v222, v223
    v_cndmask_b32 v204, v32, v34, vcc
    v_cndmask_b32 v205, v33, v35, vcc
    v_cndmask_b32 v206, v34, v32, vcc
    v_cndmask_b32 v207, v35, v33, vcc
    v_mfma_f32_16x16x32_bf16 v[120:123], a[220:223], v[156:159], v[120:123]
    s_waitcnt lgkmcnt(2)
    v_mul_f32 v224, s44, v224
    v_mul_f32 v225, s44, v225
    v_mul_f32 v226, s44, v226
    v_mfma_f32_16x16x32_bf16 v[96:99], a[192:195], v[192:195], v[96:99]
    ds_read_b128 a[208:211], v8 offset:6272
    v_mul_f32 v227, s44, v227
    v_mul_f32 v228, s44, v228
    v_mfma_f32_16x16x32_bf16 v[104:107], a[192:195], v[196:199], v[104:107]
    v_mul_f32 v229, s44, v229
    v_mul_f32 v230, s44, v230
    v_mul_f32 v231, s44, v231
    v_mfma_f32_16x16x32_bf16 v[112:115], a[192:195], v[200:203], v[112:115]
    v_cvt_pk_bf16_f32 v28, v224, v225
    v_cvt_pk_bf16_f32 v29, v226, v227
    v_cvt_pk_bf16_f32 v30, v228, v229
    v_cvt_pk_bf16_f32 v31, v230, v231
    v_cndmask_b32 v208, v28, v30, vcc
    v_cndmask_b32 v209, v29, v31, vcc
    v_cndmask_b32 v210, v30, v28, vcc
    v_cndmask_b32 v211, v31, v29, vcc
    v_mul_f32 v232, s44, v232
    v_mul_f32 v233, s44, v233
    v_mul_f32 v234, s44, v234
    v_mul_f32 v235, s44, v235
    v_mul_f32 v236, s44, v236
    v_mul_f32 v237, s44, v237
    v_mul_f32 v238, s44, v238
    v_mul_f32 v239, s44, v239
    v_cvt_pk_bf16_f32 v32, v232, v233
    v_cvt_pk_bf16_f32 v33, v234, v235
    v_cvt_pk_bf16_f32 v34, v236, v237
    v_cvt_pk_bf16_f32 v35, v238, v239
    v_cndmask_b32 v212, v32, v34, vcc
    v_cndmask_b32 v213, v33, v35, vcc
    v_cndmask_b32 v214, v34, v32, vcc
    v_cndmask_b32 v215, v35, v33, vcc
    v_mul_f32 v240, s44, v240
    v_mul_f32 v241, s44, v241
    v_mul_f32 v242, s44, v242
    v_mul_f32 v243, s44, v243
    v_mul_f32 v244, s44, v244
    v_mul_f32 v245, s44, v245
    v_mul_f32 v246, s44, v246
    v_mul_f32 v247, s44, v247
    v_cvt_pk_bf16_f32 v28, v240, v241
    v_cvt_pk_bf16_f32 v29, v242, v243
    v_cvt_pk_bf16_f32 v30, v244, v245
    v_cvt_pk_bf16_f32 v31, v246, v247
    v_cndmask_b32 v216, v28, v30, vcc
    v_cndmask_b32 v217, v29, v31, vcc
    v_cndmask_b32 v218, v30, v28, vcc
    v_cndmask_b32 v219, v31, v29, vcc
    v_mul_f32 v248, s44, v248
    v_mul_f32 v249, s44, v249
    v_mul_f32 v250, s44, v250
    v_mul_f32 v251, s44, v251
    v_mul_f32 v252, s44, v252
    v_mul_f32 v253, s44, v253
    v_mul_f32 v254, s44, v254
    v_mul_f32 v255, s44, v255
    v_cvt_pk_bf16_f32 v32, v248, v249
    v_cvt_pk_bf16_f32 v33, v250, v251
    v_cvt_pk_bf16_f32 v34, v252, v253
    v_cvt_pk_bf16_f32 v35, v254, v255
    v_cndmask_b32 v220, v32, v34, vcc
    v_cndmask_b32 v221, v33, v35, vcc
    v_cndmask_b32 v222, v34, v32, vcc
    v_cndmask_b32 v223, v35, v33, vcc
    v_mfma_f32_16x16x32_bf16 v[120:123], a[192:195], v[204:207], v[120:123]
    v_mfma_f32_16x16x32_bf16 v[96:99], a[196:199], v[208:211], v[96:99]
    ds_read_b128 a[212:215], v9 offset:6272
    v_mfma_f32_16x16x32_bf16 v[104:107], a[196:199], v[212:215], v[104:107]
    v_mfma_f32_16x16x32_bf16 v[112:115], a[196:199], v[216:219], v[112:115]
    v_mfma_f32_16x16x32_bf16 v[120:123], a[196:199], v[220:223], v[120:123]
    s_waitcnt lgkmcnt(2)
    v_mfma_f32_16x16x32_bf16 v[100:103], a[200:203], v[64:67], 0
    ds_read_b128 a[216:219], v8 offset:6400
    v_mfma_f32_16x16x32_bf16 v[108:111], a[200:203], v[68:71], 0
    v_mfma_f32_16x16x32_bf16 v[116:119], a[200:203], v[72:75], 0
    v_mfma_f32_16x16x32_bf16 v[124:127], a[200:203], v[76:79], 0
    v_max3_f32 v38, v96, v97, v98
    v_max3_f32 v39, v104, v105, v106
    v_max3_f32 v40, v112, v113, v114
    v_mfma_f32_16x16x32_bf16 v[100:103], a[204:207], v[80:83], v[100:103]
    ds_read_b128 a[220:223], v9 offset:6400
    v_max3_f32 v41, v120, v121, v122
    v_max_f32 v38, v38, v99
    v_mfma_f32_16x16x32_bf16 v[108:111], a[204:207], v[84:87], v[108:111]
    v_max_f32 v39, v39, v107
    v_max_f32 v40, v40, v115
    v_max_f32 v41, v41, v123
    v_mfma_f32_16x16x32_bf16 v[116:119], a[204:207], v[88:91], v[116:119]
    v_mov_b32 v42, v38
    v_mov_b32 v43, v39
    v_mov_b32 v44, v40
    v_mfma_f32_16x16x32_bf16 v[124:127], a[204:207], v[92:95], v[124:127]
    s_waitcnt lgkmcnt(2)
    v_mov_b32 v45, v41
    v_permlane32_swap_b32 v38, v42
    v_mfma_f32_16x16x32_bf16 v[100:103], a[208:211], v[128:131], v[100:103]
    ds_read_b128 a[192:195], v8 offset:12288
    v_permlane32_swap_b32 v39, v43
    v_mfma_f32_16x16x32_bf16 v[108:111], a[208:211], v[132:135], v[108:111]
    v_permlane32_swap_b32 v40, v44
    v_mfma_f32_16x16x32_bf16 v[116:119], a[208:211], v[136:139], v[116:119]
    v_permlane32_swap_b32 v41, v45
    v_max_f32 v38, v38, v42
    v_mfma_f32_16x16x32_bf16 v[124:127], a[208:211], v[140:143], v[124:127]
    v_max_f32 v39, v39, v43
    v_max_f32 v40, v40, v44
    v_max_f32 v41, v41, v45
    v_mfma_f32_16x16x32_bf16 v[100:103], a[212:215], v[144:147], v[100:103]
    ds_read_b128 a[196:199], v9 offset:12288
    v_mov_b32 v42, v38
    v_mov_b32 v43, v39
    v_mfma_f32_16x16x32_bf16 v[108:111], a[212:215], v[148:151], v[108:111]
    v_mov_b32 v44, v40
    v_mov_b32 v45, v41
    v_mfma_f32_16x16x32_bf16 v[116:119], a[212:215], v[152:155], v[116:119]
    s_mov_b32 s53, 36864
    s_add_u32 m0, s58, 36864
    v_permlane16_swap_b32 v38, v42
    v_mfma_f32_16x16x32_bf16 v[124:127], a[212:215], v[156:159], v[124:127]
    s_waitcnt lgkmcnt(2)
    buffer_load_dwordx4 v1, s[32:35], s53 offen nt lds
    v_mfma_f32_16x16x32_bf16 v[100:103], a[216:219], v[192:195], v[100:103]
    ds_read_b128 a[200:203], v8 offset:12416
    v_permlane16_swap_b32 v39, v43
    v_mfma_f32_16x16x32_bf16 v[108:111], a[216:219], v[196:199], v[108:111]
    v_permlane16_swap_b32 v40, v44
    v_mfma_f32_16x16x32_bf16 v[116:119], a[216:219], v[200:203], v[116:119]
    v_permlane16_swap_b32 v41, v45
    v_max_f32 v38, v38, v42
    v_mfma_f32_16x16x32_bf16 v[124:127], a[216:219], v[204:207], v[124:127]
    s_add_u32 m0, s58, 40960
    s_nop 0
    buffer_load_dwordx4 v2, s[32:35], s53 offen nt lds
    v_max_f32 v39, v39, v43
    v_mfma_f32_16x16x32_bf16 v[100:103], a[220:223], v[208:211], v[100:103]
    ds_read_b128 a[204:207], v9 offset:12416
    v_max_f32 v40, v40, v44
    v_max_f32 v41, v41, v45
    v_mfma_f32_16x16x32_bf16 v[108:111], a[220:223], v[212:215], v[108:111]
    v_sub_f32 v224, 0, v38
    v_sub_f32 v225, 0, v38
    v_sub_f32 v226, 0, v38
    v_mfma_f32_16x16x32_bf16 v[116:119], a[220:223], v[216:219], v[116:119]
    v_sub_f32 v227, 0, v38
    v_sub_f32 v228, 0, v39
    v_sub_f32 v229, 0, v39
    v_sub_f32 v230, 0, v39
    v_sub_f32 v231, 0, v39
    v_sub_f32 v232, 0, v40
    v_sub_f32 v233, 0, v40
    v_sub_f32 v234, 0, v40
    v_sub_f32 v235, 0, v40
    v_sub_f32 v236, 0, v41
    v_sub_f32 v237, 0, v41
    v_sub_f32 v238, 0, v41
    v_sub_f32 v239, 0, v41
    v_mfma_f32_16x16x32_bf16 v[124:127], a[220:223], v[220:223], v[124:127]
    s_waitcnt lgkmcnt(2)
    s_add_u32 m0, s58, 45056
    s_nop 0
    buffer_load_dwordx4 v3, s[32:35], s53 offen nt lds
    v_add_u32 v8, 12288, v8
    v_add_u32 v9, 12288, v9
    v_mfma_f32_16x16x32_bf16 v[160:163], a[192:195], v[64:67], v[224:227]
    ds_read_b128 a[208:211], v8 offset:256
    v_mfma_f32_16x16x32_bf16 v[168:171], a[192:195], v[68:71], v[228:231]
    v_mfma_f32_16x16x32_bf16 v[176:179], a[192:195], v[72:75], v[232:235]
    v_sub_f32 v96, v96, v38
    v_sub_f32 v97, v97, v38
    v_sub_f32 v98, v98, v38
    v_sub_f32 v99, v99, v38
    v_mfma_f32_16x16x32_bf16 v[184:187], a[192:195], v[76:79], v[236:239]
    v_sub_f32 v100, v100, v38
    v_sub_f32 v101, v101, v38
    v_sub_f32 v102, v102, v38
    v_sub_f32 v103, v103, v38
    v_mfma_f32_16x16x32_bf16 v[160:163], a[196:199], v[80:83], v[160:163]
    ds_read_b128 a[212:215], v9 offset:256
    v_exp_f32 v28, v96
    v_mfma_f32_16x16x32_bf16 v[168:171], a[196:199], v[84:87], v[168:171]
    v_exp_f32 v29, v97
    s_nop 0
    v_add_f32 v24, v28, v29
    v_mfma_f32_16x16x32_bf16 v[176:179], a[196:199], v[88:91], v[176:179]
    v_exp_f32 v30, v98
    v_exp_f32 v31, v99
    v_mfma_f32_16x16x32_bf16 v[184:187], a[196:199], v[92:95], v[184:187]
    s_waitcnt lgkmcnt(2)
    v_cvt_pk_bf16_f32 v48, v28, v29
    v_add_f32 v24, v24, v30
    v_exp_f32 v32, v100
    v_mfma_f32_16x16x32_bf16 v[160:163], a[200:203], v[128:131], v[160:163]
    ds_read_b128 a[216:219], v8 offset:6144
    v_exp_f32 v33, v101
    v_add_f32 v24, v24, v31
    v_mfma_f32_16x16x32_bf16 v[168:171], a[200:203], v[132:135], v[168:171]
    v_cvt_pk_bf16_f32 v49, v30, v31
    v_exp_f32 v34, v102
    v_mfma_f32_16x16x32_bf16 v[176:179], a[200:203], v[136:139], v[176:179]
    v_exp_f32 v35, v103
    v_add_f32 v24, v24, v32
    v_add_f32 v24, v24, v33
    v_mfma_f32_16x16x32_bf16 v[184:187], a[200:203], v[140:143], v[184:187]
    v_cvt_pk_bf16_f32 v50, v32, v33
    v_add_f32 v24, v24, v34
    v_sub_f32 v104, v104, v39
    v_sub_f32 v105, v105, v39
    v_mfma_f32_16x16x32_bf16 v[160:163], a[204:207], v[144:147], v[160:163]
    s_add_u32 m0, s48, 0
    ds_read_b128 a[220:223], v9 offset:6144
    v_sub_f32 v106, v106, v39
    v_sub_f32 v107, v107, v39
    v_sub_f32 v108, v108, v39
    v_mfma_f32_16x16x32_bf16 v[168:171], a[204:207], v[148:151], v[168:171]
    buffer_load_dwordx4 v1, s[32:35], s45 offen offset:0 nt lds
    v_sub_f32 v109, v109, v39
    v_sub_f32 v110, v110, v39
    v_mfma_f32_16x16x32_bf16 v[176:179], a[204:207], v[152:155], v[176:179]
    v_sub_f32 v111, v111, v39
    v_exp_f32 v28, v104
    v_mfma_f32_16x16x32_bf16 v[184:187], a[204:207], v[156:159], v[184:187]
    s_waitcnt lgkmcnt(2)
    v_exp_f32 v29, v105
    v_add_f32 v24, v24, v35
    v_cvt_pk_bf16_f32 v51, v34, v35
    v_mfma_f32_16x16x32_bf16 v[160:163], a[208:211], v[192:195], v[160:163]
    ds_read_b128 a[192:195], v8 offset:6272
    v_exp_f32 v30, v106
    v_mfma_f32_16x16x32_bf16 v[168:171], a[208:211], v[196:199], v[168:171]
    v_exp_f32 v31, v107
    v_add_f32 v25, v28, v29
    v_cvt_pk_bf16_f32 v52, v28, v29
    v_mfma_f32_16x16x32_bf16 v[176:179], a[208:211], v[200:203], v[176:179]
    v_add_f32 v25, v25, v30
    v_exp_f32 v32, v108
    v_mfma_f32_16x16x32_bf16 v[184:187], a[208:211], v[204:207], v[184:187]
    v_exp_f32 v33, v109
    v_add_f32 v25, v25, v31
    v_cvt_pk_bf16_f32 v53, v30, v31
    v_mfma_f32_16x16x32_bf16 v[160:163], a[212:215], v[208:211], v[160:163]
    ds_read_b128 a[196:199], v9 offset:6272
    v_add_f32 v25, v25, v32
    v_exp_f32 v34, v110
    v_mfma_f32_16x16x32_bf16 v[168:171], a[212:215], v[212:215], v[168:171]
    v_add_f32 v25, v25, v33
    v_exp_f32 v35, v111
    v_cvt_pk_bf16_f32 v54, v32, v33
    v_mfma_f32_16x16x32_bf16 v[176:179], a[212:215], v[216:219], v[176:179]
    v_add_f32 v25, v25, v34
    v_add_f32 v25, v25, v35
    v_sub_f32 v112, v112, v40
    v_sub_f32 v113, v113, v40
    v_mfma_f32_16x16x32_bf16 v[184:187], a[212:215], v[220:223], v[184:187]
    s_waitcnt lgkmcnt(2)
    v_sub_f32 v114, v114, v40
    v_sub_f32 v115, v115, v40
    v_sub_f32 v116, v116, v40
    v_sub_f32 v117, v117, v40
    v_mfma_f32_16x16x32_bf16 v[164:167], a[216:219], v[64:67], v[224:227]
    s_add_u32 m0, s48, 4096
    ds_read_b128 a[200:203], v8 offset:6400
    v_sub_f32 v118, v118, v40
    v_sub_f32 v119, v119, v40
    v_mfma_f32_16x16x32_bf16 v[172:175], a[216:219], v[68:71], v[228:231]
    buffer_load_dwordx4 v2, s[32:35], s45 offen offset:0 nt lds
    v_exp_f32 v28, v112
    v_mfma_f32_16x16x32_bf16 v[180:183], a[216:219], v[72:75], v[232:235]
    v_exp_f32 v29, v113
    v_cvt_pk_bf16_f32 v55, v34, v35
    v_add_f32 v26, v28, v29
    v_mfma_f32_16x16x32_bf16 v[188:191], a[216:219], v[76:79], v[236:239]
    v_exp_f32 v30, v114
    v_exp_f32 v31, v115
    v_mfma_f32_16x16x32_bf16 v[164:167], a[220:223], v[80:83], v[164:167]
    ds_read_b128 a[204:207], v9 offset:6400
    v_cvt_pk_bf16_f32 v56, v28, v29
    v_add_f32 v26, v26, v30
    v_add_f32 v26, v26, v31
    v_mfma_f32_16x16x32_bf16 v[172:175], a[220:223], v[84:87], v[172:175]
    v_exp_f32 v32, v116
    v_exp_f32 v33, v117
    v_mfma_f32_16x16x32_bf16 v[180:183], a[220:223], v[88:91], v[180:183]
    v_cvt_pk_bf16_f32 v57, v30, v31
    v_add_f32 v26, v26, v32
    v_add_f32 v26, v26, v33
    v_mfma_f32_16x16x32_bf16 v[188:191], a[220:223], v[92:95], v[188:191]
    s_waitcnt lgkmcnt(2)
    v_exp_f32 v34, v118
    v_exp_f32 v35, v119
    v_mfma_f32_16x16x32_bf16 v[164:167], a[192:195], v[128:131], v[164:167]
    ds_read_b64_tr_b16 a[208:209], v4 offset:0
    ds_read_b64_tr_b16 a[210:211], v4 offset:6144
    v_cvt_pk_bf16_f32 v58, v32, v33
    v_add_f32 v26, v26, v34
    v_mfma_f32_16x16x32_bf16 v[172:175], a[192:195], v[132:135], v[172:175]
    v_add_f32 v26, v26, v35
    v_sub_f32 v120, v120, v41
    v_sub_f32 v121, v121, v41
    v_sub_f32 v122, v122, v41
    v_mfma_f32_16x16x32_bf16 v[180:183], a[192:195], v[136:139], v[180:183]
    v_sub_f32 v123, v123, v41
    v_sub_f32 v124, v124, v41
    v_sub_f32 v125, v125, v41
    v_sub_f32 v126, v126, v41
    v_mfma_f32_16x16x32_bf16 v[188:191], a[192:195], v[140:143], v[188:191]
    v_sub_f32 v127, v127, v41
    v_exp_f32 v28, v120
    v_mfma_f32_16x16x32_bf16 v[164:167], a[196:199], v[144:147], v[164:167]
    s_add_u32 m0, s48, 8192
    ds_read_b64_tr_b16 a[212:213], v5 offset:0
    ds_read_b64_tr_b16 a[214:215], v5 offset:6144
    v_exp_f32 v29, v121
    v_mfma_f32_16x16x32_bf16 v[172:175], a[196:199], v[148:151], v[172:175]
    buffer_load_dwordx4 v3, s[32:35], s45 offen offset:0 nt lds
    v_cvt_pk_bf16_f32 v59, v34, v35
    v_add_f32 v27, v28, v29
    v_mfma_f32_16x16x32_bf16 v[180:183], a[196:199], v[152:155], v[180:183]
    v_cvt_pk_bf16_f32 v60, v28, v29
    v_exp_f32 v30, v122
    v_mfma_f32_16x16x32_bf16 v[188:191], a[196:199], v[156:159], v[188:191]
    s_waitcnt lgkmcnt(4)
    v_exp_f32 v31, v123
    v_add_f32 v27, v27, v30
    v_add_f32 v27, v27, v31
    v_mfma_f32_16x16x32_bf16 v[164:167], a[200:203], v[192:195], v[164:167]
    ds_read_b64_tr_b16 a[216:217], v6 offset:0
    ds_read_b64_tr_b16 a[218:219], v6 offset:6144
    v_cvt_pk_bf16_f32 v61, v30, v31
    v_mfma_f32_16x16x32_bf16 v[172:175], a[200:203], v[196:199], v[172:175]
    v_exp_f32 v32, v124
    v_exp_f32 v33, v125
    v_mfma_f32_16x16x32_bf16 v[180:183], a[200:203], v[200:203], v[180:183]
    v_add_f32 v27, v27, v32
    v_add_f32 v27, v27, v33
    v_cvt_pk_bf16_f32 v62, v32, v33
    v_mfma_f32_16x16x32_bf16 v[188:191], a[200:203], v[204:207], v[188:191]
    v_exp_f32 v34, v126
    s_nop 0
    v_add_f32 v27, v27, v34
    v_mfma_f32_16x16x32_bf16 v[164:167], a[204:207], v[208:211], v[164:167]
    ds_read_b64_tr_b16 a[220:221], v7 offset:0
    ds_read_b64_tr_b16 a[222:223], v7 offset:6144
    v_exp_f32 v35, v127
    v_mfma_f32_16x16x32_bf16 v[172:175], a[204:207], v[212:215], v[172:175]
    v_add_f32 v27, v27, v35
    v_cvt_pk_bf16_f32 v63, v34, v35
    v_max3_f32 v19, v24, v25, v26
    v_max_f32 v19, v19, v27
    v_mfma_f32_16x16x32_bf16 v[180:183], a[204:207], v[216:219], v[180:183]
    v_cmp_lt_f32 vcc, s43, v19
    v_mfma_f32_16x16x32_bf16 v[188:191], a[204:207], v[220:223], v[188:191]
    s_waitcnt lgkmcnt(4)
    s_cbranch_vccnz RA_F
RA_RET_F:
    v_add_f32 v20, v20, v24
    v_mfma_f32_16x16x32_bf16 a[0:3], a[208:211], v[48:51], 0
    ds_read_b64_tr_b16 a[192:193], v4 offset:128
    ds_read_b64_tr_b16 a[194:195], v4 offset:6272
    v_mfma_f32_16x16x32_bf16 a[8:11], a[208:211], v[52:55], 0
    s_waitcnt vmcnt(15)
    s_barrier
    v_add_f32 v21, v21, v25
    v_mfma_f32_16x16x32_bf16 a[16:19], a[208:211], v[56:59], 0
    v_mfma_f32_16x16x32_bf16 a[24:27], a[208:211], v[60:63], 0
    v_add_f32 v22, v22, v26
    v_add_f32 v23, v23, v27
    v_mfma_f32_16x16x32_bf16 a[4:7], a[212:215], v[48:51], 0
    ds_read_b64_tr_b16 a[196:197], v5 offset:128
    ds_read_b64_tr_b16 a[198:199], v5 offset:6272
    v_mfma_f32_16x16x32_bf16 a[12:15], a[212:215], v[52:55], 0
    v_exp_f32 v28, v160
    v_mfma_f32_16x16x32_bf16 a[20:23], a[212:215], v[56:59], 0
    v_exp_f32 v29, v161
    v_mfma_f32_16x16x32_bf16 a[28:31], a[212:215], v[60:63], 0
    s_waitcnt lgkmcnt(4)
    s_add_u32 s45, s45, 12288
    v_add_f32 v24, v28, v29
    v_mfma_f32_16x16x32_bf16 a[32:35], a[216:219], v[48:51], 0
    s_add_u32 m0, s48, 86016
    ds_read_b64_tr_b16 a[200:201], v6 offset:128
    ds_read_b64_tr_b16 a[202:203], v6 offset:6272
    v_mfma_f32_16x16x32_bf16 a[40:43], a[216:219], v[52:55], 0
    buffer_load_dwordx4 v1, s[28:31], s45 offen offset:0 nt lds
    v_mfma_f32_16x16x32_bf16 a[48:51], a[216:219], v[56:59], 0
    v_exp_f32 v30, v162
    v_mfma_f32_16x16x32_bf16 a[56:59], a[216:219], v[60:63], 0
    v_exp_f32 v31, v163
    v_mfma_f32_16x16x32_bf16 a[36:39], a[220:223], v[48:51], 0
    ds_read_b64_tr_b16 a[204:205], v7 offset:128
    ds_read_b64_tr_b16 a[206:207], v7 offset:6272
    v_mfma_f32_16x16x32_bf16 a[44:47], a[220:223], v[52:55], 0
    v_cvt_pk_bf16_f32 v240, v28, v29
    v_add_f32 v24, v24, v30
    v_mfma_f32_16x16x32_bf16 a[52:55], a[220:223], v[56:59], 0
    v_exp_f32 v32, v164
    v_mfma_f32_16x16x32_bf16 a[60:63], a[220:223], v[60:63], 0
    s_waitcnt lgkmcnt(4)
    v_exp_f32 v33, v165
    v_mfma_f32_16x16x32_bf16 a[64:67], a[192:195], v[48:51], 0
    ds_read_b64_tr_b16 a[208:209], v4 offset:256
    ds_read_b64_tr_b16 a[210:211], v4 offset:6400
    v_mfma_f32_16x16x32_bf16 a[72:75], a[192:195], v[52:55], 0
    v_add_f32 v24, v24, v31
    v_cvt_pk_bf16_f32 v241, v30, v31
    v_mfma_f32_16x16x32_bf16 a[80:83], a[192:195], v[56:59], 0
    v_exp_f32 v34, v166
    v_mfma_f32_16x16x32_bf16 a[88:91], a[192:195], v[60:63], 0
    v_exp_f32 v35, v167
    v_mfma_f32_16x16x32_bf16 a[68:71], a[196:199], v[48:51], 0
    s_add_u32 m0, s48, 90112
    ds_read_b64_tr_b16 a[212:213], v5 offset:256
    ds_read_b64_tr_b16 a[214:215], v5 offset:6400
    v_mfma_f32_16x16x32_bf16 a[76:79], a[196:199], v[52:55], 0
    buffer_load_dwordx4 v2, s[28:31], s45 offen offset:0 nt lds
    v_mfma_f32_16x16x32_bf16 a[84:87], a[196:199], v[56:59], 0
    v_add_f32 v24, v24, v32
    v_add_f32 v24, v24, v33
    v_mfma_f32_16x16x32_bf16 a[92:95], a[196:199], v[60:63], 0
    s_waitcnt lgkmcnt(4)
    v_cvt_pk_bf16_f32 v242, v32, v33
    v_add_f32 v24, v24, v34
    v_mfma_f32_16x16x32_bf16 a[96:99], a[200:203], v[48:51], 0
    ds_read_b64_tr_b16 a[216:217], v6 offset:256
    ds_read_b64_tr_b16 a[218:219], v6 offset:6400
    v_mfma_f32_16x16x32_bf16 a[104:107], a[200:203], v[52:55], 0
    v_exp_f32 v28, v168
    v_mfma_f32_16x16x32_bf16 a[112:115], a[200:203], v[56:59], 0
    v_exp_f32 v29, v169
    v_mfma_f32_16x16x32_bf16 a[120:123], a[200:203], v[60:63], 0
    v_add_f32 v24, v24, v35
    v_cvt_pk_bf16_f32 v243, v34, v35
    v_mfma_f32_16x16x32_bf16 a[100:103], a[204:207], v[48:51], 0
    ds_read_b64_tr_b16 a[220:221], v7 offset:256
    ds_read_b64_tr_b16 a[222:223], v7 offset:6400
    v_mfma_f32_16x16x32_bf16 a[108:111], a[204:207], v[52:55], 0
    v_exp_f32 v30, v170
    v_mfma_f32_16x16x32_bf16 a[116:119], a[204:207], v[56:59], 0
    v_exp_f32 v31, v171
    v_mfma_f32_16x16x32_bf16 a[124:127], a[204:207], v[60:63], 0
    s_waitcnt lgkmcnt(4)
    v_add_f32 v25, v28, v29
    v_cvt_pk_bf16_f32 v244, v28, v29
    v_mfma_f32_16x16x32_bf16 a[128:131], a[208:211], v[48:51], 0
    ds_read_b128 a[192:195], v8 offset:12288
    v_add_f32 v25, v25, v30
    v_mfma_f32_16x16x32_bf16 a[136:139], a[208:211], v[52:55], 0
    v_exp_f32 v32, v172
    v_mfma_f32_16x16x32_bf16 a[144:147], a[208:211], v[56:59], 0
    v_exp_f32 v33, v173
    v_mfma_f32_16x16x32_bf16 a[152:155], a[208:211], v[60:63], 0
    v_add_f32 v25, v25, v31
    v_cvt_pk_bf16_f32 v245, v30, v31
    v_mfma_f32_16x16x32_bf16 a[132:135], a[212:215], v[48:51], 0
    s_add_u32 m0, s48, 94208
    ds_read_b128 a[196:199], v9 offset:12288
    v_add_f32 v25, v25, v32
    v_mfma_f32_16x16x32_bf16 a[140:143], a[212:215], v[52:55], 0
    buffer_load_dwordx4 v3, s[28:31], s45 offen offset:0 nt lds
    v_mfma_f32_16x16x32_bf16 a[148:151], a[212:215], v[56:59], 0
    v_mfma_f32_16x16x32_bf16 a[156:159], a[212:215], v[60:63], 0
    s_waitcnt lgkmcnt(2)
    v_exp_f32 v34, v174
    v_mfma_f32_16x16x32_bf16 a[160:163], a[216:219], v[48:51], 0
    ds_read_b128 a[200:203], v8 offset:12416
    v_add_f32 v25, v25, v33
    v_mfma_f32_16x16x32_bf16 a[168:171], a[216:219], v[52:55], 0
    v_exp_f32 v35, v175
    v_mfma_f32_16x16x32_bf16 a[176:179], a[216:219], v[56:59], 0
    v_mfma_f32_16x16x32_bf16 a[184:187], a[216:219], v[60:63], 0
    v_cvt_pk_bf16_f32 v246, v32, v33
    v_add_f32 v25, v25, v34
    v_mfma_f32_16x16x32_bf16 a[164:167], a[220:223], v[48:51], 0
    ds_read_b128 a[204:207], v9 offset:12416
    v_add_f32 v25, v25, v35
    v_mfma_f32_16x16x32_bf16 a[172:175], a[220:223], v[52:55], 0
    v_exp_f32 v28, v176
    v_mfma_f32_16x16x32_bf16 a[180:183], a[220:223], v[56:59], 0
    v_exp_f32 v29, v177
    v_mfma_f32_16x16x32_bf16 a[188:191], a[220:223], v[60:63], 0
    s_waitcnt lgkmcnt(2)
    v_cvt_pk_bf16_f32 v247, v34, v35
.p2align 3
K_LOOP:
    v_mfma_f32_16x16x32_bf16 v[96:99], a[192:195], v[64:67], v[224:227]
    ds_read_b128 a[208:211], v8 offset:12544
    v_add_f32 v26, v28, v29
    v_mfma_f32_16x16x32_bf16 v[104:107], a[192:195], v[68:71], v[228:231]
    v_exp_f32 v30, v178
    v_mfma_f32_16x16x32_bf16 v[112:115], a[192:195], v[72:75], v[232:235]
    v_exp_f32 v31, v179
    v_mfma_f32_16x16x32_bf16 v[120:123], a[192:195], v[76:79], v[236:239]
    v_cvt_pk_bf16_f32 v248, v28, v29
    v_add_f32 v26, v26, v30
    v_mfma_f32_16x16x32_bf16 v[96:99], a[196:199], v[80:83], v[96:99]
    ds_read_b128 a[212:215], v9 offset:12544
    v_add_f32 v26, v26, v31
    v_mfma_f32_16x16x32_bf16 v[104:107], a[196:199], v[84:87], v[104:107]
    s_add_u32 s54, s54, 1
    v_exp_f32 v32, v180
    v_mfma_f32_16x16x32_bf16 v[112:115], a[196:199], v[88:91], v[112:115]
    v_exp_f32 v33, v181
    v_mfma_f32_16x16x32_bf16 v[120:123], a[196:199], v[92:95], v[120:123]
    s_waitcnt lgkmcnt(2)
    v_cvt_pk_bf16_f32 v249, v30, v31
    v_add_f32 v26, v26, v32
    v_mfma_f32_16x16x32_bf16 v[96:99], a[200:203], v[128:131], v[96:99]
    ds_read_b128 a[216:219], v8 offset:18432
    v_add_f32 v26, v26, v33
    v_mfma_f32_16x16x32_bf16 v[104:107], a[200:203], v[132:135], v[104:107]
    s_cmp_eq_u32 s54, 3
    v_exp_f32 v34, v182
    v_mfma_f32_16x16x32_bf16 v[112:115], a[200:203], v[136:139], v[112:115]
    s_cselect_b32 s52, s55, 24576
    v_exp_f32 v35, v183
    v_mfma_f32_16x16x32_bf16 v[120:123], a[200:203], v[140:143], v[120:123]
    s_cselect_b32 s54, 0, s54
    v_cvt_pk_bf16_f32 v250, v32, v33
    v_add_f32 v26, v26, v34
    v_mfma_f32_16x16x32_bf16 v[96:99], a[204:207], v[144:147], v[96:99]
    s_add_u32 m0, s48, 12288
    ds_read_b128 a[220:223], v9 offset:18432
    v_add_f32 v26, v26, v35
    v_mfma_f32_16x16x32_bf16 v[104:107], a[204:207], v[148:151], v[104:107]
    buffer_load_dwordx4 v1, s[32:35], s45 offen offset:0 nt lds
    v_mfma_f32_16x16x32_bf16 v[112:115], a[204:207], v[152:155], v[112:115]
    v_exp_f32 v28, v184
    v_mfma_f32_16x16x32_bf16 v[120:123], a[204:207], v[156:159], v[120:123]
    s_waitcnt lgkmcnt(2)
    v_exp_f32 v29, v185
    v_mfma_f32_16x16x32_bf16 v[96:99], a[208:211], v[192:195], v[96:99]
    ds_read_b128 a[192:195], v8 offset:18560
    v_cvt_pk_bf16_f32 v251, v34, v35
    v_mfma_f32_16x16x32_bf16 v[104:107], a[208:211], v[196:199], v[104:107]
    v_add_f32 v27, v28, v29
    v_cvt_pk_bf16_f32 v252, v28, v29
    v_mfma_f32_16x16x32_bf16 v[112:115], a[208:211], v[200:203], v[112:115]
    v_exp_f32 v30, v186
    v_mfma_f32_16x16x32_bf16 v[120:123], a[208:211], v[204:207], v[120:123]
    v_exp_f32 v31, v187
    v_mfma_f32_16x16x32_bf16 v[96:99], a[212:215], v[208:211], v[96:99]
    ds_read_b128 a[196:199], v9 offset:18560
    v_add_f32 v27, v27, v30
    v_mfma_f32_16x16x32_bf16 v[104:107], a[212:215], v[212:215], v[104:107]
    v_add_f32 v27, v27, v31
    v_cvt_pk_bf16_f32 v253, v30, v31
    v_mfma_f32_16x16x32_bf16 v[112:115], a[212:215], v[216:219], v[112:115]
    v_exp_f32 v32, v188
    v_mfma_f32_16x16x32_bf16 v[120:123], a[212:215], v[220:223], v[120:123]
    s_waitcnt lgkmcnt(2)
    v_exp_f32 v33, v189
    v_mfma_f32_16x16x32_bf16 v[100:103], a[216:219], v[64:67], v[224:227]
    s_add_u32 m0, s48, 16384
    ds_read_b128 a[200:203], v8 offset:18688
    v_add_f32 v27, v27, v32
    v_mfma_f32_16x16x32_bf16 v[108:111], a[216:219], v[68:71], v[228:231]
    buffer_load_dwordx4 v2, s[32:35], s45 offen offset:0 nt lds
    v_mfma_f32_16x16x32_bf16 v[116:119], a[216:219], v[72:75], v[232:235]
    v_add_f32 v27, v27, v33
    v_cvt_pk_bf16_f32 v254, v32, v33
    v_mfma_f32_16x16x32_bf16 v[124:127], a[216:219], v[76:79], v[236:239]
    v_exp_f32 v34, v190
    v_mfma_f32_16x16x32_bf16 v[100:103], a[220:223], v[80:83], v[100:103]
    ds_read_b128 a[204:207], v9 offset:18688
    v_add_f32 v27, v27, v34
    v_mfma_f32_16x16x32_bf16 v[108:111], a[220:223], v[84:87], v[108:111]
    v_exp_f32 v35, v191
    v_mfma_f32_16x16x32_bf16 v[116:119], a[220:223], v[88:91], v[116:119]
    v_add_f32 v27, v27, v35
    v_cvt_pk_bf16_f32 v255, v34, v35
    v_mfma_f32_16x16x32_bf16 v[124:127], a[220:223], v[92:95], v[124:127]
    s_waitcnt lgkmcnt(2)
    v_max3_f32 v19, v24, v25, v26
    v_max_f32 v19, v19, v27
    v_mfma_f32_16x16x32_bf16 v[100:103], a[192:195], v[128:131], v[100:103]
    ds_read_b64_tr_b16 a[208:209], v4 offset:12288
    ds_read_b64_tr_b16 a[210:211], v4 offset:18432
    v_mfma_f32_16x16x32_bf16 v[108:111], a[192:195], v[132:135], v[108:111]
    v_cmp_lt_f32 vcc, s43, v19
    v_mfma_f32_16x16x32_bf16 v[116:119], a[192:195], v[136:139], v[116:119]
    v_mfma_f32_16x16x32_bf16 v[124:127], a[192:195], v[140:143], v[124:127]
    v_mfma_f32_16x16x32_bf16 v[100:103], a[196:199], v[144:147], v[100:103]
    s_add_u32 m0, s48, 20480
    ds_read_b64_tr_b16 a[212:213], v5 offset:12288
    ds_read_b64_tr_b16 a[214:215], v5 offset:18432
    v_mfma_f32_16x16x32_bf16 v[108:111], a[196:199], v[148:151], v[108:111]
    buffer_load_dwordx4 v3, s[32:35], s45 offen offset:0 nt lds
    v_mfma_f32_16x16x32_bf16 v[116:119], a[196:199], v[152:155], v[116:119]
    v_mfma_f32_16x16x32_bf16 v[124:127], a[196:199], v[156:159], v[124:127]
    s_waitcnt lgkmcnt(4)
    v_mfma_f32_16x16x32_bf16 v[100:103], a[200:203], v[192:195], v[100:103]
    ds_read_b64_tr_b16 a[216:217], v6 offset:12288
    ds_read_b64_tr_b16 a[218:219], v6 offset:18432
    v_mfma_f32_16x16x32_bf16 v[108:111], a[200:203], v[196:199], v[108:111]
    v_mfma_f32_16x16x32_bf16 v[116:119], a[200:203], v[200:203], v[116:119]
    v_mfma_f32_16x16x32_bf16 v[124:127], a[200:203], v[204:207], v[124:127]
    v_mfma_f32_16x16x32_bf16 v[100:103], a[204:207], v[208:211], v[100:103]
    ds_read_b64_tr_b16 a[220:221], v7 offset:12288
    ds_read_b64_tr_b16 a[222:223], v7 offset:18432
    v_mfma_f32_16x16x32_bf16 v[108:111], a[204:207], v[212:215], v[108:111]
    v_mfma_f32_16x16x32_bf16 v[116:119], a[204:207], v[216:219], v[116:119]
    v_mfma_f32_16x16x32_bf16 v[124:127], a[204:207], v[220:223], v[124:127]
    s_waitcnt lgkmcnt(4)
    s_cbranch_vccnz RA_O
RA_RET_O:
    v_add_f32 v20, v20, v24
    v_mfma_f32_16x16x32_bf16 a[0:3], a[208:211], v[240:243], a[0:3]
    ds_read_b64_tr_b16 a[192:193], v4 offset:12416
    ds_read_b64_tr_b16 a[194:195], v4 offset:18560
    v_mfma_f32_16x16x32_bf16 a[8:11], a[208:211], v[244:247], a[8:11]
    s_waitcnt vmcnt(15)
    s_barrier
    v_add_f32 v21, v21, v25
    v_mfma_f32_16x16x32_bf16 a[16:19], a[208:211], v[248:251], a[16:19]
    v_add_u32 v8, s52, v8
    v_add_u32 v9, s52, v9
    v_mfma_f32_16x16x32_bf16 a[24:27], a[208:211], v[252:255], a[24:27]
    v_add_f32 v22, v22, v26
    v_add_f32 v23, v23, v27
    v_mfma_f32_16x16x32_bf16 a[4:7], a[212:215], v[240:243], a[4:7]
    ds_read_b64_tr_b16 a[196:197], v5 offset:12416
    ds_read_b64_tr_b16 a[198:199], v5 offset:18560
    v_mfma_f32_16x16x32_bf16 a[12:15], a[212:215], v[244:247], a[12:15]
    v_exp_f32 v28, v96
    v_mfma_f32_16x16x32_bf16 a[20:23], a[212:215], v[248:251], a[20:23]
    v_exp_f32 v29, v97
    v_mfma_f32_16x16x32_bf16 a[28:31], a[212:215], v[252:255], a[28:31]
    s_waitcnt lgkmcnt(4)
    s_add_u32 s45, s45, 12288
    v_add_f32 v24, v28, v29
    v_mfma_f32_16x16x32_bf16 a[32:35], a[216:219], v[240:243], a[32:35]
    s_add_u32 m0, s48, 98304
    ds_read_b64_tr_b16 a[200:201], v6 offset:12416
    ds_read_b64_tr_b16 a[202:203], v6 offset:18560
    v_mfma_f32_16x16x32_bf16 a[40:43], a[216:219], v[244:247], a[40:43]
    buffer_load_dwordx4 v1, s[28:31], s45 offen offset:0 nt lds
    v_mfma_f32_16x16x32_bf16 a[48:51], a[216:219], v[248:251], a[48:51]
    v_exp_f32 v30, v98
    v_mfma_f32_16x16x32_bf16 a[56:59], a[216:219], v[252:255], a[56:59]
    v_exp_f32 v31, v99
    v_mfma_f32_16x16x32_bf16 a[36:39], a[220:223], v[240:243], a[36:39]
    ds_read_b64_tr_b16 a[204:205], v7 offset:12416
    ds_read_b64_tr_b16 a[206:207], v7 offset:18560
    v_mfma_f32_16x16x32_bf16 a[44:47], a[220:223], v[244:247], a[44:47]
    v_cvt_pk_bf16_f32 v48, v28, v29
    v_add_f32 v24, v24, v30
    v_mfma_f32_16x16x32_bf16 a[52:55], a[220:223], v[248:251], a[52:55]
    v_exp_f32 v32, v100
    v_mfma_f32_16x16x32_bf16 a[60:63], a[220:223], v[252:255], a[60:63]
    s_waitcnt lgkmcnt(4)
    v_exp_f32 v33, v101
    v_mfma_f32_16x16x32_bf16 a[64:67], a[192:195], v[240:243], a[64:67]
    ds_read_b64_tr_b16 a[208:209], v4 offset:12544
    ds_read_b64_tr_b16 a[210:211], v4 offset:18688
    v_mfma_f32_16x16x32_bf16 a[72:75], a[192:195], v[244:247], a[72:75]
    v_add_f32 v24, v24, v31
    v_cvt_pk_bf16_f32 v49, v30, v31
    v_mfma_f32_16x16x32_bf16 a[80:83], a[192:195], v[248:251], a[80:83]
    v_exp_f32 v34, v102
    v_mfma_f32_16x16x32_bf16 a[88:91], a[192:195], v[252:255], a[88:91]
    v_exp_f32 v35, v103
    v_mfma_f32_16x16x32_bf16 a[68:71], a[196:199], v[240:243], a[68:71]
    s_add_u32 m0, s48, 102400
    ds_read_b64_tr_b16 a[212:213], v5 offset:12544
    ds_read_b64_tr_b16 a[214:215], v5 offset:18688
    v_mfma_f32_16x16x32_bf16 a[76:79], a[196:199], v[244:247], a[76:79]
    buffer_load_dwordx4 v2, s[28:31], s45 offen offset:0 nt lds
    v_mfma_f32_16x16x32_bf16 a[84:87], a[196:199], v[248:251], a[84:87]
    v_add_f32 v24, v24, v32
    v_add_f32 v24, v24, v33
    v_mfma_f32_16x16x32_bf16 a[92:95], a[196:199], v[252:255], a[92:95]
    s_waitcnt lgkmcnt(4)
    v_cvt_pk_bf16_f32 v50, v32, v33
    v_add_f32 v24, v24, v34
    v_mfma_f32_16x16x32_bf16 a[96:99], a[200:203], v[240:243], a[96:99]
    ds_read_b64_tr_b16 a[216:217], v6 offset:12544
    ds_read_b64_tr_b16 a[218:219], v6 offset:18688
    v_mfma_f32_16x16x32_bf16 a[104:107], a[200:203], v[244:247], a[104:107]
    v_exp_f32 v28, v104
    v_mfma_f32_16x16x32_bf16 a[112:115], a[200:203], v[248:251], a[112:115]
    v_exp_f32 v29, v105
    v_mfma_f32_16x16x32_bf16 a[120:123], a[200:203], v[252:255], a[120:123]
    v_add_f32 v24, v24, v35
    v_cvt_pk_bf16_f32 v51, v34, v35
    v_mfma_f32_16x16x32_bf16 a[100:103], a[204:207], v[240:243], a[100:103]
    ds_read_b64_tr_b16 a[220:221], v7 offset:12544
    ds_read_b64_tr_b16 a[222:223], v7 offset:18688
    v_mfma_f32_16x16x32_bf16 a[108:111], a[204:207], v[244:247], a[108:111]
    v_exp_f32 v30, v106
    v_mfma_f32_16x16x32_bf16 a[116:119], a[204:207], v[248:251], a[116:119]
    v_exp_f32 v31, v107
    v_mfma_f32_16x16x32_bf16 a[124:127], a[204:207], v[252:255], a[124:127]
    s_waitcnt lgkmcnt(4)
    v_add_f32 v25, v28, v29
    v_cvt_pk_bf16_f32 v52, v28, v29
    v_mfma_f32_16x16x32_bf16 a[128:131], a[208:211], v[240:243], a[128:131]
    ds_read_b128 a[192:195], v8 offset:0
    v_add_f32 v25, v25, v30
    v_mfma_f32_16x16x32_bf16 a[136:139], a[208:211], v[244:247], a[136:139]
    v_exp_f32 v32, v108
    v_mfma_f32_16x16x32_bf16 a[144:147], a[208:211], v[248:251], a[144:147]
    v_exp_f32 v33, v109
    v_mfma_f32_16x16x32_bf16 a[152:155], a[208:211], v[252:255], a[152:155]
    v_add_f32 v25, v25, v31
    v_cvt_pk_bf16_f32 v53, v30, v31
    v_mfma_f32_16x16x32_bf16 a[132:135], a[212:215], v[240:243], a[132:135]
    s_add_u32 m0, s48, 106496
    ds_read_b128 a[196:199], v9 offset:0
    v_add_f32 v25, v25, v32
    v_mfma_f32_16x16x32_bf16 a[140:143], a[212:215], v[244:247], a[140:143]
    buffer_load_dwordx4 v3, s[28:31], s45 offen offset:0 nt lds
    v_mfma_f32_16x16x32_bf16 a[148:151], a[212:215], v[248:251], a[148:151]
    v_add_u32 v4, s52, v4
    v_add_u32 v5, s52, v5
    v_mfma_f32_16x16x32_bf16 a[156:159], a[212:215], v[252:255], a[156:159]
    s_waitcnt lgkmcnt(2)
    v_exp_f32 v34, v110
    v_mfma_f32_16x16x32_bf16 a[160:163], a[216:219], v[240:243], a[160:163]
    ds_read_b128 a[200:203], v8 offset:128
    v_add_f32 v25, v25, v33
    v_mfma_f32_16x16x32_bf16 a[168:171], a[216:219], v[244:247], a[168:171]
    v_exp_f32 v35, v111
    v_mfma_f32_16x16x32_bf16 a[176:179], a[216:219], v[248:251], a[176:179]
    v_add_u32 v6, s52, v6
    v_add_u32 v7, s52, v7
    v_mfma_f32_16x16x32_bf16 a[184:187], a[216:219], v[252:255], a[184:187]
    v_cvt_pk_bf16_f32 v54, v32, v33
    v_add_f32 v25, v25, v34
    v_mfma_f32_16x16x32_bf16 a[164:167], a[220:223], v[240:243], a[164:167]
    ds_read_b128 a[204:207], v9 offset:128
    v_add_f32 v25, v25, v35
    v_mfma_f32_16x16x32_bf16 a[172:175], a[220:223], v[244:247], a[172:175]
    s_mov_b32 s48, s47
    v_exp_f32 v28, v112
    v_mfma_f32_16x16x32_bf16 a[180:183], a[220:223], v[248:251], a[180:183]
    s_add_u32 s47, s47, s52
    v_exp_f32 v29, v113
    v_mfma_f32_16x16x32_bf16 a[188:191], a[220:223], v[252:255], a[188:191]
    s_waitcnt lgkmcnt(2)
    v_cvt_pk_bf16_f32 v55, v34, v35
    v_mfma_f32_16x16x32_bf16 v[160:163], a[192:195], v[64:67], v[224:227]
    ds_read_b128 a[208:211], v8 offset:256
    v_add_f32 v26, v28, v29
    v_mfma_f32_16x16x32_bf16 v[168:171], a[192:195], v[68:71], v[228:231]
    v_exp_f32 v30, v114
    v_mfma_f32_16x16x32_bf16 v[176:179], a[192:195], v[72:75], v[232:235]
    v_exp_f32 v31, v115
    v_mfma_f32_16x16x32_bf16 v[184:187], a[192:195], v[76:79], v[236:239]
    v_cvt_pk_bf16_f32 v56, v28, v29
    v_add_f32 v26, v26, v30
    v_mfma_f32_16x16x32_bf16 v[160:163], a[196:199], v[80:83], v[160:163]
    ds_read_b128 a[212:215], v9 offset:256
    v_add_f32 v26, v26, v31
    v_mfma_f32_16x16x32_bf16 v[168:171], a[196:199], v[84:87], v[168:171]
    v_exp_f32 v32, v116
    v_mfma_f32_16x16x32_bf16 v[176:179], a[196:199], v[88:91], v[176:179]
    v_exp_f32 v33, v117
    v_mfma_f32_16x16x32_bf16 v[184:187], a[196:199], v[92:95], v[184:187]
    s_waitcnt lgkmcnt(2)
    v_cvt_pk_bf16_f32 v57, v30, v31
    v_add_f32 v26, v26, v32
    v_mfma_f32_16x16x32_bf16 v[160:163], a[200:203], v[128:131], v[160:163]
    ds_read_b128 a[216:219], v8 offset:6144
    v_add_f32 v26, v26, v33
    v_mfma_f32_16x16x32_bf16 v[168:171], a[200:203], v[132:135], v[168:171]
    v_exp_f32 v34, v118
    v_mfma_f32_16x16x32_bf16 v[176:179], a[200:203], v[136:139], v[176:179]
    v_exp_f32 v35, v119
    v_mfma_f32_16x16x32_bf16 v[184:187], a[200:203], v[140:143], v[184:187]
    v_cvt_pk_bf16_f32 v58, v32, v33
    v_add_f32 v26, v26, v34
    v_mfma_f32_16x16x32_bf16 v[160:163], a[204:207], v[144:147], v[160:163]
    s_add_u32 m0, s48, 0
    ds_read_b128 a[220:223], v9 offset:6144
    v_add_f32 v26, v26, v35
    v_mfma_f32_16x16x32_bf16 v[168:171], a[204:207], v[148:151], v[168:171]
    buffer_load_dwordx4 v1, s[32:35], s45 offen offset:0 nt lds
    v_mfma_f32_16x16x32_bf16 v[176:179], a[204:207], v[152:155], v[176:179]
    v_exp_f32 v28, v120
    v_mfma_f32_16x16x32_bf16 v[184:187], a[204:207], v[156:159], v[184:187]
    s_waitcnt lgkmcnt(2)
    v_exp_f32 v29, v121
    v_mfma_f32_16x16x32_bf16 v[160:163], a[208:211], v[192:195], v[160:163]
    ds_read_b128 a[192:195], v8 offset:6272
    v_cvt_pk_bf16_f32 v59, v34, v35
    v_mfma_f32_16x16x32_bf16 v[168:171], a[208:211], v[196:199], v[168:171]
    v_add_f32 v27, v28, v29
    v_cvt_pk_bf16_f32 v60, v28, v29
    v_mfma_f32_16x16x32_bf16 v[176:179], a[208:211], v[200:203], v[176:179]
    v_exp_f32 v30, v122
    v_mfma_f32_16x16x32_bf16 v[184:187], a[208:211], v[204:207], v[184:187]
    v_exp_f32 v31, v123
    v_mfma_f32_16x16x32_bf16 v[160:163], a[212:215], v[208:211], v[160:163]
    ds_read_b128 a[196:199], v9 offset:6272
    v_add_f32 v27, v27, v30
    v_mfma_f32_16x16x32_bf16 v[168:171], a[212:215], v[212:215], v[168:171]
    v_add_f32 v27, v27, v31
    v_cvt_pk_bf16_f32 v61, v30, v31
    v_mfma_f32_16x16x32_bf16 v[176:179], a[212:215], v[216:219], v[176:179]
    v_exp_f32 v32, v124
    v_mfma_f32_16x16x32_bf16 v[184:187], a[212:215], v[220:223], v[184:187]
    s_waitcnt lgkmcnt(2)
    v_exp_f32 v33, v125
    v_mfma_f32_16x16x32_bf16 v[164:167], a[216:219], v[64:67], v[224:227]
    s_add_u32 m0, s48, 4096
    ds_read_b128 a[200:203], v8 offset:6400
    v_add_f32 v27, v27, v32
    v_mfma_f32_16x16x32_bf16 v[172:175], a[216:219], v[68:71], v[228:231]
    buffer_load_dwordx4 v2, s[32:35], s45 offen offset:0 nt lds
    v_mfma_f32_16x16x32_bf16 v[180:183], a[216:219], v[72:75], v[232:235]
    v_add_f32 v27, v27, v33
    v_cvt_pk_bf16_f32 v62, v32, v33
    v_mfma_f32_16x16x32_bf16 v[188:191], a[216:219], v[76:79], v[236:239]
    v_exp_f32 v34, v126
    v_mfma_f32_16x16x32_bf16 v[164:167], a[220:223], v[80:83], v[164:167]
    ds_read_b128 a[204:207], v9 offset:6400
    v_add_f32 v27, v27, v34
    v_mfma_f32_16x16x32_bf16 v[172:175], a[220:223], v[84:87], v[172:175]
    v_exp_f32 v35, v127
    v_mfma_f32_16x16x32_bf16 v[180:183], a[220:223], v[88:91], v[180:183]
    v_add_f32 v27, v27, v35
    v_cvt_pk_bf16_f32 v63, v34, v35
    v_mfma_f32_16x16x32_bf16 v[188:191], a[220:223], v[92:95], v[188:191]
    s_waitcnt lgkmcnt(2)
    v_max3_f32 v19, v24, v25, v26
    v_max_f32 v19, v19, v27
    v_mfma_f32_16x16x32_bf16 v[164:167], a[192:195], v[128:131], v[164:167]
    ds_read_b64_tr_b16 a[208:209], v4 offset:0
    ds_read_b64_tr_b16 a[210:211], v4 offset:6144
    v_mfma_f32_16x16x32_bf16 v[172:175], a[192:195], v[132:135], v[172:175]
    v_cmp_lt_f32 vcc, s43, v19
    v_mfma_f32_16x16x32_bf16 v[180:183], a[192:195], v[136:139], v[180:183]
    v_mfma_f32_16x16x32_bf16 v[188:191], a[192:195], v[140:143], v[188:191]
    v_mfma_f32_16x16x32_bf16 v[164:167], a[196:199], v[144:147], v[164:167]
    s_add_u32 m0, s48, 8192
    ds_read_b64_tr_b16 a[212:213], v5 offset:0
    ds_read_b64_tr_b16 a[214:215], v5 offset:6144
    v_mfma_f32_16x16x32_bf16 v[172:175], a[196:199], v[148:151], v[172:175]
    buffer_load_dwordx4 v3, s[32:35], s45 offen offset:0 nt lds
    v_mfma_f32_16x16x32_bf16 v[180:183], a[196:199], v[152:155], v[180:183]
    v_mfma_f32_16x16x32_bf16 v[188:191], a[196:199], v[156:159], v[188:191]
    s_waitcnt lgkmcnt(4)
    v_mfma_f32_16x16x32_bf16 v[164:167], a[200:203], v[192:195], v[164:167]
    ds_read_b64_tr_b16 a[216:217], v6 offset:0
    ds_read_b64_tr_b16 a[218:219], v6 offset:6144
    v_mfma_f32_16x16x32_bf16 v[172:175], a[200:203], v[196:199], v[172:175]
    v_mfma_f32_16x16x32_bf16 v[180:183], a[200:203], v[200:203], v[180:183]
    v_mfma_f32_16x16x32_bf16 v[188:191], a[200:203], v[204:207], v[188:191]
    v_mfma_f32_16x16x32_bf16 v[164:167], a[204:207], v[208:211], v[164:167]
    ds_read_b64_tr_b16 a[220:221], v7 offset:0
    ds_read_b64_tr_b16 a[222:223], v7 offset:6144
    v_mfma_f32_16x16x32_bf16 v[172:175], a[204:207], v[212:215], v[172:175]
    v_mfma_f32_16x16x32_bf16 v[180:183], a[204:207], v[216:219], v[180:183]
    v_mfma_f32_16x16x32_bf16 v[188:191], a[204:207], v[220:223], v[188:191]
    s_waitcnt lgkmcnt(4)
    s_cbranch_vccnz RA_E
RA_RET_E:
    v_add_f32 v20, v20, v24
    v_mfma_f32_16x16x32_bf16 a[0:3], a[208:211], v[48:51], a[0:3]
    ds_read_b64_tr_b16 a[192:193], v4 offset:128
    ds_read_b64_tr_b16 a[194:195], v4 offset:6272
    v_mfma_f32_16x16x32_bf16 a[8:11], a[208:211], v[52:55], a[8:11]
    s_waitcnt vmcnt(15)
    s_barrier
    v_add_f32 v21, v21, v25
    v_mfma_f32_16x16x32_bf16 a[16:19], a[208:211], v[56:59], a[16:19]
    buffer_load_dword v47, v46, s[8:11], s4 offen
    v_mfma_f32_16x16x32_bf16 a[24:27], a[208:211], v[60:63], a[24:27]
    v_add_f32 v22, v22, v26
    v_add_f32 v23, v23, v27
    v_mfma_f32_16x16x32_bf16 a[4:7], a[212:215], v[48:51], a[4:7]
    ds_read_b64_tr_b16 a[196:197], v5 offset:128
    ds_read_b64_tr_b16 a[198:199], v5 offset:6272
    v_mfma_f32_16x16x32_bf16 a[12:15], a[212:215], v[52:55], a[12:15]
    s_add_u32 s4, s4, 1048576
    v_exp_f32 v28, v160
    v_mfma_f32_16x16x32_bf16 a[20:23], a[212:215], v[56:59], a[20:23]
    v_exp_f32 v29, v161
    v_mfma_f32_16x16x32_bf16 a[28:31], a[212:215], v[60:63], a[28:31]
    s_waitcnt lgkmcnt(4)
    s_add_u32 s45, s45, 12288
    v_add_f32 v24, v28, v29
    v_mfma_f32_16x16x32_bf16 a[32:35], a[216:219], v[48:51], a[32:35]
    s_add_u32 m0, s48, 86016
    ds_read_b64_tr_b16 a[200:201], v6 offset:128
    ds_read_b64_tr_b16 a[202:203], v6 offset:6272
    v_mfma_f32_16x16x32_bf16 a[40:43], a[216:219], v[52:55], a[40:43]
    buffer_load_dwordx4 v1, s[28:31], s45 offen offset:0 nt lds
    v_mfma_f32_16x16x32_bf16 a[48:51], a[216:219], v[56:59], a[48:51]
    v_exp_f32 v30, v162
    v_mfma_f32_16x16x32_bf16 a[56:59], a[216:219], v[60:63], a[56:59]
    v_exp_f32 v31, v163
    v_mfma_f32_16x16x32_bf16 a[36:39], a[220:223], v[48:51], a[36:39]
    ds_read_b64_tr_b16 a[204:205], v7 offset:128
    ds_read_b64_tr_b16 a[206:207], v7 offset:6272
    v_mfma_f32_16x16x32_bf16 a[44:47], a[220:223], v[52:55], a[44:47]
    v_cvt_pk_bf16_f32 v240, v28, v29
    v_add_f32 v24, v24, v30
    v_mfma_f32_16x16x32_bf16 a[52:55], a[220:223], v[56:59], a[52:55]
    v_exp_f32 v32, v164
    v_mfma_f32_16x16x32_bf16 a[60:63], a[220:223], v[60:63], a[60:63]
    s_waitcnt lgkmcnt(4)
    v_exp_f32 v33, v165
    v_mfma_f32_16x16x32_bf16 a[64:67], a[192:195], v[48:51], a[64:67]
    ds_read_b64_tr_b16 a[208:209], v4 offset:256
    ds_read_b64_tr_b16 a[210:211], v4 offset:6400
    v_mfma_f32_16x16x32_bf16 a[72:75], a[192:195], v[52:55], a[72:75]
    v_add_f32 v24, v24, v31
    v_cvt_pk_bf16_f32 v241, v30, v31
    v_mfma_f32_16x16x32_bf16 a[80:83], a[192:195], v[56:59], a[80:83]
    v_exp_f32 v34, v166
    v_mfma_f32_16x16x32_bf16 a[88:91], a[192:195], v[60:63], a[88:91]
    v_exp_f32 v35, v167
    v_mfma_f32_16x16x32_bf16 a[68:71], a[196:199], v[48:51], a[68:71]
    s_add_u32 m0, s48, 90112
    ds_read_b64_tr_b16 a[212:213], v5 offset:256
    ds_read_b64_tr_b16 a[214:215], v5 offset:6400
    v_mfma_f32_16x16x32_bf16 a[76:79], a[196:199], v[52:55], a[76:79]
    buffer_load_dwordx4 v2, s[28:31], s45 offen offset:0 nt lds
    v_mfma_f32_16x16x32_bf16 a[84:87], a[196:199], v[56:59], a[84:87]
    v_add_f32 v24, v24, v32
    v_add_f32 v24, v24, v33
    v_mfma_f32_16x16x32_bf16 a[92:95], a[196:199], v[60:63], a[92:95]
    s_waitcnt lgkmcnt(4)
    v_cvt_pk_bf16_f32 v242, v32, v33
    v_add_f32 v24, v24, v34
    v_mfma_f32_16x16x32_bf16 a[96:99], a[200:203], v[48:51], a[96:99]
    ds_read_b64_tr_b16 a[216:217], v6 offset:256
    ds_read_b64_tr_b16 a[218:219], v6 offset:6400
    v_mfma_f32_16x16x32_bf16 a[104:107], a[200:203], v[52:55], a[104:107]
    v_exp_f32 v28, v168
    v_mfma_f32_16x16x32_bf16 a[112:115], a[200:203], v[56:59], a[112:115]
    v_exp_f32 v29, v169
    v_mfma_f32_16x16x32_bf16 a[120:123], a[200:203], v[60:63], a[120:123]
    v_add_f32 v24, v24, v35
    v_cvt_pk_bf16_f32 v243, v34, v35
    v_mfma_f32_16x16x32_bf16 a[100:103], a[204:207], v[48:51], a[100:103]
    ds_read_b64_tr_b16 a[220:221], v7 offset:256
    ds_read_b64_tr_b16 a[222:223], v7 offset:6400
    v_mfma_f32_16x16x32_bf16 a[108:111], a[204:207], v[52:55], a[108:111]
    v_exp_f32 v30, v170
    v_mfma_f32_16x16x32_bf16 a[116:119], a[204:207], v[56:59], a[116:119]
    v_exp_f32 v31, v171
    v_mfma_f32_16x16x32_bf16 a[124:127], a[204:207], v[60:63], a[124:127]
    s_waitcnt lgkmcnt(4)
    v_add_f32 v25, v28, v29
    v_cvt_pk_bf16_f32 v244, v28, v29
    v_mfma_f32_16x16x32_bf16 a[128:131], a[208:211], v[48:51], a[128:131]
    ds_read_b128 a[192:195], v8 offset:12288
    v_add_f32 v25, v25, v30
    v_mfma_f32_16x16x32_bf16 a[136:139], a[208:211], v[52:55], a[136:139]
    v_exp_f32 v32, v172
    v_mfma_f32_16x16x32_bf16 a[144:147], a[208:211], v[56:59], a[144:147]
    v_exp_f32 v33, v173
    v_mfma_f32_16x16x32_bf16 a[152:155], a[208:211], v[60:63], a[152:155]
    v_add_f32 v25, v25, v31
    v_cvt_pk_bf16_f32 v245, v30, v31
    v_mfma_f32_16x16x32_bf16 a[132:135], a[212:215], v[48:51], a[132:135]
    s_add_u32 m0, s48, 94208
    ds_read_b128 a[196:199], v9 offset:12288
    v_add_f32 v25, v25, v32
    v_mfma_f32_16x16x32_bf16 a[140:143], a[212:215], v[52:55], a[140:143]
    buffer_load_dwordx4 v3, s[28:31], s45 offen offset:0 nt lds
    v_mfma_f32_16x16x32_bf16 a[148:151], a[212:215], v[56:59], a[148:151]
    v_mfma_f32_16x16x32_bf16 a[156:159], a[212:215], v[60:63], a[156:159]
    s_waitcnt lgkmcnt(2)
    v_exp_f32 v34, v174
    v_mfma_f32_16x16x32_bf16 a[160:163], a[216:219], v[48:51], a[160:163]
    ds_read_b128 a[200:203], v8 offset:12416
    v_add_f32 v25, v25, v33
    v_mfma_f32_16x16x32_bf16 a[168:171], a[216:219], v[52:55], a[168:171]
    v_exp_f32 v35, v175
    v_mfma_f32_16x16x32_bf16 a[176:179], a[216:219], v[56:59], a[176:179]
    v_mfma_f32_16x16x32_bf16 a[184:187], a[216:219], v[60:63], a[184:187]
    v_cvt_pk_bf16_f32 v246, v32, v33
    v_add_f32 v25, v25, v34
    v_mfma_f32_16x16x32_bf16 a[164:167], a[220:223], v[48:51], a[164:167]
    ds_read_b128 a[204:207], v9 offset:12416
    v_add_f32 v25, v25, v35
    v_mfma_f32_16x16x32_bf16 a[172:175], a[220:223], v[52:55], a[172:175]
    s_add_u32 s49, s49, 1
    v_exp_f32 v28, v176
    v_mfma_f32_16x16x32_bf16 a[180:183], a[220:223], v[56:59], a[180:183]
    s_cmp_lg_u32 s49, 15
    v_exp_f32 v29, v177
    v_mfma_f32_16x16x32_bf16 a[188:191], a[220:223], v[60:63], a[188:191]
    s_waitcnt lgkmcnt(2)
    v_cvt_pk_bf16_f32 v247, v34, v35
    s_cbranch_scc1 K_LOOP
    v_mfma_f32_16x16x32_bf16 v[96:99], a[192:195], v[64:67], v[224:227]
    s_mul_i32 s47, s40, 5120
    s_lshr_b32 s42, s40, 1
    ds_read_b128 a[208:211], v8 offset:12544
    v_add_f32 v26, v28, v29
    v_mfma_f32_16x16x32_bf16 v[104:107], a[192:195], v[68:71], v[228:231]
    s_and_b32 s50, s101, 0
    s_add_u32 s44, s50, s42
    v_exp_f32 v30, v178
    v_mfma_f32_16x16x32_bf16 v[112:115], a[192:195], v[72:75], v[232:235]
    s_mul_i32 s42, s42, 40960
    s_lshl_b32 s44, s42, 2
    v_exp_f32 v31, v179
    v_mfma_f32_16x16x32_bf16 v[120:123], a[192:195], v[76:79], v[236:239]
    s_bfe_u32 s53, s101, 0x20001
    s_mul_i32 s53, s53, 320
    v_cvt_pk_bf16_f32 v248, v28, v29
    v_add_f32 v26, v26, v30
    v_mfma_f32_16x16x32_bf16 v[96:99], a[196:199], v[80:83], v[96:99]
    s_add_u32 s20, s8, s53
    s_addc_u32 s21, s9, 0
    ds_read_b128 a[212:215], v9 offset:12544
    v_add_f32 v26, v26, v31
    v_mfma_f32_16x16x32_bf16 v[104:107], a[196:199], v[84:87], v[104:107]
    s_sub_u32 s22, 1966080, s53
    s_mov_b32 s23, 0x20000
    v_exp_f32 v32, v180
    v_mfma_f32_16x16x32_bf16 v[112:115], a[196:199], v[88:91], v[112:115]
    s_lshr_b32 s3, s101, 3
    s_lshl_b32 s45, s100, 2
    v_exp_f32 v33, v181
    v_mfma_f32_16x16x32_bf16 v[120:123], a[196:199], v[92:95], v[120:123]
    s_waitcnt lgkmcnt(2)
    s_add_u32 s45, s45, s3
    v_cvt_pk_bf16_f32 v249, v30, v31
    v_add_f32 v26, v26, v32
    v_mfma_f32_16x16x32_bf16 v[96:99], a[200:203], v[128:131], v[96:99]
    s_lshl_b32 s45, s45, 10
    s_lshl_b32 s46, s100, 1
    ds_read_b128 a[216:219], v8 offset:18432
    v_add_f32 v26, v26, v33
    v_mfma_f32_16x16x32_bf16 v[104:107], a[200:203], v[132:135], v[104:107]
    s_and_b32 s53, s101, 1
    s_add_u32 s46, s46, s53
    v_exp_f32 v34, v182
    v_mfma_f32_16x16x32_bf16 v[112:115], a[200:203], v[136:139], v[112:115]
    s_lshl_b32 s46, s46, 2
    s_bfe_u32 s53, s101, 0x20001
    v_exp_f32 v35, v183
    v_mfma_f32_16x16x32_bf16 v[120:123], a[200:203], v[140:143], v[120:123]
    s_add_u32 s46, s46, s53
    s_lshl_b32 s46, s46, 9
    v_cvt_pk_bf16_f32 v250, v32, v33
    v_add_f32 v26, v26, v34
    v_mfma_f32_16x16x32_bf16 v[96:99], a[204:207], v[144:147], v[96:99]
    s_add_u32 s46, s46, 32768
    s_mov_b32 s48, s3
    ds_read_b128 a[220:223], v9 offset:18432
    v_add_f32 v26, v26, v35
    v_mfma_f32_16x16x32_bf16 v[104:107], a[204:207], v[148:151], v[104:107]
    s_lshl_b32 s3, s100, 1
    s_and_b32 s53, s101, 1
    s_add_u32 s3, s3, s53
    s_lshl_b32 s3, s3, 2
    v_mfma_f32_16x16x32_bf16 v[112:115], a[204:207], v[152:155], v[112:115]
    s_add_u32 s49, s3, s40
    s_mul_i32 s3, s49, 384
    v_exp_f32 v28, v184
    v_mfma_f32_16x16x32_bf16 v[120:123], a[204:207], v[156:159], v[120:123]
    s_waitcnt lgkmcnt(2)
    s_mul_i32 s53, s48, 96
    v_exp_f32 v29, v185
    v_mfma_f32_16x16x32_bf16 v[96:99], a[208:211], v[192:195], v[96:99]
    s_add_u32 s3, s3, s53
    s_lshl_b32 s3, s3, 10
    ds_read_b128 a[192:195], v8 offset:18560
    v_cvt_pk_bf16_f32 v251, v34, v35
    v_mfma_f32_16x16x32_bf16 v[104:107], a[208:211], v[196:199], v[104:107]
    s_add_u32 s24, s18, s3
    s_addc_u32 s25, s19, 0
    v_add_f32 v27, v28, v29
    v_cvt_pk_bf16_f32 v252, v28, v29
    v_mfma_f32_16x16x32_bf16 v[112:115], a[208:211], v[200:203], v[112:115]
    s_mov_b32 s26, 98304
    s_mov_b32 s27, 0x20000
    v_exp_f32 v30, v186
    v_mfma_f32_16x16x32_bf16 v[120:123], a[208:211], v[204:207], v[120:123]
    s_and_b32 s3, s101, 7
    s_lshl_b32 s3, s3, 2
    v_exp_f32 v31, v187
    v_mfma_f32_16x16x32_bf16 v[96:99], a[212:215], v[208:211], v[96:99]
    s_add_u32 s3, s3, s45
    ds_read_b128 a[196:199], v9 offset:18560
    v_add_f32 v27, v27, v30
    v_mov_b32 v1, s3
    v_mfma_f32_16x16x32_bf16 v[104:107], a[212:215], v[212:215], v[104:107]
    v_add_f32 v27, v27, v31
    v_cvt_pk_bf16_f32 v253, v30, v31
    v_not_b32 v2, s5
    v_mfma_f32_16x16x32_bf16 v[112:115], a[212:215], v[216:219], v[112:115]
    v_exp_f32 v32, v188
    v_bfe_u32 v3, v0, 3, 3
    v_mfma_f32_16x16x32_bf16 v[120:123], a[212:215], v[220:223], v[120:123]
    s_waitcnt lgkmcnt(2)
    v_exp_f32 v33, v189
    v_lshl_add_u32 v3, v3, 2, s45
    v_mfma_f32_16x16x32_bf16 v[100:103], a[216:219], v[64:67], v[224:227]
    ds_read_b128 a[200:203], v8 offset:18688
    v_add_f32 v27, v27, v32
    v_mfma_f32_16x16x32_bf16 v[108:111], a[216:219], v[68:71], v[228:231]
    v_mfma_f32_16x16x32_bf16 v[116:119], a[216:219], v[72:75], v[232:235]
    v_add_f32 v27, v27, v33
    v_cvt_pk_bf16_f32 v254, v32, v33
    v_mfma_f32_16x16x32_bf16 v[124:127], a[216:219], v[76:79], v[236:239]
    v_exp_f32 v34, v190
    v_mfma_f32_16x16x32_bf16 v[100:103], a[220:223], v[80:83], v[100:103]
    ds_read_b128 a[204:207], v9 offset:18688
    v_add_f32 v27, v27, v34
    v_mfma_f32_16x16x32_bf16 v[108:111], a[220:223], v[84:87], v[108:111]
    v_exp_f32 v35, v191
    v_mfma_f32_16x16x32_bf16 v[116:119], a[220:223], v[88:91], v[116:119]
    v_add_f32 v27, v27, v35
    v_cvt_pk_bf16_f32 v255, v34, v35
    v_mfma_f32_16x16x32_bf16 v[124:127], a[220:223], v[92:95], v[124:127]
    s_waitcnt lgkmcnt(2)
    v_max3_f32 v19, v24, v25, v26
    v_max_f32 v19, v19, v27
    v_mfma_f32_16x16x32_bf16 v[100:103], a[192:195], v[128:131], v[100:103]
    ds_read_b64_tr_b16 a[208:209], v4 offset:12288
    ds_read_b64_tr_b16 a[210:211], v4 offset:18432
    v_mfma_f32_16x16x32_bf16 v[108:111], a[192:195], v[132:135], v[108:111]
    v_cmp_lt_f32 vcc, s43, v19
    v_mfma_f32_16x16x32_bf16 v[116:119], a[192:195], v[136:139], v[116:119]
    v_mfma_f32_16x16x32_bf16 v[124:127], a[192:195], v[140:143], v[124:127]
    v_mfma_f32_16x16x32_bf16 v[100:103], a[196:199], v[144:147], v[100:103]
    ds_read_b64_tr_b16 a[212:213], v5 offset:12288
    ds_read_b64_tr_b16 a[214:215], v5 offset:18432
    v_mfma_f32_16x16x32_bf16 v[108:111], a[196:199], v[148:151], v[108:111]
    v_mfma_f32_16x16x32_bf16 v[116:119], a[196:199], v[152:155], v[116:119]
    v_mfma_f32_16x16x32_bf16 v[124:127], a[196:199], v[156:159], v[124:127]
    s_waitcnt lgkmcnt(4)
    v_mfma_f32_16x16x32_bf16 v[100:103], a[200:203], v[192:195], v[100:103]
    ds_read_b64_tr_b16 a[216:217], v6 offset:12288
    ds_read_b64_tr_b16 a[218:219], v6 offset:18432
    v_mfma_f32_16x16x32_bf16 v[108:111], a[200:203], v[196:199], v[108:111]
    v_mfma_f32_16x16x32_bf16 v[116:119], a[200:203], v[200:203], v[116:119]
    v_mfma_f32_16x16x32_bf16 v[124:127], a[200:203], v[204:207], v[124:127]
    v_mfma_f32_16x16x32_bf16 v[100:103], a[204:207], v[208:211], v[100:103]
    ds_read_b64_tr_b16 a[220:221], v7 offset:12288
    ds_read_b64_tr_b16 a[222:223], v7 offset:18432
    v_mfma_f32_16x16x32_bf16 v[108:111], a[204:207], v[212:215], v[108:111]
    v_mfma_f32_16x16x32_bf16 v[116:119], a[204:207], v[216:219], v[116:119]
    v_mfma_f32_16x16x32_bf16 v[124:127], a[204:207], v[220:223], v[124:127]
    s_waitcnt lgkmcnt(4)
    s_cbranch_vccnz RA_G
RA_RET_G:
    v_add_f32 v20, v20, v24
    v_mfma_f32_16x16x32_bf16 a[0:3], a[208:211], v[240:243], a[0:3]
    ds_read_b64_tr_b16 a[192:193], v4 offset:12416
    ds_read_b64_tr_b16 a[194:195], v4 offset:18560
    v_mfma_f32_16x16x32_bf16 a[8:11], a[208:211], v[244:247], a[8:11]
    s_waitcnt vmcnt(0)
    s_barrier
    v_add_f32 v21, v21, v25
    v_mfma_f32_16x16x32_bf16 a[16:19], a[208:211], v[248:251], a[16:19]
    v_add_u32 v8, s55, v8
    v_add_u32 v9, s55, v9
    v_mov_b32 v2, s5
    v_mfma_f32_16x16x32_bf16 a[24:27], a[208:211], v[252:255], a[24:27]
    global_load_dword v47, v36, s[56:57]
    v_add_f32 v22, v22, v26
    v_add_f32 v23, v23, v27
    v_mfma_f32_16x16x32_bf16 a[4:7], a[212:215], v[240:243], a[4:7]
    ds_read_b64_tr_b16 a[196:197], v5 offset:12416
    ds_read_b64_tr_b16 a[198:199], v5 offset:18560
    v_mfma_f32_16x16x32_bf16 a[12:15], a[212:215], v[244:247], a[12:15]
    v_exp_f32 v28, v96
    v_mfma_f32_16x16x32_bf16 a[20:23], a[212:215], v[248:251], a[20:23]
    s_add_u32 m0, s47, 102400
    s_add_u32 s53, s42, 0
    v_exp_f32 v29, v97
    v_mfma_f32_16x16x32_bf16 a[28:31], a[212:215], v[252:255], a[28:31]
    s_waitcnt lgkmcnt(4)
    buffer_load_dwordx4 v12, s[20:23], s53 offen offset:0 lds
    v_add_f32 v24, v28, v29
    v_mfma_f32_16x16x32_bf16 a[32:35], a[216:219], v[240:243], a[32:35]
    ds_read_b64_tr_b16 a[200:201], v6 offset:12416
    ds_read_b64_tr_b16 a[202:203], v6 offset:18560
    v_mfma_f32_16x16x32_bf16 a[40:43], a[216:219], v[244:247], a[40:43]
    v_mfma_f32_16x16x32_bf16 a[48:51], a[216:219], v[248:251], a[48:51]
    buffer_load_dwordx4 v13, s[20:23], s53 offen offset:1024 lds
    v_exp_f32 v30, v98
    v_mfma_f32_16x16x32_bf16 a[56:59], a[216:219], v[252:255], a[56:59]
    v_exp_f32 v31, v99
    v_mfma_f32_16x16x32_bf16 a[36:39], a[220:223], v[240:243], a[36:39]
    ds_read_b64_tr_b16 a[204:205], v7 offset:12416
    ds_read_b64_tr_b16 a[206:207], v7 offset:18560
    v_mfma_f32_16x16x32_bf16 a[44:47], a[220:223], v[244:247], a[44:47]
    buffer_load_dwordx4 v14, s[20:23], s53 offen offset:2048 lds
    v_cvt_pk_bf16_f32 v48, v28, v29
    v_add_f32 v24, v24, v30
    v_mfma_f32_16x16x32_bf16 a[52:55], a[220:223], v[248:251], a[52:55]
    v_exp_f32 v32, v100
    v_mfma_f32_16x16x32_bf16 a[60:63], a[220:223], v[252:255], a[60:63]
    s_waitcnt lgkmcnt(4)
    v_exp_f32 v33, v101
    v_mfma_f32_16x16x32_bf16 a[64:67], a[192:195], v[240:243], a[64:67]
    ds_read_b64_tr_b16 a[208:209], v4 offset:12544
    ds_read_b64_tr_b16 a[210:211], v4 offset:18688
    buffer_load_dwordx4 v15, s[20:23], s53 offen offset:3072 lds
    v_mfma_f32_16x16x32_bf16 a[72:75], a[192:195], v[244:247], a[72:75]
    v_add_f32 v24, v24, v31
    v_cvt_pk_bf16_f32 v49, v30, v31
    v_mfma_f32_16x16x32_bf16 a[80:83], a[192:195], v[248:251], a[80:83]
    v_exp_f32 v34, v102
    v_mfma_f32_16x16x32_bf16 a[88:91], a[192:195], v[252:255], a[88:91]
    s_add_u32 m0, s47, 106496
    s_nop 0
    buffer_load_dwordx4 v16, s[20:23], s53 offen offset:0 lds
    v_exp_f32 v35, v103
    v_mfma_f32_16x16x32_bf16 a[68:71], a[196:199], v[240:243], a[68:71]
    ds_read_b64_tr_b16 a[212:213], v5 offset:12544
    ds_read_b64_tr_b16 a[214:215], v5 offset:18688
    v_mfma_f32_16x16x32_bf16 a[76:79], a[196:199], v[244:247], a[76:79]
    v_mfma_f32_16x16x32_bf16 a[84:87], a[196:199], v[248:251], a[84:87]
    s_add_u32 m0, s47, 122880
    s_add_u32 s53, s44, 81920
    v_add_f32 v24, v24, v32
    v_add_f32 v24, v24, v33
    v_mfma_f32_16x16x32_bf16 a[92:95], a[196:199], v[252:255], a[92:95]
    s_waitcnt lgkmcnt(4)
    buffer_load_dwordx4 v12, s[20:23], s53 offen offset:0 lds
    v_cvt_pk_bf16_f32 v50, v32, v33
    v_add_f32 v24, v24, v34
    v_mfma_f32_16x16x32_bf16 a[96:99], a[200:203], v[240:243], a[96:99]
    ds_read_b64_tr_b16 a[216:217], v6 offset:12544
    ds_read_b64_tr_b16 a[218:219], v6 offset:18688
    v_mfma_f32_16x16x32_bf16 a[104:107], a[200:203], v[244:247], a[104:107]
    v_exp_f32 v28, v104
    v_mfma_f32_16x16x32_bf16 a[112:115], a[200:203], v[248:251], a[112:115]
    buffer_load_dwordx4 v13, s[20:23], s53 offen offset:1024 lds
    v_exp_f32 v29, v105
    v_mfma_f32_16x16x32_bf16 a[120:123], a[200:203], v[252:255], a[120:123]
    v_add_f32 v24, v24, v35
    v_cvt_pk_bf16_f32 v51, v34, v35
    v_mfma_f32_16x16x32_bf16 a[100:103], a[204:207], v[240:243], a[100:103]
    ds_read_b64_tr_b16 a[220:221], v7 offset:12544
    ds_read_b64_tr_b16 a[222:223], v7 offset:18688
    v_mfma_f32_16x16x32_bf16 a[108:111], a[204:207], v[244:247], a[108:111]
    buffer_load_dwordx4 v14, s[20:23], s53 offen offset:2048 lds
    v_exp_f32 v30, v106
    v_mfma_f32_16x16x32_bf16 a[116:119], a[204:207], v[248:251], a[116:119]
    v_exp_f32 v31, v107
    v_mfma_f32_16x16x32_bf16 a[124:127], a[204:207], v[252:255], a[124:127]
    s_waitcnt lgkmcnt(4)
    v_add_f32 v25, v28, v29
    v_cvt_pk_bf16_f32 v52, v28, v29
    v_mfma_f32_16x16x32_bf16 a[128:131], a[208:211], v[240:243], a[128:131]
    ds_read_b128 a[192:195], v8 offset:0
    buffer_load_dwordx4 v15, s[20:23], s53 offen offset:3072 lds
    v_add_f32 v25, v25, v30
    v_mfma_f32_16x16x32_bf16 a[136:139], a[208:211], v[244:247], a[136:139]
    v_exp_f32 v32, v108
    v_mfma_f32_16x16x32_bf16 a[144:147], a[208:211], v[248:251], a[144:147]
    v_exp_f32 v33, v109
    v_mfma_f32_16x16x32_bf16 a[152:155], a[208:211], v[252:255], a[152:155]
    s_add_u32 m0, s47, 126976
    s_nop 0
    buffer_load_dwordx4 v16, s[20:23], s53 offen offset:0 lds
    v_add_f32 v25, v25, v31
    v_cvt_pk_bf16_f32 v53, v30, v31
    v_mfma_f32_16x16x32_bf16 a[132:135], a[212:215], v[240:243], a[132:135]
    ds_read_b128 a[196:199], v9 offset:0
    v_add_f32 v25, v25, v32
    v_mfma_f32_16x16x32_bf16 a[140:143], a[212:215], v[244:247], a[140:143]
    v_mfma_f32_16x16x32_bf16 a[148:151], a[212:215], v[248:251], a[148:151]
    v_add_u32 v4, s55, v4
    v_add_u32 v5, s55, v5
    v_mfma_f32_16x16x32_bf16 a[156:159], a[212:215], v[252:255], a[156:159]
    s_waitcnt lgkmcnt(2)
    v_exp_f32 v34, v110
    v_mfma_f32_16x16x32_bf16 a[160:163], a[216:219], v[240:243], a[160:163]
    ds_read_b128 a[200:203], v8 offset:128
    v_add_f32 v25, v25, v33
    v_mfma_f32_16x16x32_bf16 a[168:171], a[216:219], v[244:247], a[168:171]
    v_exp_f32 v35, v111
    v_mfma_f32_16x16x32_bf16 a[176:179], a[216:219], v[248:251], a[176:179]
    v_add_u32 v6, s55, v6
    v_add_u32 v7, s55, v7
    v_mfma_f32_16x16x32_bf16 a[184:187], a[216:219], v[252:255], a[184:187]
    v_cvt_pk_bf16_f32 v54, v32, v33
    v_add_f32 v25, v25, v34
    v_mfma_f32_16x16x32_bf16 a[164:167], a[220:223], v[240:243], a[164:167]
    ds_read_b128 a[204:207], v9 offset:128
    v_add_f32 v25, v25, v35
    v_mfma_f32_16x16x32_bf16 a[172:175], a[220:223], v[244:247], a[172:175]
    v_exp_f32 v28, v112
    v_mfma_f32_16x16x32_bf16 a[180:183], a[220:223], v[248:251], a[180:183]
    v_exp_f32 v29, v113
    v_mfma_f32_16x16x32_bf16 a[188:191], a[220:223], v[252:255], a[188:191]
    s_waitcnt lgkmcnt(2)
    v_cvt_pk_bf16_f32 v55, v34, v35
    v_mfma_f32_16x16x32_bf16 v[160:163], a[192:195], v[64:67], v[224:227]
    s_add_u32 m0, s47, 143360
    s_add_u32 s53, s42, 286720
    ds_read_b128 a[208:211], v8 offset:256
    v_add_f32 v26, v28, v29
    v_mfma_f32_16x16x32_bf16 v[168:171], a[192:195], v[68:71], v[228:231]
    buffer_load_dwordx4 v12, s[20:23], s53 offen offset:0 lds
    v_exp_f32 v30, v114
    v_mfma_f32_16x16x32_bf16 v[176:179], a[192:195], v[72:75], v[232:235]
    s_mul_i32 s3, s49, 40960
    s_bfe_u32 s54, s101, 0x20001
    v_exp_f32 v31, v115
    v_mfma_f32_16x16x32_bf16 v[184:187], a[192:195], v[76:79], v[236:239]
    s_mul_i32 s52, s54, 320
    s_add_u32 s3, s3, s52
    v_cvt_pk_bf16_f32 v56, v28, v29
    v_add_f32 v26, v26, v30
    v_mfma_f32_16x16x32_bf16 v[160:163], a[196:199], v[80:83], v[160:163]
    ds_read_b128 a[212:215], v9 offset:256
    buffer_load_dwordx4 v13, s[20:23], s53 offen offset:1024 lds
    v_add_f32 v26, v26, v31
    v_mfma_f32_16x16x32_bf16 v[168:171], a[196:199], v[84:87], v[168:171]
    s_add_u32 s32, s14, s3
    s_addc_u32 s33, s15, 0
    v_exp_f32 v32, v116
    v_mfma_f32_16x16x32_bf16 v[176:179], a[196:199], v[88:91], v[176:179]
    s_sub_u32 s34, 2621440, s3
    s_mov_b32 s35, 0x20000
    v_exp_f32 v33, v117
    v_mfma_f32_16x16x32_bf16 v[184:187], a[196:199], v[92:95], v[184:187]
    s_waitcnt lgkmcnt(2)
    buffer_load_dwordx4 v14, s[20:23], s53 offen offset:2048 lds
    v_cvt_pk_bf16_f32 v57, v30, v31
    v_add_f32 v26, v26, v32
    v_mfma_f32_16x16x32_bf16 v[160:163], a[200:203], v[128:131], v[160:163]
    s_lshl_b32 s3, s49, 2
    s_add_u32 s3, s3, s54
    ds_read_b128 a[216:219], v8 offset:6144
    v_add_f32 v26, v26, v33
    v_mfma_f32_16x16x32_bf16 v[168:171], a[200:203], v[132:135], v[168:171]
    s_mul_i32 s3, s3, 40960
    s_add_u32 s3, s3, 33554432
    v_exp_f32 v34, v118
    v_mfma_f32_16x16x32_bf16 v[176:179], a[200:203], v[136:139], v[176:179]
    buffer_load_dwordx4 v15, s[20:23], s53 offen offset:3072 lds
    v_exp_f32 v35, v119
    v_mfma_f32_16x16x32_bf16 v[184:187], a[200:203], v[140:143], v[184:187]
    s_add_u32 s28, s18, s3
    s_addc_u32 s29, s19, 0
    v_cvt_pk_bf16_f32 v58, v32, v33
    v_add_f32 v26, v26, v34
    v_mfma_f32_16x16x32_bf16 v[160:163], a[204:207], v[144:147], v[160:163]
    s_mov_b32 s30, 40960
    s_mov_b32 s31, 0x20000
    ds_read_b128 a[220:223], v9 offset:6144
    v_add_f32 v26, v26, v35
    v_mfma_f32_16x16x32_bf16 v[168:171], a[204:207], v[148:151], v[168:171]
    s_add_u32 m0, s47, 147456
    s_nop 0
    buffer_load_dwordx4 v16, s[20:23], s53 offen offset:0 lds
    v_mfma_f32_16x16x32_bf16 v[176:179], a[204:207], v[152:155], v[176:179]
    v_exp_f32 v28, v120
    v_mfma_f32_16x16x32_bf16 v[184:187], a[204:207], v[156:159], v[184:187]
    s_waitcnt lgkmcnt(2)
    v_exp_f32 v29, v121
    v_mfma_f32_16x16x32_bf16 v[160:163], a[208:211], v[192:195], v[160:163]
    s_add_u32 m0, s47, 40960
    s_add_u32 s53, s42, 491520
    ds_read_b128 a[192:195], v8 offset:6272
    v_cvt_pk_bf16_f32 v59, v34, v35
    v_mfma_f32_16x16x32_bf16 v[168:171], a[208:211], v[196:199], v[168:171]
    buffer_load_dwordx4 v12, s[20:23], s53 offen offset:0 lds
    v_add_f32 v27, v28, v29
    v_cvt_pk_bf16_f32 v60, v28, v29
    v_mfma_f32_16x16x32_bf16 v[176:179], a[208:211], v[200:203], v[176:179]
    v_exp_f32 v30, v122
    v_mfma_f32_16x16x32_bf16 v[184:187], a[208:211], v[204:207], v[184:187]
    v_exp_f32 v31, v123
    v_mfma_f32_16x16x32_bf16 v[160:163], a[212:215], v[208:211], v[160:163]
    ds_read_b128 a[196:199], v9 offset:6272
    buffer_load_dwordx4 v13, s[20:23], s53 offen offset:1024 lds
    v_add_f32 v27, v27, v30
    v_mfma_f32_16x16x32_bf16 v[168:171], a[212:215], v[212:215], v[168:171]
    v_add_f32 v27, v27, v31
    v_cvt_pk_bf16_f32 v61, v30, v31
    v_mfma_f32_16x16x32_bf16 v[176:179], a[212:215], v[216:219], v[176:179]
    v_exp_f32 v32, v124
    v_mfma_f32_16x16x32_bf16 v[184:187], a[212:215], v[220:223], v[184:187]
    s_waitcnt lgkmcnt(2)
    buffer_load_dwordx4 v14, s[20:23], s53 offen offset:2048 lds
    v_exp_f32 v33, v125
    v_mfma_f32_16x16x32_bf16 v[164:167], a[216:219], v[64:67], v[224:227]
    ds_read_b128 a[200:203], v8 offset:6400
    v_add_f32 v27, v27, v32
    v_mfma_f32_16x16x32_bf16 v[172:175], a[216:219], v[68:71], v[228:231]
    v_mfma_f32_16x16x32_bf16 v[180:183], a[216:219], v[72:75], v[232:235]
    buffer_load_dwordx4 v15, s[20:23], s53 offen offset:3072 lds
    v_add_f32 v27, v27, v33
    v_cvt_pk_bf16_f32 v62, v32, v33
    v_mfma_f32_16x16x32_bf16 v[188:191], a[216:219], v[76:79], v[236:239]
    v_exp_f32 v34, v126
    v_mfma_f32_16x16x32_bf16 v[164:167], a[220:223], v[80:83], v[164:167]
    ds_read_b128 a[204:207], v9 offset:6400
    v_add_f32 v27, v27, v34
    v_mfma_f32_16x16x32_bf16 v[172:175], a[220:223], v[84:87], v[172:175]
    s_add_u32 m0, s47, 45056
    s_nop 0
    buffer_load_dwordx4 v16, s[20:23], s53 offen offset:0 lds
    v_exp_f32 v35, v127
    v_mfma_f32_16x16x32_bf16 v[180:183], a[220:223], v[88:91], v[180:183]
    v_add_f32 v27, v27, v35
    v_cvt_pk_bf16_f32 v63, v34, v35
    v_mfma_f32_16x16x32_bf16 v[188:191], a[220:223], v[92:95], v[188:191]
    s_waitcnt lgkmcnt(2)
    v_max3_f32 v19, v24, v25, v26
    v_max_f32 v19, v19, v27
    v_mfma_f32_16x16x32_bf16 v[164:167], a[192:195], v[128:131], v[164:167]
    ds_read_b64_tr_b16 a[208:209], v4 offset:0
    ds_read_b64_tr_b16 a[210:211], v4 offset:6144
    v_mfma_f32_16x16x32_bf16 v[172:175], a[192:195], v[132:135], v[172:175]
    v_cmp_lt_f32 vcc, s43, v19
    v_mfma_f32_16x16x32_bf16 v[180:183], a[192:195], v[136:139], v[180:183]
    v_mfma_f32_16x16x32_bf16 v[188:191], a[192:195], v[140:143], v[188:191]
    v_mfma_f32_16x16x32_bf16 v[164:167], a[196:199], v[144:147], v[164:167]
    ds_read_b64_tr_b16 a[212:213], v5 offset:0
    ds_read_b64_tr_b16 a[214:215], v5 offset:6144
    v_mfma_f32_16x16x32_bf16 v[172:175], a[196:199], v[148:151], v[172:175]
    v_mfma_f32_16x16x32_bf16 v[180:183], a[196:199], v[152:155], v[180:183]
    v_mfma_f32_16x16x32_bf16 v[188:191], a[196:199], v[156:159], v[188:191]
    s_waitcnt lgkmcnt(4)
    v_mfma_f32_16x16x32_bf16 v[164:167], a[200:203], v[192:195], v[164:167]
    ds_read_b64_tr_b16 a[216:217], v6 offset:0
    ds_read_b64_tr_b16 a[218:219], v6 offset:6144
    v_mfma_f32_16x16x32_bf16 v[172:175], a[200:203], v[196:199], v[172:175]
    v_mfma_f32_16x16x32_bf16 v[180:183], a[200:203], v[200:203], v[180:183]
    v_mfma_f32_16x16x32_bf16 v[188:191], a[200:203], v[204:207], v[188:191]
    v_mfma_f32_16x16x32_bf16 v[164:167], a[204:207], v[208:211], v[164:167]
    ds_read_b64_tr_b16 a[220:221], v7 offset:0
    ds_read_b64_tr_b16 a[222:223], v7 offset:6144
    v_mfma_f32_16x16x32_bf16 v[172:175], a[204:207], v[212:215], v[172:175]
    v_mfma_f32_16x16x32_bf16 v[180:183], a[204:207], v[216:219], v[180:183]
    v_mfma_f32_16x16x32_bf16 v[188:191], a[204:207], v[220:223], v[188:191]
    s_waitcnt lgkmcnt(4)
    s_cbranch_vccnz RA_H
RA_RET_H:
    v_add_f32 v20, v20, v24
    v_mfma_f32_16x16x32_bf16 a[0:3], a[208:211], v[48:51], a[0:3]
    ds_read_b64_tr_b16 a[192:193], v4 offset:128
    ds_read_b64_tr_b16 a[194:195], v4 offset:6272
    v_mfma_f32_16x16x32_bf16 a[8:11], a[208:211], v[52:55], a[8:11]
    s_barrier
    v_add_f32 v21, v21, v25
    v_mfma_f32_16x16x32_bf16 a[16:19], a[208:211], v[56:59], a[16:19]
    s_add_u32 m0, s47, 61440
    s_add_u32 s53, s44, 573440
    buffer_load_dwordx4 v12, s[20:23], s53 offen offset:0 lds
    v_mfma_f32_16x16x32_bf16 a[24:27], a[208:211], v[60:63], a[24:27]
    v_add_f32 v22, v22, v26
    v_add_f32 v23, v23, v27
    v_mfma_f32_16x16x32_bf16 a[4:7], a[212:215], v[48:51], a[4:7]
    ds_read_b64_tr_b16 a[196:197], v5 offset:128
    ds_read_b64_tr_b16 a[198:199], v5 offset:6272
    v_mfma_f32_16x16x32_bf16 a[12:15], a[212:215], v[52:55], a[12:15]
    buffer_load_dwordx4 v13, s[20:23], s53 offen offset:1024 lds
    v_exp_f32 v28, v160
    v_mfma_f32_16x16x32_bf16 a[20:23], a[212:215], v[56:59], a[20:23]
    v_exp_f32 v29, v161
    v_mfma_f32_16x16x32_bf16 a[28:31], a[212:215], v[60:63], a[28:31]
    s_waitcnt lgkmcnt(4)
    v_add_f32 v24, v28, v29
    v_mfma_f32_16x16x32_bf16 a[32:35], a[216:219], v[48:51], a[32:35]
    ds_read_b64_tr_b16 a[200:201], v6 offset:128
    ds_read_b64_tr_b16 a[202:203], v6 offset:6272
    buffer_load_dwordx4 v14, s[20:23], s53 offen offset:2048 lds
    v_mfma_f32_16x16x32_bf16 a[40:43], a[216:219], v[52:55], a[40:43]
    v_mfma_f32_16x16x32_bf16 a[48:51], a[216:219], v[56:59], a[48:51]
    v_exp_f32 v30, v162
    v_mfma_f32_16x16x32_bf16 a[56:59], a[216:219], v[60:63], a[56:59]
    buffer_load_dwordx4 v15, s[20:23], s53 offen offset:3072 lds
    v_exp_f32 v31, v163
    v_mfma_f32_16x16x32_bf16 a[36:39], a[220:223], v[48:51], a[36:39]
    ds_read_b64_tr_b16 a[204:205], v7 offset:128
    ds_read_b64_tr_b16 a[206:207], v7 offset:6272
    v_mfma_f32_16x16x32_bf16 a[44:47], a[220:223], v[52:55], a[44:47]
    v_cvt_pk_bf16_f32 v240, v28, v29
    v_add_f32 v24, v24, v30
    v_mfma_f32_16x16x32_bf16 a[52:55], a[220:223], v[56:59], a[52:55]
    s_add_u32 m0, s47, 65536
    s_nop 0
    buffer_load_dwordx4 v16, s[20:23], s53 offen offset:0 lds
    v_exp_f32 v32, v164
    v_mfma_f32_16x16x32_bf16 a[60:63], a[220:223], v[60:63], a[60:63]
    s_waitcnt lgkmcnt(4)
    v_exp_f32 v33, v165
    v_mfma_f32_16x16x32_bf16 a[64:67], a[192:195], v[48:51], a[64:67]
    ds_read_b64_tr_b16 a[208:209], v4 offset:256
    ds_read_b64_tr_b16 a[210:211], v4 offset:6400
    v_mfma_f32_16x16x32_bf16 a[72:75], a[192:195], v[52:55], a[72:75]
    s_add_u32 m0, s47, 81920
    s_add_u32 s53, s42, 778240
    v_add_f32 v24, v24, v31
    v_cvt_pk_bf16_f32 v241, v30, v31
    v_mfma_f32_16x16x32_bf16 a[80:83], a[192:195], v[56:59], a[80:83]
    buffer_load_dwordx4 v12, s[20:23], s53 offen offset:0 lds
    v_exp_f32 v34, v166
    v_mfma_f32_16x16x32_bf16 a[88:91], a[192:195], v[60:63], a[88:91]
    v_exp_f32 v35, v167
    v_mfma_f32_16x16x32_bf16 a[68:71], a[196:199], v[48:51], a[68:71]
    ds_read_b64_tr_b16 a[212:213], v5 offset:256
    ds_read_b64_tr_b16 a[214:215], v5 offset:6400
    v_mfma_f32_16x16x32_bf16 a[76:79], a[196:199], v[52:55], a[76:79]
    buffer_load_dwordx4 v13, s[20:23], s53 offen offset:1024 lds
    v_mfma_f32_16x16x32_bf16 a[84:87], a[196:199], v[56:59], a[84:87]
    v_add_f32 v24, v24, v32
    v_add_f32 v24, v24, v33
    v_mfma_f32_16x16x32_bf16 a[92:95], a[196:199], v[60:63], a[92:95]
    s_waitcnt lgkmcnt(4)
    v_cvt_pk_bf16_f32 v242, v32, v33
    v_add_f32 v24, v24, v34
    v_mfma_f32_16x16x32_bf16 a[96:99], a[200:203], v[48:51], a[96:99]
    ds_read_b64_tr_b16 a[216:217], v6 offset:256
    ds_read_b64_tr_b16 a[218:219], v6 offset:6400
    buffer_load_dwordx4 v14, s[20:23], s53 offen offset:2048 lds
    v_mfma_f32_16x16x32_bf16 a[104:107], a[200:203], v[52:55], a[104:107]
    v_exp_f32 v28, v168
    v_mfma_f32_16x16x32_bf16 a[112:115], a[200:203], v[56:59], a[112:115]
    v_exp_f32 v29, v169
    v_mfma_f32_16x16x32_bf16 a[120:123], a[200:203], v[60:63], a[120:123]
    buffer_load_dwordx4 v15, s[20:23], s53 offen offset:3072 lds
    v_add_f32 v24, v24, v35
    v_cvt_pk_bf16_f32 v243, v34, v35
    v_mfma_f32_16x16x32_bf16 a[100:103], a[204:207], v[48:51], a[100:103]
    ds_read_b64_tr_b16 a[220:221], v7 offset:256
    ds_read_b64_tr_b16 a[222:223], v7 offset:6400
    v_mfma_f32_16x16x32_bf16 a[108:111], a[204:207], v[52:55], a[108:111]
    v_exp_f32 v30, v170
    v_mfma_f32_16x16x32_bf16 a[116:119], a[204:207], v[56:59], a[116:119]
    s_add_u32 m0, s47, 86016
    s_nop 0
    buffer_load_dwordx4 v16, s[20:23], s53 offen offset:0 lds
    v_exp_f32 v31, v171
    v_mfma_f32_16x16x32_bf16 a[124:127], a[204:207], v[60:63], a[124:127]
    s_waitcnt lgkmcnt(4)
    v_add_f32 v25, v28, v29
    v_cvt_pk_bf16_f32 v244, v28, v29
    v_mfma_f32_16x16x32_bf16 a[128:131], a[208:211], v[48:51], a[128:131]
    ds_read_b64_tr_b16 a[192:193], v4 offset:12288
    ds_read_b64_tr_b16 a[194:195], v4 offset:18432
    v_add_f32 v25, v25, v30
    v_mfma_f32_16x16x32_bf16 a[136:139], a[208:211], v[52:55], a[136:139]
    ds_read_b64_tr_b16 a[196:197], v5 offset:12288
    v_exp_f32 v32, v172
    v_mfma_f32_16x16x32_bf16 a[144:147], a[208:211], v[56:59], a[144:147]
    ds_read_b64_tr_b16 a[198:199], v5 offset:18432
    v_exp_f32 v33, v173
    v_mfma_f32_16x16x32_bf16 a[152:155], a[208:211], v[60:63], a[152:155]
    ds_read_b64_tr_b16 a[200:201], v6 offset:12288
    v_add_f32 v25, v25, v31
    v_cvt_pk_bf16_f32 v245, v30, v31
    v_mfma_f32_16x16x32_bf16 a[132:135], a[212:215], v[48:51], a[132:135]
    ds_read_b64_tr_b16 a[202:203], v6 offset:18432
    ds_read_b64_tr_b16 a[204:205], v7 offset:12288
    v_add_f32 v25, v25, v32
    v_mfma_f32_16x16x32_bf16 a[140:143], a[212:215], v[52:55], a[140:143]
    ds_read_b64_tr_b16 a[206:207], v7 offset:18432
    v_mfma_f32_16x16x32_bf16 a[148:151], a[212:215], v[56:59], a[148:151]
    v_mfma_f32_16x16x32_bf16 a[156:159], a[212:215], v[60:63], a[156:159]
    s_waitcnt lgkmcnt(8)
    v_exp_f32 v34, v174
    v_mfma_f32_16x16x32_bf16 a[160:163], a[216:219], v[48:51], a[160:163]
    v_add_f32 v25, v25, v33
    v_mfma_f32_16x16x32_bf16 a[168:171], a[216:219], v[52:55], a[168:171]
    v_exp_f32 v35, v175
    v_mfma_f32_16x16x32_bf16 a[176:179], a[216:219], v[56:59], a[176:179]
    v_mfma_f32_16x16x32_bf16 a[184:187], a[216:219], v[60:63], a[184:187]
    v_cvt_pk_bf16_f32 v246, v32, v33
    v_add_f32 v25, v25, v34
    v_mfma_f32_16x16x32_bf16 a[164:167], a[220:223], v[48:51], a[164:167]
    v_add_f32 v25, v25, v35
    v_mfma_f32_16x16x32_bf16 a[172:175], a[220:223], v[52:55], a[172:175]
    v_exp_f32 v28, v176
    v_mfma_f32_16x16x32_bf16 a[180:183], a[220:223], v[56:59], a[180:183]
    v_exp_f32 v29, v177
    v_mfma_f32_16x16x32_bf16 a[188:191], a[220:223], v[60:63], a[188:191]
    v_cvt_pk_bf16_f32 v247, v34, v35
    ds_read_b64_tr_b16 a[208:209], v4 offset:12416
    ds_read_b64_tr_b16 a[210:211], v4 offset:18560
    ds_read_b64_tr_b16 a[212:213], v5 offset:12416
    ds_read_b64_tr_b16 a[214:215], v5 offset:18560
    ds_read_b64_tr_b16 a[216:217], v6 offset:12416
    ds_read_b64_tr_b16 a[218:219], v6 offset:18560
    ds_read_b64_tr_b16 a[220:221], v7 offset:12416
    ds_read_b64_tr_b16 a[222:223], v7 offset:18560
    v_add_f32 v26, v28, v29
    v_exp_f32 v30, v178
    v_exp_f32 v31, v179
    v_cvt_pk_bf16_f32 v248, v28, v29
    v_add_f32 v26, v26, v30
    v_add_f32 v26, v26, v31
    v_exp_f32 v32, v180
    v_exp_f32 v33, v181
    v_cvt_pk_bf16_f32 v249, v30, v31
    v_add_f32 v26, v26, v32
    v_add_f32 v26, v26, v33
    v_exp_f32 v34, v182
    v_exp_f32 v35, v183
    v_cvt_pk_bf16_f32 v250, v32, v33
    v_add_f32 v26, v26, v34
    v_add_f32 v26, v26, v35
    v_exp_f32 v28, v184
    v_exp_f32 v29, v185
    v_cvt_pk_bf16_f32 v251, v34, v35
    v_add_f32 v27, v28, v29
    v_cvt_pk_bf16_f32 v252, v28, v29
    v_exp_f32 v30, v186
    v_exp_f32 v31, v187
    v_add_f32 v27, v27, v30
    v_add_f32 v27, v27, v31
    v_cvt_pk_bf16_f32 v253, v30, v31
    v_exp_f32 v32, v188
    v_exp_f32 v33, v189
    v_add_f32 v27, v27, v32
    v_add_f32 v27, v27, v33
    v_cvt_pk_bf16_f32 v254, v32, v33
    v_exp_f32 v34, v190
    s_nop 0
    v_add_f32 v27, v27, v34
    v_exp_f32 v35, v191
    s_nop 0
    v_add_f32 v27, v27, v35
    v_cvt_pk_bf16_f32 v255, v34, v35
    v_max3_f32 v19, v24, v25, v26
    v_max_f32 v19, v19, v27
    v_cmp_lt_f32 vcc, s43, v19
    s_cbranch_vccnz RA_X
RA_RET_X:
    v_add_f32 v20, v20, v24
    v_add_f32 v21, v21, v25
    v_add_f32 v22, v22, v26
    v_add_f32 v23, v23, v27
    s_waitcnt lgkmcnt(14)
    v_mfma_f32_16x16x32_bf16 a[0:3], a[192:195], v[240:243], a[0:3]
    v_mov_b32 v42, v20
    v_mov_b32 v43, v21
    v_mov_b32 v44, v22
    v_mov_b32 v45, v23
    v_permlane32_swap_b32 v20, v42
    v_mfma_f32_16x16x32_bf16 a[8:11], a[192:195], v[244:247], a[8:11]
    v_permlane32_swap_b32 v21, v43
    v_permlane32_swap_b32 v22, v44
    v_permlane32_swap_b32 v23, v45
    v_add_f32 v20, v20, v42
    v_mfma_f32_16x16x32_bf16 a[16:19], a[192:195], v[248:251], a[16:19]
    v_add_f32 v21, v21, v43
    v_add_f32 v22, v22, v44
    v_add_f32 v23, v23, v45
    v_mov_b32 v42, v20
    v_mov_b32 v43, v21
    v_mov_b32 v44, v22
    v_mov_b32 v45, v23
    v_mfma_f32_16x16x32_bf16 a[24:27], a[192:195], v[252:255], a[24:27]
    v_permlane16_swap_b32 v20, v42
    v_permlane16_swap_b32 v21, v43
    v_permlane16_swap_b32 v22, v44
    s_waitcnt lgkmcnt(12)
    v_mfma_f32_16x16x32_bf16 a[4:7], a[196:199], v[240:243], a[4:7]
    ds_read_b64_tr_b16 a[192:193], v4 offset:12544
    ds_read_b64_tr_b16 a[194:195], v4 offset:18688
    v_permlane16_swap_b32 v23, v45
    v_add_f32 v20, v20, v42
    v_add_f32 v21, v21, v43
    v_add_f32 v22, v22, v44
    v_mfma_f32_16x16x32_bf16 a[12:15], a[196:199], v[244:247], a[12:15]
    v_add_f32 v23, v23, v45
    v_rcp_f32 v20, v20
    v_rcp_f32 v21, v21
    v_rcp_f32 v22, v22
    v_mfma_f32_16x16x32_bf16 a[20:23], a[196:199], v[248:251], a[20:23]
    v_rcp_f32 v23, v23
    v_mfma_f32_16x16x32_bf16 a[28:31], a[196:199], v[252:255], a[28:31]
    s_waitcnt lgkmcnt(12)
    v_mfma_f32_16x16x32_bf16 a[32:35], a[200:203], v[240:243], a[32:35]
    ds_read_b64_tr_b16 a[196:197], v5 offset:12544
    ds_read_b64_tr_b16 a[198:199], v5 offset:18688
    v_mfma_f32_16x16x32_bf16 a[40:43], a[200:203], v[244:247], a[40:43]
    v_mfma_f32_16x16x32_bf16 a[48:51], a[200:203], v[248:251], a[48:51]
    v_accvgpr_read_b32 v192, a0
    v_accvgpr_read_b32 v193, a1
    v_accvgpr_read_b32 v194, a2
    v_accvgpr_read_b32 v195, a3
    v_accvgpr_read_b32 v196, a4
    v_accvgpr_read_b32 v197, a5
    v_accvgpr_read_b32 v198, a6
    v_mfma_f32_16x16x32_bf16 a[56:59], a[200:203], v[252:255], a[56:59]
    v_accvgpr_read_b32 v199, a7
    v_mul_f32 v192, v20, v192
    v_mul_f32 v193, v20, v193
    v_mul_f32 v194, v20, v194
    v_mul_f32 v195, v20, v195
    v_mul_f32 v196, v20, v196
    v_mul_f32 v197, v20, v197
    s_waitcnt lgkmcnt(12)
    v_mfma_f32_16x16x32_bf16 a[36:39], a[204:207], v[240:243], a[36:39]
    ds_read_b64_tr_b16 a[200:201], v6 offset:12544
    ds_read_b64_tr_b16 a[202:203], v6 offset:18688
    v_mul_f32 v198, v20, v198
    v_mul_f32 v199, v20, v199
    v_cvt_pk_bf16_f32 v192, v192, v193
    v_cvt_pk_bf16_f32 v193, v194, v195
    v_cvt_pk_bf16_f32 v194, v196, v197
    v_mfma_f32_16x16x32_bf16 a[44:47], a[204:207], v[244:247], a[44:47]
    v_cvt_pk_bf16_f32 v195, v198, v199
    v_mfma_f32_16x16x32_bf16 a[52:55], a[204:207], v[248:251], a[52:55]
    s_mov_b32 s3, 0
    buffer_store_dwordx4 v[192:195], v10, s[36:39], s3 offen offset:0 sc1
    v_accvgpr_read_b32 v200, a8
    v_accvgpr_read_b32 v201, a9
    v_accvgpr_read_b32 v202, a10
    v_accvgpr_read_b32 v203, a11
    v_accvgpr_read_b32 v204, a12
    v_mfma_f32_16x16x32_bf16 a[60:63], a[204:207], v[252:255], a[60:63]
    v_accvgpr_read_b32 v205, a13
    v_accvgpr_read_b32 v206, a14
    v_accvgpr_read_b32 v207, a15
    v_mul_f32 v200, v21, v200
    v_mul_f32 v201, v21, v201
    v_mul_f32 v202, v21, v202
    v_mul_f32 v203, v21, v203
    s_waitcnt lgkmcnt(12)
    v_mfma_f32_16x16x32_bf16 a[64:67], a[208:211], v[240:243], a[64:67]
    ds_read_b64_tr_b16 a[204:205], v7 offset:12544
    ds_read_b64_tr_b16 a[206:207], v7 offset:18688
    v_mul_f32 v204, v21, v204
    v_mul_f32 v205, v21, v205
    v_mul_f32 v206, v21, v206
    v_mul_f32 v207, v21, v207
    v_cvt_pk_bf16_f32 v200, v200, v201
    v_mfma_f32_16x16x32_bf16 a[72:75], a[208:211], v[244:247], a[72:75]
    v_cvt_pk_bf16_f32 v201, v202, v203
    v_cvt_pk_bf16_f32 v202, v204, v205
    v_cvt_pk_bf16_f32 v203, v206, v207
    v_mfma_f32_16x16x32_bf16 a[80:83], a[208:211], v[248:251], a[80:83]
    s_mov_b32 s3, 0
    buffer_store_dwordx4 v[200:203], v10, s[36:39], s3 offen offset:1024 sc1
    v_accvgpr_read_b32 v208, a16
    v_accvgpr_read_b32 v209, a17
    v_accvgpr_read_b32 v210, a18
    v_accvgpr_read_b32 v211, a19
    v_accvgpr_read_b32 v212, a20
    v_mfma_f32_16x16x32_bf16 a[88:91], a[208:211], v[252:255], a[88:91]
    v_accvgpr_read_b32 v213, a21
    v_accvgpr_read_b32 v214, a22
    v_accvgpr_read_b32 v215, a23
    v_mul_f32 v208, v22, v208
    v_mul_f32 v209, v22, v209
    v_mul_f32 v210, v22, v210
    v_mul_f32 v211, v22, v211
    s_waitcnt lgkmcnt(12)
    v_mfma_f32_16x16x32_bf16 a[68:71], a[212:215], v[240:243], a[68:71]
    v_mul_f32 v212, v22, v212
    v_mul_f32 v213, v22, v213
    v_mul_f32 v214, v22, v214
    v_mul_f32 v215, v22, v215
    v_cvt_pk_bf16_f32 v208, v208, v209
    v_cvt_pk_bf16_f32 v209, v210, v211
    v_cvt_pk_bf16_f32 v210, v212, v213
    v_mfma_f32_16x16x32_bf16 a[76:79], a[212:215], v[244:247], a[76:79]
    v_cvt_pk_bf16_f32 v211, v214, v215
    v_mfma_f32_16x16x32_bf16 a[84:87], a[212:215], v[248:251], a[84:87]
    s_mov_b32 s3, 393216
    buffer_store_dwordx4 v[208:211], v10, s[36:39], s3 offen offset:0 sc1
    v_accvgpr_read_b32 v216, a24
    v_accvgpr_read_b32 v217, a25
    v_accvgpr_read_b32 v218, a26
    v_accvgpr_read_b32 v219, a27
    v_accvgpr_read_b32 v220, a28
    v_mfma_f32_16x16x32_bf16 a[92:95], a[212:215], v[252:255], a[92:95]
    v_accvgpr_read_b32 v221, a29
    v_accvgpr_read_b32 v222, a30
    v_accvgpr_read_b32 v223, a31
    v_mul_f32 v216, v23, v216
    v_mul_f32 v217, v23, v217
    v_mul_f32 v218, v23, v218
    v_mul_f32 v219, v23, v219
    s_waitcnt lgkmcnt(10)
    v_mfma_f32_16x16x32_bf16 a[96:99], a[216:219], v[240:243], a[96:99]
    v_mul_f32 v220, v23, v220
    v_mul_f32 v221, v23, v221
    v_mul_f32 v222, v23, v222
    v_mul_f32 v223, v23, v223
    v_cvt_pk_bf16_f32 v216, v216, v217
    v_cvt_pk_bf16_f32 v217, v218, v219
    v_cvt_pk_bf16_f32 v218, v220, v221
    v_mfma_f32_16x16x32_bf16 a[104:107], a[216:219], v[244:247], a[104:107]
    v_cvt_pk_bf16_f32 v219, v222, v223
    v_mfma_f32_16x16x32_bf16 a[112:115], a[216:219], v[248:251], a[112:115]
    s_mov_b32 s3, 393216
    buffer_store_dwordx4 v[216:219], v10, s[36:39], s3 offen offset:1024 sc1
    v_accvgpr_read_b32 v224, a32
    v_accvgpr_read_b32 v225, a33
    v_accvgpr_read_b32 v226, a34
    v_accvgpr_read_b32 v227, a35
    v_accvgpr_read_b32 v228, a36
    v_mfma_f32_16x16x32_bf16 a[120:123], a[216:219], v[252:255], a[120:123]
    v_accvgpr_read_b32 v229, a37
    v_accvgpr_read_b32 v230, a38
    v_accvgpr_read_b32 v231, a39
    v_mul_f32 v224, v20, v224
    v_mul_f32 v225, v20, v225
    v_mul_f32 v226, v20, v226
    v_mul_f32 v227, v20, v227
    s_waitcnt lgkmcnt(8)
    v_mfma_f32_16x16x32_bf16 a[100:103], a[220:223], v[240:243], a[100:103]
    v_mul_f32 v228, v20, v228
    v_mul_f32 v229, v20, v229
    v_mul_f32 v230, v20, v230
    v_mul_f32 v231, v20, v231
    v_cvt_pk_bf16_f32 v224, v224, v225
    v_cvt_pk_bf16_f32 v225, v226, v227
    v_cvt_pk_bf16_f32 v226, v228, v229
    v_mfma_f32_16x16x32_bf16 a[108:111], a[220:223], v[244:247], a[108:111]
    v_cvt_pk_bf16_f32 v227, v230, v231
    v_mfma_f32_16x16x32_bf16 a[116:119], a[220:223], v[248:251], a[116:119]
    s_mov_b32 s3, 0
    buffer_store_dwordx4 v[224:227], v10, s[36:39], s3 offen offset:2048 sc1
    v_accvgpr_read_b32 v232, a40
    v_accvgpr_read_b32 v233, a41
    v_accvgpr_read_b32 v234, a42
    v_accvgpr_read_b32 v235, a43
    v_accvgpr_read_b32 v236, a44
    v_mfma_f32_16x16x32_bf16 a[124:127], a[220:223], v[252:255], a[124:127]
    v_accvgpr_read_b32 v237, a45
    v_accvgpr_read_b32 v238, a46
    v_accvgpr_read_b32 v239, a47
    v_mul_f32 v232, v21, v232
    v_mul_f32 v233, v21, v233
    v_mul_f32 v234, v21, v234
    v_mul_f32 v235, v21, v235
    s_waitcnt lgkmcnt(6)
    v_mfma_f32_16x16x32_bf16 a[128:131], a[192:195], v[240:243], a[128:131]
    v_mul_f32 v236, v21, v236
    v_mul_f32 v237, v21, v237
    v_mul_f32 v238, v21, v238
    v_mul_f32 v239, v21, v239
    v_cvt_pk_bf16_f32 v232, v232, v233
    v_cvt_pk_bf16_f32 v233, v234, v235
    v_cvt_pk_bf16_f32 v234, v236, v237
    v_mfma_f32_16x16x32_bf16 a[136:139], a[192:195], v[244:247], a[136:139]
    v_cvt_pk_bf16_f32 v235, v238, v239
    v_mfma_f32_16x16x32_bf16 a[144:147], a[192:195], v[248:251], a[144:147]
    s_mov_b32 s3, 0
    buffer_store_dwordx4 v[232:235], v10, s[36:39], s3 offen offset:3072 sc1
    v_accvgpr_read_b32 v192, a48
    v_accvgpr_read_b32 v193, a49
    v_accvgpr_read_b32 v194, a50
    v_accvgpr_read_b32 v195, a51
    v_accvgpr_read_b32 v196, a52
    v_mfma_f32_16x16x32_bf16 a[152:155], a[192:195], v[252:255], a[152:155]
    v_accvgpr_read_b32 v197, a53
    v_accvgpr_read_b32 v198, a54
    v_accvgpr_read_b32 v199, a55
    v_mul_f32 v192, v22, v192
    v_mul_f32 v193, v22, v193
    v_mul_f32 v194, v22, v194
    v_mul_f32 v195, v22, v195
    s_waitcnt lgkmcnt(4)
    v_mfma_f32_16x16x32_bf16 a[132:135], a[196:199], v[240:243], a[132:135]
    v_mul_f32 v196, v22, v196
    v_mul_f32 v197, v22, v197
    v_mul_f32 v198, v22, v198
    v_mul_f32 v199, v22, v199
    v_cvt_pk_bf16_f32 v192, v192, v193
    v_cvt_pk_bf16_f32 v193, v194, v195
    v_cvt_pk_bf16_f32 v194, v196, v197
    v_mfma_f32_16x16x32_bf16 a[140:143], a[196:199], v[244:247], a[140:143]
    v_cvt_pk_bf16_f32 v195, v198, v199
    v_mfma_f32_16x16x32_bf16 a[148:151], a[196:199], v[248:251], a[148:151]
    s_mov_b32 s3, 393216
    buffer_store_dwordx4 v[192:195], v10, s[36:39], s3 offen offset:2048 sc1
    v_accvgpr_read_b32 v200, a56
    v_accvgpr_read_b32 v201, a57
    v_accvgpr_read_b32 v202, a58
    v_accvgpr_read_b32 v203, a59
    v_accvgpr_read_b32 v204, a60
    v_mfma_f32_16x16x32_bf16 a[156:159], a[196:199], v[252:255], a[156:159]
    v_accvgpr_read_b32 v205, a61
    v_accvgpr_read_b32 v206, a62
    v_accvgpr_read_b32 v207, a63
    v_mul_f32 v200, v23, v200
    v_mul_f32 v201, v23, v201
    v_mul_f32 v202, v23, v202
    v_mul_f32 v203, v23, v203
    s_waitcnt lgkmcnt(2)
    v_mfma_f32_16x16x32_bf16 a[160:163], a[200:203], v[240:243], a[160:163]
    v_mul_f32 v204, v23, v204
    v_mul_f32 v205, v23, v205
    v_mul_f32 v206, v23, v206
    v_mul_f32 v207, v23, v207
    v_cvt_pk_bf16_f32 v200, v200, v201
    v_cvt_pk_bf16_f32 v201, v202, v203
    v_cvt_pk_bf16_f32 v202, v204, v205
    v_mfma_f32_16x16x32_bf16 a[168:171], a[200:203], v[244:247], a[168:171]
    v_cvt_pk_bf16_f32 v203, v206, v207
    v_mfma_f32_16x16x32_bf16 a[176:179], a[200:203], v[248:251], a[176:179]
    s_mov_b32 s3, 393216
    buffer_store_dwordx4 v[200:203], v10, s[36:39], s3 offen offset:3072 sc1
    v_accvgpr_read_b32 v208, a64
    v_accvgpr_read_b32 v209, a65
    v_accvgpr_read_b32 v210, a66
    v_accvgpr_read_b32 v211, a67
    v_accvgpr_read_b32 v212, a68
    v_mfma_f32_16x16x32_bf16 a[184:187], a[200:203], v[252:255], a[184:187]
    v_accvgpr_read_b32 v213, a69
    v_accvgpr_read_b32 v214, a70
    v_accvgpr_read_b32 v215, a71
    v_mul_f32 v208, v20, v208
    v_mul_f32 v209, v20, v209
    v_mul_f32 v210, v20, v210
    v_mul_f32 v211, v20, v211
    s_waitcnt lgkmcnt(0)
    v_mfma_f32_16x16x32_bf16 a[164:167], a[204:207], v[240:243], a[164:167]
    v_mul_f32 v212, v20, v212
    v_mul_f32 v213, v20, v213
    v_mul_f32 v214, v20, v214
    v_mul_f32 v215, v20, v215
    v_cvt_pk_bf16_f32 v208, v208, v209
    v_cvt_pk_bf16_f32 v209, v210, v211
    v_cvt_pk_bf16_f32 v210, v212, v213
    v_mfma_f32_16x16x32_bf16 a[172:175], a[204:207], v[244:247], a[172:175]
    v_cvt_pk_bf16_f32 v211, v214, v215
    v_mfma_f32_16x16x32_bf16 a[180:183], a[204:207], v[248:251], a[180:183]
    s_mov_b32 s3, 4096
    buffer_store_dwordx4 v[208:211], v10, s[36:39], s3 offen offset:0 sc1
    v_accvgpr_read_b32 v216, a72
    v_accvgpr_read_b32 v217, a73
    v_accvgpr_read_b32 v218, a74
    v_accvgpr_read_b32 v219, a75
    v_accvgpr_read_b32 v220, a76
    v_mfma_f32_16x16x32_bf16 a[188:191], a[204:207], v[252:255], a[188:191]
    v_accvgpr_read_b32 v221, a77
    v_accvgpr_read_b32 v222, a78
    v_accvgpr_read_b32 v223, a79
    v_mul_f32 v216, v21, v216
    v_mul_f32 v217, v21, v217
    v_mul_f32 v218, v21, v218
    v_mul_f32 v219, v21, v219
    v_mul_f32 v220, v21, v220
    v_mul_f32 v221, v21, v221
    v_mul_f32 v222, v21, v222
    v_mul_f32 v223, v21, v223
    v_cvt_pk_bf16_f32 v216, v216, v217
    v_cvt_pk_bf16_f32 v217, v218, v219
    v_cvt_pk_bf16_f32 v218, v220, v221
    v_cvt_pk_bf16_f32 v219, v222, v223
    s_mov_b32 s3, 4096
    buffer_store_dwordx4 v[216:219], v10, s[36:39], s3 offen offset:1024 sc1
    v_accvgpr_read_b32 v224, a80
    v_accvgpr_read_b32 v225, a81
    v_accvgpr_read_b32 v226, a82
    v_accvgpr_read_b32 v227, a83
    v_accvgpr_read_b32 v228, a84
    v_accvgpr_read_b32 v229, a85
    v_accvgpr_read_b32 v230, a86
    v_accvgpr_read_b32 v231, a87
    v_mul_f32 v224, v22, v224
    v_mul_f32 v225, v22, v225
    v_mul_f32 v226, v22, v226
    v_mul_f32 v227, v22, v227
    v_mul_f32 v228, v22, v228
    v_mul_f32 v229, v22, v229
    v_mul_f32 v230, v22, v230
    v_mul_f32 v231, v22, v231
    v_cvt_pk_bf16_f32 v224, v224, v225
    v_cvt_pk_bf16_f32 v225, v226, v227
    v_cvt_pk_bf16_f32 v226, v228, v229
    v_cvt_pk_bf16_f32 v227, v230, v231
    s_mov_b32 s3, 397312
    buffer_store_dwordx4 v[224:227], v10, s[36:39], s3 offen offset:0 sc1
    v_accvgpr_read_b32 v232, a88
    v_accvgpr_read_b32 v233, a89
    v_accvgpr_read_b32 v234, a90
    v_accvgpr_read_b32 v235, a91
    v_accvgpr_read_b32 v236, a92
    v_accvgpr_read_b32 v237, a93
    v_accvgpr_read_b32 v238, a94
    v_accvgpr_read_b32 v239, a95
    v_mul_f32 v232, v23, v232
    v_mul_f32 v233, v23, v233
    v_mul_f32 v234, v23, v234
    v_mul_f32 v235, v23, v235
    v_mul_f32 v236, v23, v236
    v_mul_f32 v237, v23, v237
    v_mul_f32 v238, v23, v238
    v_mul_f32 v239, v23, v239
    v_cvt_pk_bf16_f32 v232, v232, v233
    v_cvt_pk_bf16_f32 v233, v234, v235
    v_cvt_pk_bf16_f32 v234, v236, v237
    v_cvt_pk_bf16_f32 v235, v238, v239
    s_mov_b32 s3, 397312
    buffer_store_dwordx4 v[232:235], v10, s[36:39], s3 offen offset:1024 sc1
    v_accvgpr_read_b32 v192, a96
    v_accvgpr_read_b32 v193, a97
    v_accvgpr_read_b32 v194, a98
    v_accvgpr_read_b32 v195, a99
    v_accvgpr_read_b32 v196, a100
    v_accvgpr_read_b32 v197, a101
    v_accvgpr_read_b32 v198, a102
    v_accvgpr_read_b32 v199, a103
    v_pk_mul_f32 v[192:193], v[192:193], v[20:21] op_sel:[0,0] op_sel_hi:[1,0]
    v_pk_mul_f32 v[194:195], v[194:195], v[20:21] op_sel:[0,0] op_sel_hi:[1,0]
    v_pk_mul_f32 v[196:197], v[196:197], v[20:21] op_sel:[0,0] op_sel_hi:[1,0]
    v_pk_mul_f32 v[198:199], v[198:199], v[20:21] op_sel:[0,0] op_sel_hi:[1,0]
    v_cvt_pk_bf16_f32 v64, v192, v193
    v_cvt_pk_bf16_f32 v65, v194, v195
    v_cvt_pk_bf16_f32 v66, v196, v197
    v_cvt_pk_bf16_f32 v67, v198, v199
    v_accvgpr_read_b32 v200, a104
    v_accvgpr_read_b32 v201, a105
    v_accvgpr_read_b32 v202, a106
    v_accvgpr_read_b32 v203, a107
    v_accvgpr_read_b32 v204, a108
    v_accvgpr_read_b32 v205, a109
    v_accvgpr_read_b32 v206, a110
    v_accvgpr_read_b32 v207, a111
    v_pk_mul_f32 v[200:201], v[200:201], v[20:21] op_sel:[0,1] op_sel_hi:[1,1]
    v_pk_mul_f32 v[202:203], v[202:203], v[20:21] op_sel:[0,1] op_sel_hi:[1,1]
    v_pk_mul_f32 v[204:205], v[204:205], v[20:21] op_sel:[0,1] op_sel_hi:[1,1]
    v_pk_mul_f32 v[206:207], v[206:207], v[20:21] op_sel:[0,1] op_sel_hi:[1,1]
    v_cvt_pk_bf16_f32 v68, v200, v201
    v_cvt_pk_bf16_f32 v69, v202, v203
    v_cvt_pk_bf16_f32 v70, v204, v205
    v_cvt_pk_bf16_f32 v71, v206, v207
    v_accvgpr_read_b32 v208, a112
    v_accvgpr_read_b32 v209, a113
    v_accvgpr_read_b32 v210, a114
    v_accvgpr_read_b32 v211, a115
    v_accvgpr_read_b32 v212, a116
    v_accvgpr_read_b32 v213, a117
    v_accvgpr_read_b32 v214, a118
    v_accvgpr_read_b32 v215, a119
    v_pk_mul_f32 v[208:209], v[208:209], v[22:23] op_sel:[0,0] op_sel_hi:[1,0]
    v_pk_mul_f32 v[210:211], v[210:211], v[22:23] op_sel:[0,0] op_sel_hi:[1,0]
    v_pk_mul_f32 v[212:213], v[212:213], v[22:23] op_sel:[0,0] op_sel_hi:[1,0]
    v_pk_mul_f32 v[214:215], v[214:215], v[22:23] op_sel:[0,0] op_sel_hi:[1,0]
    v_cvt_pk_bf16_f32 v72, v208, v209
    v_cvt_pk_bf16_f32 v73, v210, v211
    v_cvt_pk_bf16_f32 v74, v212, v213
    v_cvt_pk_bf16_f32 v75, v214, v215
    v_accvgpr_read_b32 v216, a120
    v_accvgpr_read_b32 v217, a121
    v_accvgpr_read_b32 v218, a122
    v_accvgpr_read_b32 v219, a123
    v_accvgpr_read_b32 v220, a124
    v_accvgpr_read_b32 v221, a125
    v_accvgpr_read_b32 v222, a126
    v_accvgpr_read_b32 v223, a127
    v_pk_mul_f32 v[216:217], v[216:217], v[22:23] op_sel:[0,1] op_sel_hi:[1,1]
    v_pk_mul_f32 v[218:219], v[218:219], v[22:23] op_sel:[0,1] op_sel_hi:[1,1]
    v_pk_mul_f32 v[220:221], v[220:221], v[22:23] op_sel:[0,1] op_sel_hi:[1,1]
    v_pk_mul_f32 v[222:223], v[222:223], v[22:23] op_sel:[0,1] op_sel_hi:[1,1]
    v_cvt_pk_bf16_f32 v76, v216, v217
    v_cvt_pk_bf16_f32 v77, v218, v219
    v_cvt_pk_bf16_f32 v78, v220, v221
    v_cvt_pk_bf16_f32 v79, v222, v223
    v_accvgpr_read_b32 v224, a128
    v_accvgpr_read_b32 v225, a129
    v_accvgpr_read_b32 v226, a130
    v_accvgpr_read_b32 v227, a131
    v_accvgpr_read_b32 v228, a132
    v_accvgpr_read_b32 v229, a133
    v_accvgpr_read_b32 v230, a134
    v_accvgpr_read_b32 v231, a135
    v_pk_mul_f32 v[224:225], v[224:225], v[20:21] op_sel:[0,0] op_sel_hi:[1,0]
    v_pk_mul_f32 v[226:227], v[226:227], v[20:21] op_sel:[0,0] op_sel_hi:[1,0]
    v_pk_mul_f32 v[228:229], v[228:229], v[20:21] op_sel:[0,0] op_sel_hi:[1,0]
    v_pk_mul_f32 v[230:231], v[230:231], v[20:21] op_sel:[0,0] op_sel_hi:[1,0]
    v_cvt_pk_bf16_f32 v80, v224, v225
    v_cvt_pk_bf16_f32 v81, v226, v227
    v_cvt_pk_bf16_f32 v82, v228, v229
    v_cvt_pk_bf16_f32 v83, v230, v231
    v_accvgpr_read_b32 v232, a136
    v_accvgpr_read_b32 v233, a137
    v_accvgpr_read_b32 v234, a138
    v_accvgpr_read_b32 v235, a139
    v_accvgpr_read_b32 v236, a140
    v_accvgpr_read_b32 v237, a141
    v_accvgpr_read_b32 v238, a142
    v_accvgpr_read_b32 v239, a143
    v_pk_mul_f32 v[232:233], v[232:233], v[20:21] op_sel:[0,1] op_sel_hi:[1,1]
    v_pk_mul_f32 v[234:235], v[234:235], v[20:21] op_sel:[0,1] op_sel_hi:[1,1]
    v_pk_mul_f32 v[236:237], v[236:237], v[20:21] op_sel:[0,1] op_sel_hi:[1,1]
    v_pk_mul_f32 v[238:239], v[238:239], v[20:21] op_sel:[0,1] op_sel_hi:[1,1]
    v_cvt_pk_bf16_f32 v84, v232, v233
    v_cvt_pk_bf16_f32 v85, v234, v235
    v_cvt_pk_bf16_f32 v86, v236, v237
    v_cvt_pk_bf16_f32 v87, v238, v239
    v_accvgpr_read_b32 v192, a144
    v_accvgpr_read_b32 v193, a145
    v_accvgpr_read_b32 v194, a146
    v_accvgpr_read_b32 v195, a147
    v_accvgpr_read_b32 v196, a148
    v_accvgpr_read_b32 v197, a149
    v_accvgpr_read_b32 v198, a150
    v_accvgpr_read_b32 v199, a151
    v_pk_mul_f32 v[192:193], v[192:193], v[22:23] op_sel:[0,0] op_sel_hi:[1,0]
    v_pk_mul_f32 v[194:195], v[194:195], v[22:23] op_sel:[0,0] op_sel_hi:[1,0]
    v_pk_mul_f32 v[196:197], v[196:197], v[22:23] op_sel:[0,0] op_sel_hi:[1,0]
    v_pk_mul_f32 v[198:199], v[198:199], v[22:23] op_sel:[0,0] op_sel_hi:[1,0]
    v_cvt_pk_bf16_f32 v88, v192, v193
    v_cvt_pk_bf16_f32 v89, v194, v195
    v_cvt_pk_bf16_f32 v90, v196, v197
    v_cvt_pk_bf16_f32 v91, v198, v199
    v_accvgpr_read_b32 v200, a152
    v_accvgpr_read_b32 v201, a153
    v_accvgpr_read_b32 v202, a154
    v_accvgpr_read_b32 v203, a155
    v_accvgpr_read_b32 v204, a156
    v_accvgpr_read_b32 v205, a157
    v_accvgpr_read_b32 v206, a158
    v_accvgpr_read_b32 v207, a159
    v_pk_mul_f32 v[200:201], v[200:201], v[22:23] op_sel:[0,1] op_sel_hi:[1,1]
    v_pk_mul_f32 v[202:203], v[202:203], v[22:23] op_sel:[0,1] op_sel_hi:[1,1]
    v_pk_mul_f32 v[204:205], v[204:205], v[22:23] op_sel:[0,1] op_sel_hi:[1,1]
    v_pk_mul_f32 v[206:207], v[206:207], v[22:23] op_sel:[0,1] op_sel_hi:[1,1]
    v_cvt_pk_bf16_f32 v92, v200, v201
    v_cvt_pk_bf16_f32 v93, v202, v203
    v_cvt_pk_bf16_f32 v94, v204, v205
    v_cvt_pk_bf16_f32 v95, v206, v207
    v_accvgpr_read_b32 v208, a160
    v_accvgpr_read_b32 v209, a161
    v_accvgpr_read_b32 v210, a162
    v_accvgpr_read_b32 v211, a163
    v_accvgpr_read_b32 v212, a164
    v_accvgpr_read_b32 v213, a165
    v_accvgpr_read_b32 v214, a166
    v_accvgpr_read_b32 v215, a167
    v_pk_mul_f32 v[208:209], v[208:209], v[20:21] op_sel:[0,0] op_sel_hi:[1,0]
    v_pk_mul_f32 v[210:211], v[210:211], v[20:21] op_sel:[0,0] op_sel_hi:[1,0]
    v_pk_mul_f32 v[212:213], v[212:213], v[20:21] op_sel:[0,0] op_sel_hi:[1,0]
    v_pk_mul_f32 v[214:215], v[214:215], v[20:21] op_sel:[0,0] op_sel_hi:[1,0]
    v_cvt_pk_bf16_f32 v96, v208, v209
    v_cvt_pk_bf16_f32 v97, v210, v211
    v_cvt_pk_bf16_f32 v98, v212, v213
    v_cvt_pk_bf16_f32 v99, v214, v215
    v_accvgpr_read_b32 v216, a168
    v_accvgpr_read_b32 v217, a169
    v_accvgpr_read_b32 v218, a170
    v_accvgpr_read_b32 v219, a171
    v_accvgpr_read_b32 v220, a172
    v_accvgpr_read_b32 v221, a173
    v_accvgpr_read_b32 v222, a174
    v_accvgpr_read_b32 v223, a175
    v_pk_mul_f32 v[216:217], v[216:217], v[20:21] op_sel:[0,1] op_sel_hi:[1,1]
    v_pk_mul_f32 v[218:219], v[218:219], v[20:21] op_sel:[0,1] op_sel_hi:[1,1]
    v_pk_mul_f32 v[220:221], v[220:221], v[20:21] op_sel:[0,1] op_sel_hi:[1,1]
    v_pk_mul_f32 v[222:223], v[222:223], v[20:21] op_sel:[0,1] op_sel_hi:[1,1]
    v_cvt_pk_bf16_f32 v100, v216, v217
    v_cvt_pk_bf16_f32 v101, v218, v219
    v_cvt_pk_bf16_f32 v102, v220, v221
    v_cvt_pk_bf16_f32 v103, v222, v223
    v_accvgpr_read_b32 v224, a176
    v_accvgpr_read_b32 v225, a177
    v_accvgpr_read_b32 v226, a178
    v_accvgpr_read_b32 v227, a179
    v_accvgpr_read_b32 v228, a180
    v_accvgpr_read_b32 v229, a181
    v_accvgpr_read_b32 v230, a182
    v_accvgpr_read_b32 v231, a183
    v_pk_mul_f32 v[224:225], v[224:225], v[22:23] op_sel:[0,0] op_sel_hi:[1,0]
    v_pk_mul_f32 v[226:227], v[226:227], v[22:23] op_sel:[0,0] op_sel_hi:[1,0]
    v_pk_mul_f32 v[228:229], v[228:229], v[22:23] op_sel:[0,0] op_sel_hi:[1,0]
    v_pk_mul_f32 v[230:231], v[230:231], v[22:23] op_sel:[0,0] op_sel_hi:[1,0]
    v_cvt_pk_bf16_f32 v104, v224, v225
    v_cvt_pk_bf16_f32 v105, v226, v227
    v_cvt_pk_bf16_f32 v106, v228, v229
    v_cvt_pk_bf16_f32 v107, v230, v231
    v_accvgpr_read_b32 v232, a184
    v_accvgpr_read_b32 v233, a185
    v_accvgpr_read_b32 v234, a186
    v_accvgpr_read_b32 v235, a187
    v_accvgpr_read_b32 v236, a188
    v_accvgpr_read_b32 v237, a189
    v_accvgpr_read_b32 v238, a190
    v_accvgpr_read_b32 v239, a191
    v_pk_mul_f32 v[232:233], v[232:233], v[22:23] op_sel:[0,1] op_sel_hi:[1,1]
    v_pk_mul_f32 v[234:235], v[234:235], v[22:23] op_sel:[0,1] op_sel_hi:[1,1]
    v_pk_mul_f32 v[236:237], v[236:237], v[22:23] op_sel:[0,1] op_sel_hi:[1,1]
    v_pk_mul_f32 v[238:239], v[238:239], v[22:23] op_sel:[0,1] op_sel_hi:[1,1]
    v_cvt_pk_bf16_f32 v108, v232, v233
    v_cvt_pk_bf16_f32 v109, v234, v235
    v_cvt_pk_bf16_f32 v110, v236, v237
    v_cvt_pk_bf16_f32 v111, v238, v239
    v_add_u32 v246, s47, v11
    v_add_u32 v247, 61440, v246
    v_add_u32 v248, 122880, v246
    v_xor_b32 v240, 0, v18
    v_add_u32 v242, 61440, v240
    v_add_u32 v244, 122880, v240
    v_xor_b32 v241, 32, v18
    v_add_u32 v243, 61440, v241
    v_add_u32 v245, 122880, v241
    s_waitcnt vmcnt(0)
    s_barrier
    s_cmp_lg_u32 s40, 0
    s_cbranch_scc1 H1_NF
    global_store_dword v1, v2, s[6:7] sc1
H1_NF:
    s_add_u32 m0, s47, 0
    s_add_u32 s53, s42, 983040
    buffer_load_dwordx4 v12, s[20:23], s53 offen offset:0 lds
    buffer_load_dwordx4 v13, s[20:23], s53 offen offset:1024 lds
    buffer_load_dwordx4 v14, s[20:23], s53 offen offset:2048 lds
    buffer_load_dwordx4 v15, s[20:23], s53 offen offset:3072 lds
    s_add_u32 m0, s47, 4096
    s_nop 0
    buffer_load_dwordx4 v16, s[20:23], s53 offen offset:0 lds
    s_add_u32 m0, s47, 20480
    s_add_u32 s53, s44, 1064960
    buffer_load_dwordx4 v12, s[20:23], s53 offen offset:0 lds
    buffer_load_dwordx4 v13, s[20:23], s53 offen offset:1024 lds
    buffer_load_dwordx4 v14, s[20:23], s53 offen offset:2048 lds
    buffer_load_dwordx4 v15, s[20:23], s53 offen offset:3072 lds
    s_add_u32 m0, s47, 24576
    s_nop 0
    buffer_load_dwordx4 v16, s[20:23], s53 offen offset:0 lds
    s_mov_b32 s52, 262144
H1_POLL:
    global_load_dword v48, v3, s[6:7] offset:0 sc1
    s_sub_u32 s52, s52, 1
    s_waitcnt vmcnt(0)
    s_cbranch_scc1 H1_OK
    v_cmp_ne_u32 vcc, s5, v48
    s_cbranch_vccz H1_OK
    s_sleep 1
    s_branch H1_POLL
H1_OK:
    ds_read_b64_tr_b16 a[192:193], v242 offset:40960
    ds_read_b64_tr_b16 a[194:195], v242 offset:46080
    ds_read_b64_tr_b16 a[196:197], v243 offset:40960
    ds_read_b64_tr_b16 a[198:199], v243 offset:46080
    ds_read_b64_tr_b16 a[200:201], v242 offset:41024
    ds_read_b64_tr_b16 a[202:203], v242 offset:46144
    ds_read_b64_tr_b16 a[204:205], v243 offset:41024
    ds_read_b64_tr_b16 a[206:207], v243 offset:46144
    ds_read_b64_tr_b16 a[208:209], v242 offset:41088
    ds_read_b64_tr_b16 a[210:211], v242 offset:46208
    ds_read_b64_tr_b16 a[212:213], v243 offset:41088
    ds_read_b64_tr_b16 a[214:215], v243 offset:46208
    s_mov_b32 s54, 0
    buffer_load_dwordx4 a[0:3], v11, s[24:27], s54 offen offset:0 sc1
    buffer_load_dwordx4 a[4:7], v11, s[24:27], s54 offen offset:1024 sc1
    s_mov_b32 s54, 2048
    buffer_load_dwordx4 a[8:11], v11, s[24:27], s54 offen offset:0 sc1
    buffer_load_dwordx4 a[12:15], v11, s[24:27], s54 offen offset:1024 sc1
    s_mov_b32 s54, 4096
    buffer_load_dwordx4 a[16:19], v11, s[24:27], s54 offen offset:0 sc1
    buffer_load_dwordx4 a[20:23], v11, s[24:27], s54 offen offset:1024 sc1
    s_mov_b32 s54, 12288
    buffer_load_dwordx4 a[24:27], v11, s[24:27], s54 offen offset:0 sc1
    buffer_load_dwordx4 a[28:31], v11, s[24:27], s54 offen offset:1024 sc1
    s_mov_b32 s54, 14336
    buffer_load_dwordx4 a[32:35], v11, s[24:27], s54 offen offset:0 sc1
    buffer_load_dwordx4 a[36:39], v11, s[24:27], s54 offen offset:1024 sc1
    s_mov_b32 s54, 16384
    buffer_load_dwordx4 a[40:43], v11, s[24:27], s54 offen offset:0 sc1
    buffer_load_dwordx4 a[44:47], v11, s[24:27], s54 offen offset:1024 sc1
    s_mov_b32 s54, 24576
    buffer_load_dwordx4 a[48:51], v11, s[24:27], s54 offen offset:0 sc1
    buffer_load_dwordx4 a[52:55], v11, s[24:27], s54 offen offset:1024 sc1
    s_mov_b32 s54, 26624
    buffer_load_dwordx4 a[56:59], v11, s[24:27], s54 offen offset:0 sc1
    buffer_load_dwordx4 a[60:63], v11, s[24:27], s54 offen offset:1024 sc1
    s_waitcnt vmcnt(15) lgkmcnt(10)
    v_mfma_f32_16x16x32_bf16 v[128:131], a[192:195], a[0:3], 0
    s_mov_b32 s54, 28672
    ds_read_b64_tr_b16 a[216:217], v242 offset:41152
    ds_read_b64_tr_b16 a[218:219], v242 offset:46272
    s_waitcnt vmcnt(14)
    v_mfma_f32_16x16x32_bf16 v[136:139], a[192:195], a[4:7], 0
    buffer_load_dwordx4 a[64:67], v11, s[24:27], s54 offen offset:0 sc1
    s_waitcnt lgkmcnt(10)
    v_mfma_f32_16x16x32_bf16 v[132:135], a[196:199], a[0:3], 0
    ds_read_b64_tr_b16 a[220:221], v243 offset:41152
    ds_read_b64_tr_b16 a[222:223], v243 offset:46272
    v_mfma_f32_16x16x32_bf16 v[140:143], a[196:199], a[4:7], 0
    s_waitcnt lgkmcnt(8)
    v_mfma_f32_16x16x32_bf16 v[144:147], a[200:203], a[0:3], 0
    ds_read_b64_tr_b16 a[192:193], v242 offset:41216
    ds_read_b64_tr_b16 a[194:195], v242 offset:46336
    v_mfma_f32_16x16x32_bf16 v[152:155], a[200:203], a[4:7], 0
    s_barrier
    v_mfma_f32_16x16x32_bf16 v[148:151], a[204:207], a[0:3], 0
    ds_read_b64_tr_b16 a[196:197], v243 offset:41216
    ds_read_b64_tr_b16 a[198:199], v243 offset:46336
    v_mfma_f32_16x16x32_bf16 v[156:159], a[204:207], a[4:7], 0
    s_waitcnt lgkmcnt(8)
    buffer_load_dwordx4 a[68:71], v11, s[24:27], s54 offen offset:1024 sc1
    v_mfma_f32_16x16x32_bf16 v[160:163], a[208:211], a[0:3], 0
    ds_read_b64_tr_b16 a[200:201], v242 offset:51200
    ds_read_b64_tr_b16 a[202:203], v242 offset:56320
    v_mfma_f32_16x16x32_bf16 v[168:171], a[208:211], a[4:7], 0
    v_mfma_f32_16x16x32_bf16 v[164:167], a[212:215], a[0:3], 0
    s_mov_b32 s54, 36864
    ds_read_b64_tr_b16 a[204:205], v243 offset:51200
    ds_read_b64_tr_b16 a[206:207], v243 offset:56320
    v_mfma_f32_16x16x32_bf16 v[172:175], a[212:215], a[4:7], 0
    s_waitcnt lgkmcnt(8)
    buffer_load_dwordx4 a[72:75], v11, s[24:27], s54 offen offset:0 sc1
    v_mfma_f32_16x16x32_bf16 v[176:179], a[216:219], a[0:3], 0
    ds_read_b64_tr_b16 a[208:209], v242 offset:51264
    ds_read_b64_tr_b16 a[210:211], v242 offset:56384
    v_mfma_f32_16x16x32_bf16 v[184:187], a[216:219], a[4:7], 0
    v_mfma_f32_16x16x32_bf16 v[180:183], a[220:223], a[0:3], 0
    ds_read_b64_tr_b16 a[212:213], v243 offset:51264
    ds_read_b64_tr_b16 a[214:215], v243 offset:56384
    v_mfma_f32_16x16x32_bf16 v[188:191], a[220:223], a[4:7], 0
    s_waitcnt lgkmcnt(8)
    buffer_load_dwordx4 a[76:79], v11, s[24:27], s54 offen offset:1024 sc1
    v_mfma_f32_16x16x32_bf16 v[192:195], a[192:195], a[0:3], 0
    ds_read_b64_tr_b16 a[216:217], v242 offset:51328
    ds_read_b64_tr_b16 a[218:219], v242 offset:56448
    v_mfma_f32_16x16x32_bf16 v[200:203], a[192:195], a[4:7], 0
    v_mfma_f32_16x16x32_bf16 v[196:199], a[196:199], a[0:3], 0
    ds_read_b64_tr_b16 a[220:221], v243 offset:51328
    ds_read_b64_tr_b16 a[222:223], v243 offset:56448
    v_mfma_f32_16x16x32_bf16 v[204:207], a[196:199], a[4:7], 0
    s_waitcnt vmcnt(16) lgkmcnt(8)
    v_mfma_f32_16x16x32_bf16 v[128:131], a[200:203], a[8:11], v[128:131]
    s_mov_b32 s54, 38912
    ds_read_b64_tr_b16 a[192:193], v242 offset:51392
    ds_read_b64_tr_b16 a[194:195], v242 offset:56512
    v_mfma_f32_16x16x32_bf16 v[136:139], a[200:203], a[12:15], v[136:139]
    buffer_load_dwordx4 a[80:83], v11, s[24:27], s54 offen offset:0 sc1
    v_mfma_f32_16x16x32_bf16 v[132:135], a[204:207], a[8:11], v[132:135]
    ds_read_b64_tr_b16 a[196:197], v243 offset:51392
    ds_read_b64_tr_b16 a[198:199], v243 offset:56512
    v_mfma_f32_16x16x32_bf16 v[140:143], a[204:207], a[12:15], v[140:143]
    s_waitcnt lgkmcnt(8)
    v_mfma_f32_16x16x32_bf16 v[144:147], a[208:211], a[8:11], v[144:147]
    ds_read_b64_tr_b16 a[200:201], v242 offset:51456
    ds_read_b64_tr_b16 a[202:203], v242 offset:56576
    v_mfma_f32_16x16x32_bf16 v[152:155], a[208:211], a[12:15], v[152:155]
    buffer_load_dwordx4 a[84:87], v11, s[24:27], s54 offen offset:1024 sc1
    v_mfma_f32_16x16x32_bf16 v[148:151], a[212:215], a[8:11], v[148:151]
    ds_read_b64_tr_b16 a[204:205], v243 offset:51456
    ds_read_b64_tr_b16 a[206:207], v243 offset:56576
    v_mfma_f32_16x16x32_bf16 v[156:159], a[212:215], a[12:15], v[156:159]
    s_waitcnt lgkmcnt(8)
    v_mfma_f32_16x16x32_bf16 v[160:163], a[216:219], a[8:11], v[160:163]
    ds_read_b64_tr_b16 a[208:209], v244 offset:0
    ds_read_b64_tr_b16 a[210:211], v244 offset:5120
    v_mfma_f32_16x16x32_bf16 v[168:171], a[216:219], a[12:15], v[168:171]
    v_mfma_f32_16x16x32_bf16 v[164:167], a[220:223], a[8:11], v[164:167]
    s_mov_b32 s54, 40960
    ds_read_b64_tr_b16 a[212:213], v245 offset:0
    ds_read_b64_tr_b16 a[214:215], v245 offset:5120
    v_mfma_f32_16x16x32_bf16 v[172:175], a[220:223], a[12:15], v[172:175]
    s_waitcnt lgkmcnt(8)
    buffer_load_dwordx4 a[88:91], v11, s[24:27], s54 offen offset:0 sc1
    v_mfma_f32_16x16x32_bf16 v[176:179], a[192:195], a[8:11], v[176:179]
    ds_read_b64_tr_b16 a[216:217], v244 offset:64
    ds_read_b64_tr_b16 a[218:219], v244 offset:5184
    v_mfma_f32_16x16x32_bf16 v[184:187], a[192:195], a[12:15], v[184:187]
    v_mfma_f32_16x16x32_bf16 v[180:183], a[196:199], a[8:11], v[180:183]
    ds_read_b64_tr_b16 a[220:221], v245 offset:64
    ds_read_b64_tr_b16 a[222:223], v245 offset:5184
    v_mfma_f32_16x16x32_bf16 v[188:191], a[196:199], a[12:15], v[188:191]
    s_waitcnt lgkmcnt(8)
    buffer_load_dwordx4 a[92:95], v11, s[24:27], s54 offen offset:1024 sc1
    v_mfma_f32_16x16x32_bf16 v[192:195], a[200:203], a[8:11], v[192:195]
    ds_read_b64_tr_b16 a[192:193], v244 offset:128
    ds_read_b64_tr_b16 a[194:195], v244 offset:5248
    v_mfma_f32_16x16x32_bf16 v[200:203], a[200:203], a[12:15], v[200:203]
    v_mfma_f32_16x16x32_bf16 v[196:199], a[204:207], a[8:11], v[196:199]
    ds_read_b64_tr_b16 a[196:197], v245 offset:128
    ds_read_b64_tr_b16 a[198:199], v245 offset:5248
    v_mfma_f32_16x16x32_bf16 v[204:207], a[204:207], a[12:15], v[204:207]
    s_waitcnt vmcnt(18) lgkmcnt(8)
    v_mfma_f32_16x16x32_bf16 v[128:131], a[208:211], a[16:19], v[128:131]
    s_mov_b32 s54, 49152
    ds_read_b64_tr_b16 a[200:201], v244 offset:192
    ds_read_b64_tr_b16 a[202:203], v244 offset:5312
    v_mfma_f32_16x16x32_bf16 v[136:139], a[208:211], a[20:23], v[136:139]
    buffer_load_dwordx4 a[96:99], v11, s[24:27], s54 offen offset:0 sc1
    v_mfma_f32_16x16x32_bf16 v[132:135], a[212:215], a[16:19], v[132:135]
    ds_read_b64_tr_b16 a[204:205], v245 offset:192
    ds_read_b64_tr_b16 a[206:207], v245 offset:5312
    v_mfma_f32_16x16x32_bf16 v[140:143], a[212:215], a[20:23], v[140:143]
    s_waitcnt lgkmcnt(8)
    v_mfma_f32_16x16x32_bf16 v[144:147], a[216:219], a[16:19], v[144:147]
    ds_read_b64_tr_b16 a[208:209], v244 offset:256
    ds_read_b64_tr_b16 a[210:211], v244 offset:5376
    v_mfma_f32_16x16x32_bf16 v[152:155], a[216:219], a[20:23], v[152:155]
    s_barrier
    v_mfma_f32_16x16x32_bf16 v[148:151], a[220:223], a[16:19], v[148:151]
    ds_read_b64_tr_b16 a[212:213], v245 offset:256
    ds_read_b64_tr_b16 a[214:215], v245 offset:5376
    v_mfma_f32_16x16x32_bf16 v[156:159], a[220:223], a[20:23], v[156:159]
    s_waitcnt lgkmcnt(8)
    buffer_load_dwordx4 a[100:103], v11, s[24:27], s54 offen offset:1024 sc1
    v_mfma_f32_16x16x32_bf16 v[160:163], a[192:195], a[16:19], v[160:163]
    ds_read_b64_tr_b16 a[216:217], v244 offset:10240
    ds_read_b64_tr_b16 a[218:219], v244 offset:15360
    v_mfma_f32_16x16x32_bf16 v[168:171], a[192:195], a[20:23], v[168:171]
    v_mfma_f32_16x16x32_bf16 v[164:167], a[196:199], a[16:19], v[164:167]
    s_mov_b32 s54, 51200
    ds_read_b64_tr_b16 a[220:221], v245 offset:10240
    ds_read_b64_tr_b16 a[222:223], v245 offset:15360
    v_mfma_f32_16x16x32_bf16 v[172:175], a[196:199], a[20:23], v[172:175]
    s_waitcnt lgkmcnt(8)
    buffer_load_dwordx4 a[104:107], v11, s[24:27], s54 offen offset:0 sc1
    v_mfma_f32_16x16x32_bf16 v[176:179], a[200:203], a[16:19], v[176:179]
    ds_read_b64_tr_b16 a[192:193], v244 offset:10304
    ds_read_b64_tr_b16 a[194:195], v244 offset:15424
    v_mfma_f32_16x16x32_bf16 v[184:187], a[200:203], a[20:23], v[184:187]
    v_mfma_f32_16x16x32_bf16 v[180:183], a[204:207], a[16:19], v[180:183]
    ds_read_b64_tr_b16 a[196:197], v245 offset:10304
    ds_read_b64_tr_b16 a[198:199], v245 offset:15424
    v_mfma_f32_16x16x32_bf16 v[188:191], a[204:207], a[20:23], v[188:191]
    s_waitcnt lgkmcnt(8)
    buffer_load_dwordx4 a[108:111], v11, s[24:27], s54 offen offset:1024 sc1
    v_mfma_f32_16x16x32_bf16 v[192:195], a[208:211], a[16:19], v[192:195]
    ds_read_b64_tr_b16 a[200:201], v244 offset:10368
    ds_read_b64_tr_b16 a[202:203], v244 offset:15488
    v_mfma_f32_16x16x32_bf16 v[200:203], a[208:211], a[20:23], v[200:203]
    v_mfma_f32_16x16x32_bf16 v[196:199], a[212:215], a[16:19], v[196:199]
    ds_read_b64_tr_b16 a[204:205], v245 offset:10368
    ds_read_b64_tr_b16 a[206:207], v245 offset:15488
    v_mfma_f32_16x16x32_bf16 v[204:207], a[212:215], a[20:23], v[204:207]
    s_waitcnt vmcnt(20) lgkmcnt(8)
    v_mfma_f32_16x16x32_bf16 v[128:131], a[216:219], a[24:27], v[128:131]
    s_mov_b32 s54, 53248
    ds_read_b64_tr_b16 a[208:209], v244 offset:10432
    ds_read_b64_tr_b16 a[210:211], v244 offset:15552
    v_mfma_f32_16x16x32_bf16 v[136:139], a[216:219], a[28:31], v[136:139]
    buffer_load_dwordx4 a[112:115], v11, s[24:27], s54 offen offset:0 sc1
    v_mfma_f32_16x16x32_bf16 v[132:135], a[220:223], a[24:27], v[132:135]
    ds_read_b64_tr_b16 a[212:213], v245 offset:10432
    ds_read_b64_tr_b16 a[214:215], v245 offset:15552
    v_mfma_f32_16x16x32_bf16 v[140:143], a[220:223], a[28:31], v[140:143]
    s_waitcnt lgkmcnt(8)
    v_mfma_f32_16x16x32_bf16 v[144:147], a[192:195], a[24:27], v[144:147]
    ds_read_b64_tr_b16 a[216:217], v244 offset:10496
    ds_read_b64_tr_b16 a[218:219], v244 offset:15616
    v_mfma_f32_16x16x32_bf16 v[152:155], a[192:195], a[28:31], v[152:155]
    buffer_load_dwordx4 a[116:119], v11, s[24:27], s54 offen offset:1024 sc1
    v_mfma_f32_16x16x32_bf16 v[148:151], a[196:199], a[24:27], v[148:151]
    ds_read_b64_tr_b16 a[220:221], v245 offset:10496
    ds_read_b64_tr_b16 a[222:223], v245 offset:15616
    v_mfma_f32_16x16x32_bf16 v[156:159], a[196:199], a[28:31], v[156:159]
    s_waitcnt lgkmcnt(8)
    v_mfma_f32_16x16x32_bf16 v[160:163], a[200:203], a[24:27], v[160:163]
    ds_read_b64_tr_b16 a[192:193], v244 offset:20480
    ds_read_b64_tr_b16 a[194:195], v244 offset:25600
    v_mfma_f32_16x16x32_bf16 v[168:171], a[200:203], a[28:31], v[168:171]
    v_mfma_f32_16x16x32_bf16 v[164:167], a[204:207], a[24:27], v[164:167]
    s_mov_b32 s54, 61440
    ds_read_b64_tr_b16 a[196:197], v245 offset:20480
    ds_read_b64_tr_b16 a[198:199], v245 offset:25600
    v_mfma_f32_16x16x32_bf16 v[172:175], a[204:207], a[28:31], v[172:175]
    s_waitcnt lgkmcnt(8)
    buffer_load_dwordx4 a[120:123], v11, s[24:27], s54 offen offset:0 sc1
    v_mfma_f32_16x16x32_bf16 v[176:179], a[208:211], a[24:27], v[176:179]
    ds_read_b64_tr_b16 a[200:201], v244 offset:20544
    ds_read_b64_tr_b16 a[202:203], v244 offset:25664
    v_mfma_f32_16x16x32_bf16 v[184:187], a[208:211], a[28:31], v[184:187]
    v_mfma_f32_16x16x32_bf16 v[180:183], a[212:215], a[24:27], v[180:183]
    ds_read_b64_tr_b16 a[204:205], v245 offset:20544
    ds_read_b64_tr_b16 a[206:207], v245 offset:25664
    v_mfma_f32_16x16x32_bf16 v[188:191], a[212:215], a[28:31], v[188:191]
    s_waitcnt lgkmcnt(8)
    s_add_u32 m0, s47, 102400
    s_add_u32 s53, s42, 1269760
    v_mfma_f32_16x16x32_bf16 v[192:195], a[216:219], a[24:27], v[192:195]
    ds_read_b64_tr_b16 a[208:209], v244 offset:20608
    ds_read_b64_tr_b16 a[210:211], v244 offset:25728
    v_mfma_f32_16x16x32_bf16 v[200:203], a[216:219], a[28:31], v[200:203]
    buffer_load_dwordx4 v12, s[20:23], s53 offen offset:0 lds
    v_mfma_f32_16x16x32_bf16 v[196:199], a[220:223], a[24:27], v[196:199]
    ds_read_b64_tr_b16 a[212:213], v245 offset:20608
    ds_read_b64_tr_b16 a[214:215], v245 offset:25728
    v_mfma_f32_16x16x32_bf16 v[204:207], a[220:223], a[28:31], v[204:207]
    s_waitcnt vmcnt(22) lgkmcnt(8)
    v_mfma_f32_16x16x32_bf16 v[128:131], a[192:195], a[32:35], v[128:131]
    s_mov_b32 s3, 4096
    ds_read_b64_tr_b16 a[216:217], v244 offset:20672
    ds_read_b64_tr_b16 a[218:219], v244 offset:25792
    v_mfma_f32_16x16x32_bf16 v[136:139], a[192:195], a[36:39], v[136:139]
    buffer_store_dwordx4 v[64:67], v10, s[36:39], s3 offen offset:2048 sc1
    v_mfma_f32_16x16x32_bf16 v[132:135], a[196:199], a[32:35], v[132:135]
    ds_read_b64_tr_b16 a[220:221], v245 offset:20672
    ds_read_b64_tr_b16 a[222:223], v245 offset:25792
    v_mfma_f32_16x16x32_bf16 v[140:143], a[196:199], a[36:39], v[140:143]
    s_waitcnt lgkmcnt(8)
    v_mfma_f32_16x16x32_bf16 v[144:147], a[200:203], a[32:35], v[144:147]
    ds_read_b64_tr_b16 a[192:193], v244 offset:20736
    ds_read_b64_tr_b16 a[194:195], v244 offset:25856
    v_mfma_f32_16x16x32_bf16 v[152:155], a[200:203], a[36:39], v[152:155]
    s_barrier
    v_mfma_f32_16x16x32_bf16 v[148:151], a[204:207], a[32:35], v[148:151]
    ds_read_b64_tr_b16 a[196:197], v245 offset:20736
    ds_read_b64_tr_b16 a[198:199], v245 offset:25856
    v_mfma_f32_16x16x32_bf16 v[156:159], a[204:207], a[36:39], v[156:159]
    s_waitcnt lgkmcnt(8)
    buffer_load_dwordx4 v13, s[20:23], s53 offen offset:1024 lds
    v_mfma_f32_16x16x32_bf16 v[160:163], a[208:211], a[32:35], v[160:163]
    ds_read_b64_tr_b16 a[200:201], v244 offset:30720
    ds_read_b64_tr_b16 a[202:203], v244 offset:35840
    v_mfma_f32_16x16x32_bf16 v[168:171], a[208:211], a[36:39], v[168:171]
    v_mfma_f32_16x16x32_bf16 v[164:167], a[212:215], a[32:35], v[164:167]
    ds_read_b64_tr_b16 a[204:205], v245 offset:30720
    ds_read_b64_tr_b16 a[206:207], v245 offset:35840
    v_mfma_f32_16x16x32_bf16 v[172:175], a[212:215], a[36:39], v[172:175]
    s_waitcnt lgkmcnt(8)
    buffer_load_dwordx4 v14, s[20:23], s53 offen offset:2048 lds
    v_mfma_f32_16x16x32_bf16 v[176:179], a[216:219], a[32:35], v[176:179]
    ds_read_b64_tr_b16 a[208:209], v244 offset:30784
    ds_read_b64_tr_b16 a[210:211], v244 offset:35904
    v_mfma_f32_16x16x32_bf16 v[184:187], a[216:219], a[36:39], v[184:187]
    v_mfma_f32_16x16x32_bf16 v[180:183], a[220:223], a[32:35], v[180:183]
    ds_read_b64_tr_b16 a[212:213], v245 offset:30784
    ds_read_b64_tr_b16 a[214:215], v245 offset:35904
    v_mfma_f32_16x16x32_bf16 v[188:191], a[220:223], a[36:39], v[188:191]
    s_waitcnt lgkmcnt(8)
    s_mov_b32 s3, 4096
    v_mfma_f32_16x16x32_bf16 v[192:195], a[192:195], a[32:35], v[192:195]
    ds_read_b64_tr_b16 a[216:217], v244 offset:30848
    ds_read_b64_tr_b16 a[218:219], v244 offset:35968
    v_mfma_f32_16x16x32_bf16 v[200:203], a[192:195], a[36:39], v[200:203]
    buffer_store_dwordx4 v[68:71], v10, s[36:39], s3 offen offset:3072 sc1
    v_mfma_f32_16x16x32_bf16 v[196:199], a[196:199], a[32:35], v[196:199]
    ds_read_b64_tr_b16 a[220:221], v245 offset:30848
    ds_read_b64_tr_b16 a[222:223], v245 offset:35968
    v_mfma_f32_16x16x32_bf16 v[204:207], a[196:199], a[36:39], v[204:207]
    s_waitcnt vmcnt(24) lgkmcnt(8)
    v_mfma_f32_16x16x32_bf16 v[128:131], a[200:203], a[40:43], v[128:131]
    ds_read_b64_tr_b16 a[192:193], v244 offset:30912
    ds_read_b64_tr_b16 a[194:195], v244 offset:36032
    v_mfma_f32_16x16x32_bf16 v[136:139], a[200:203], a[44:47], v[136:139]
    buffer_load_dwordx4 v15, s[20:23], s53 offen offset:3072 lds
    v_mfma_f32_16x16x32_bf16 v[132:135], a[204:207], a[40:43], v[132:135]
    ds_read_b64_tr_b16 a[196:197], v245 offset:30912
    ds_read_b64_tr_b16 a[198:199], v245 offset:36032
    v_mfma_f32_16x16x32_bf16 v[140:143], a[204:207], a[44:47], v[140:143]
    s_waitcnt lgkmcnt(8)
    v_mfma_f32_16x16x32_bf16 v[144:147], a[208:211], a[40:43], v[144:147]
    ds_read_b64_tr_b16 a[200:201], v244 offset:30976
    ds_read_b64_tr_b16 a[202:203], v244 offset:36096
    v_mfma_f32_16x16x32_bf16 v[152:155], a[208:211], a[44:47], v[152:155]
    s_mov_b32 s3, 397312
    buffer_store_dwordx4 v[72:75], v10, s[36:39], s3 offen offset:2048 sc1
    v_mfma_f32_16x16x32_bf16 v[148:151], a[212:215], a[40:43], v[148:151]
    ds_read_b64_tr_b16 a[204:205], v245 offset:30976
    ds_read_b64_tr_b16 a[206:207], v245 offset:36096
    v_mfma_f32_16x16x32_bf16 v[156:159], a[212:215], a[44:47], v[156:159]
    s_waitcnt lgkmcnt(8)
    v_mfma_f32_16x16x32_bf16 v[160:163], a[216:219], a[40:43], v[160:163]
    ds_read_b64_tr_b16 a[208:209], v240 offset:40960
    ds_read_b64_tr_b16 a[210:211], v240 offset:46080
    v_mfma_f32_16x16x32_bf16 v[168:171], a[216:219], a[44:47], v[168:171]
    v_mfma_f32_16x16x32_bf16 v[164:167], a[220:223], a[40:43], v[164:167]
    s_add_u32 m0, s47, 106496
    ds_read_b64_tr_b16 a[212:213], v241 offset:40960
    ds_read_b64_tr_b16 a[214:215], v241 offset:46080
    v_mfma_f32_16x16x32_bf16 v[172:175], a[220:223], a[44:47], v[172:175]
    s_waitcnt lgkmcnt(8)
    buffer_load_dwordx4 v16, s[20:23], s53 offen offset:0 lds
    v_mfma_f32_16x16x32_bf16 v[176:179], a[192:195], a[40:43], v[176:179]
    ds_read_b64_tr_b16 a[216:217], v240 offset:41024
    ds_read_b64_tr_b16 a[218:219], v240 offset:46144
    v_mfma_f32_16x16x32_bf16 v[184:187], a[192:195], a[44:47], v[184:187]
    v_mfma_f32_16x16x32_bf16 v[180:183], a[196:199], a[40:43], v[180:183]
    ds_read_b64_tr_b16 a[220:221], v241 offset:41024
    ds_read_b64_tr_b16 a[222:223], v241 offset:46144
    v_mfma_f32_16x16x32_bf16 v[188:191], a[196:199], a[44:47], v[188:191]
    s_waitcnt lgkmcnt(8)
    buffer_load_dwordx4 a[124:127], v11, s[24:27], s54 offen offset:1024 sc1
    v_mfma_f32_16x16x32_bf16 v[192:195], a[200:203], a[40:43], v[192:195]
    ds_read_b64_tr_b16 a[192:193], v240 offset:41088
    ds_read_b64_tr_b16 a[194:195], v240 offset:46208
    v_mfma_f32_16x16x32_bf16 v[200:203], a[200:203], a[44:47], v[200:203]
    v_mfma_f32_16x16x32_bf16 v[196:199], a[204:207], a[40:43], v[196:199]
    ds_read_b64_tr_b16 a[196:197], v241 offset:41088
    ds_read_b64_tr_b16 a[198:199], v241 offset:46208
    v_mfma_f32_16x16x32_bf16 v[204:207], a[204:207], a[44:47], v[204:207]
    s_waitcnt vmcnt(26) lgkmcnt(8)
    v_mfma_f32_16x16x32_bf16 v[128:131], a[208:211], a[48:51], v[128:131]
    s_mov_b32 s3, 397312
    ds_read_b64_tr_b16 a[200:201], v240 offset:41152
    ds_read_b64_tr_b16 a[202:203], v240 offset:46272
    v_mfma_f32_16x16x32_bf16 v[136:139], a[208:211], a[52:55], v[136:139]
    buffer_store_dwordx4 v[76:79], v10, s[36:39], s3 offen offset:3072 sc1
    v_mfma_f32_16x16x32_bf16 v[132:135], a[212:215], a[48:51], v[132:135]
    ds_read_b64_tr_b16 a[204:205], v241 offset:41152
    ds_read_b64_tr_b16 a[206:207], v241 offset:46272
    v_mfma_f32_16x16x32_bf16 v[140:143], a[212:215], a[52:55], v[140:143]
    s_waitcnt lgkmcnt(8)
    v_mfma_f32_16x16x32_bf16 v[144:147], a[216:219], a[48:51], v[144:147]
    ds_read_b64_tr_b16 a[208:209], v240 offset:41216
    ds_read_b64_tr_b16 a[210:211], v240 offset:46336
    v_mfma_f32_16x16x32_bf16 v[152:155], a[216:219], a[52:55], v[152:155]
    s_barrier
    s_mov_b32 s54, 63488
    v_mfma_f32_16x16x32_bf16 v[148:151], a[220:223], a[48:51], v[148:151]
    ds_read_b64_tr_b16 a[212:213], v241 offset:41216
    ds_read_b64_tr_b16 a[214:215], v241 offset:46336
    v_mfma_f32_16x16x32_bf16 v[156:159], a[220:223], a[52:55], v[156:159]
    s_waitcnt lgkmcnt(8)
    buffer_load_dwordx4 a[128:131], v11, s[24:27], s54 offen offset:0 sc1
    v_mfma_f32_16x16x32_bf16 v[160:163], a[192:195], a[48:51], v[160:163]
    ds_read_b64_tr_b16 a[216:217], v240 offset:51200
    ds_read_b64_tr_b16 a[218:219], v240 offset:56320
    v_mfma_f32_16x16x32_bf16 v[168:171], a[192:195], a[52:55], v[168:171]
    v_mfma_f32_16x16x32_bf16 v[164:167], a[196:199], a[48:51], v[164:167]
    s_mov_b32 s3, 8192
    ds_read_b64_tr_b16 a[220:221], v241 offset:51200
    ds_read_b64_tr_b16 a[222:223], v241 offset:56320
    v_mfma_f32_16x16x32_bf16 v[172:175], a[196:199], a[52:55], v[172:175]
    s_waitcnt lgkmcnt(8)
    buffer_store_dwordx4 v[80:83], v10, s[36:39], s3 offen offset:0 sc1
    v_mfma_f32_16x16x32_bf16 v[176:179], a[200:203], a[48:51], v[176:179]
    ds_read_b64_tr_b16 a[192:193], v240 offset:51264
    ds_read_b64_tr_b16 a[194:195], v240 offset:56384
    v_mfma_f32_16x16x32_bf16 v[184:187], a[200:203], a[52:55], v[184:187]
    v_mfma_f32_16x16x32_bf16 v[180:183], a[204:207], a[48:51], v[180:183]
    ds_read_b64_tr_b16 a[196:197], v241 offset:51264
    ds_read_b64_tr_b16 a[198:199], v241 offset:56384
    v_mfma_f32_16x16x32_bf16 v[188:191], a[204:207], a[52:55], v[188:191]
    s_waitcnt lgkmcnt(8)
    buffer_load_dwordx4 a[132:135], v11, s[24:27], s54 offen offset:1024 sc1
    v_mfma_f32_16x16x32_bf16 v[192:195], a[208:211], a[48:51], v[192:195]
    ds_read_b64_tr_b16 a[200:201], v240 offset:51328
    ds_read_b64_tr_b16 a[202:203], v240 offset:56448
    v_mfma_f32_16x16x32_bf16 v[200:203], a[208:211], a[52:55], v[200:203]
    v_mfma_f32_16x16x32_bf16 v[196:199], a[212:215], a[48:51], v[196:199]
    ds_read_b64_tr_b16 a[204:205], v241 offset:51328
    ds_read_b64_tr_b16 a[206:207], v241 offset:56448
    v_mfma_f32_16x16x32_bf16 v[204:207], a[212:215], a[52:55], v[204:207]
    s_waitcnt vmcnt(28) lgkmcnt(8)
    v_mfma_f32_16x16x32_bf16 v[128:131], a[216:219], a[56:59], v[128:131]
    s_mov_b32 s3, 8192
    ds_read_b64_tr_b16 a[208:209], v240 offset:51392
    ds_read_b64_tr_b16 a[210:211], v240 offset:56512
    v_mfma_f32_16x16x32_bf16 v[136:139], a[216:219], a[60:63], v[136:139]
    buffer_store_dwordx4 v[84:87], v10, s[36:39], s3 offen offset:1024 sc1
    v_mfma_f32_16x16x32_bf16 v[132:135], a[220:223], a[56:59], v[132:135]
    ds_read_b64_tr_b16 a[212:213], v241 offset:51392
    ds_read_b64_tr_b16 a[214:215], v241 offset:56512
    v_mfma_f32_16x16x32_bf16 v[140:143], a[220:223], a[60:63], v[140:143]
    s_waitcnt lgkmcnt(8)
    v_mfma_f32_16x16x32_bf16 v[144:147], a[192:195], a[56:59], v[144:147]
    ds_read_b64_tr_b16 a[216:217], v240 offset:51456
    ds_read_b64_tr_b16 a[218:219], v240 offset:56576
    v_mfma_f32_16x16x32_bf16 v[152:155], a[192:195], a[60:63], v[152:155]
    s_mov_b32 s54, 65536
    buffer_load_dwordx4 a[136:139], v11, s[24:27], s54 offen offset:0 sc1
    v_mfma_f32_16x16x32_bf16 v[148:151], a[196:199], a[56:59], v[148:151]
    ds_read_b64_tr_b16 a[220:221], v241 offset:51456
    ds_read_b64_tr_b16 a[222:223], v241 offset:56576
    v_mfma_f32_16x16x32_bf16 v[156:159], a[196:199], a[60:63], v[156:159]
    s_waitcnt lgkmcnt(8)
    v_mfma_f32_16x16x32_bf16 v[160:163], a[200:203], a[56:59], v[160:163]
    ds_read_b64_tr_b16 a[192:193], v242 offset:0
    ds_read_b64_tr_b16 a[194:195], v242 offset:5120
    v_mfma_f32_16x16x32_bf16 v[168:171], a[200:203], a[60:63], v[168:171]
    v_mfma_f32_16x16x32_bf16 v[164:167], a[204:207], a[56:59], v[164:167]
    s_add_u32 m0, s47, 122880
    ds_read_b64_tr_b16 a[196:197], v243 offset:0
    ds_read_b64_tr_b16 a[198:199], v243 offset:5120
    v_mfma_f32_16x16x32_bf16 v[172:175], a[204:207], a[60:63], v[172:175]
    s_waitcnt lgkmcnt(8)
    s_add_u32 s53, s42, 1474560
    v_mfma_f32_16x16x32_bf16 v[176:179], a[208:211], a[56:59], v[176:179]
    ds_read_b64_tr_b16 a[200:201], v242 offset:64
    ds_read_b64_tr_b16 a[202:203], v242 offset:5184
    v_mfma_f32_16x16x32_bf16 v[184:187], a[208:211], a[60:63], v[184:187]
    buffer_load_dwordx4 v12, s[20:23], s53 offen offset:0 lds
    v_mfma_f32_16x16x32_bf16 v[180:183], a[212:215], a[56:59], v[180:183]
    ds_read_b64_tr_b16 a[204:205], v243 offset:64
    ds_read_b64_tr_b16 a[206:207], v243 offset:5184
    v_mfma_f32_16x16x32_bf16 v[188:191], a[212:215], a[60:63], v[188:191]
    s_waitcnt lgkmcnt(8)
    s_mov_b32 s3, 401408
    v_mfma_f32_16x16x32_bf16 v[192:195], a[216:219], a[56:59], v[192:195]
    ds_read_b64_tr_b16 a[208:209], v242 offset:128
    ds_read_b64_tr_b16 a[210:211], v242 offset:5248
    v_mfma_f32_16x16x32_bf16 v[200:203], a[216:219], a[60:63], v[200:203]
    buffer_store_dwordx4 v[88:91], v10, s[36:39], s3 offen offset:0 sc1
    v_mfma_f32_16x16x32_bf16 v[196:199], a[220:223], a[56:59], v[196:199]
    ds_read_b64_tr_b16 a[212:213], v243 offset:128
    ds_read_b64_tr_b16 a[214:215], v243 offset:5248
    v_mfma_f32_16x16x32_bf16 v[204:207], a[220:223], a[60:63], v[204:207]
    s_waitcnt vmcnt(30) lgkmcnt(8)
    v_mfma_f32_16x16x32_bf16 v[128:131], a[192:195], a[64:67], v[128:131]
    ds_read_b64_tr_b16 a[216:217], v242 offset:192
    ds_read_b64_tr_b16 a[218:219], v242 offset:5312
    v_mfma_f32_16x16x32_bf16 v[136:139], a[192:195], a[68:71], v[136:139]
    buffer_load_dwordx4 v13, s[20:23], s53 offen offset:1024 lds
    v_mfma_f32_16x16x32_bf16 v[132:135], a[196:199], a[64:67], v[132:135]
    ds_read_b64_tr_b16 a[220:221], v243 offset:192
    ds_read_b64_tr_b16 a[222:223], v243 offset:5312
    v_mfma_f32_16x16x32_bf16 v[140:143], a[196:199], a[68:71], v[140:143]
    s_waitcnt lgkmcnt(8)
    v_mfma_f32_16x16x32_bf16 v[144:147], a[200:203], a[64:67], v[144:147]
    ds_read_b64_tr_b16 a[192:193], v242 offset:256
    ds_read_b64_tr_b16 a[194:195], v242 offset:5376
    v_mfma_f32_16x16x32_bf16 v[152:155], a[200:203], a[68:71], v[152:155]
    s_barrier
    s_mov_b32 s3, 401408
    v_mfma_f32_16x16x32_bf16 v[148:151], a[204:207], a[64:67], v[148:151]
    ds_read_b64_tr_b16 a[196:197], v243 offset:256
    ds_read_b64_tr_b16 a[198:199], v243 offset:5376
    v_mfma_f32_16x16x32_bf16 v[156:159], a[204:207], a[68:71], v[156:159]
    s_waitcnt lgkmcnt(8)
    buffer_store_dwordx4 v[92:95], v10, s[36:39], s3 offen offset:1024 sc1
    v_mfma_f32_16x16x32_bf16 v[160:163], a[208:211], a[64:67], v[160:163]
    ds_read_b64_tr_b16 a[200:201], v242 offset:10240
    ds_read_b64_tr_b16 a[202:203], v242 offset:15360
    v_mfma_f32_16x16x32_bf16 v[168:171], a[208:211], a[68:71], v[168:171]
    v_mfma_f32_16x16x32_bf16 v[164:167], a[212:215], a[64:67], v[164:167]
    ds_read_b64_tr_b16 a[204:205], v243 offset:10240
    ds_read_b64_tr_b16 a[206:207], v243 offset:15360
    v_mfma_f32_16x16x32_bf16 v[172:175], a[212:215], a[68:71], v[172:175]
    s_waitcnt lgkmcnt(8)
    buffer_load_dwordx4 v14, s[20:23], s53 offen offset:2048 lds
    v_mfma_f32_16x16x32_bf16 v[176:179], a[216:219], a[64:67], v[176:179]
    ds_read_b64_tr_b16 a[208:209], v242 offset:10304
    ds_read_b64_tr_b16 a[210:211], v242 offset:15424
    v_mfma_f32_16x16x32_bf16 v[184:187], a[216:219], a[68:71], v[184:187]
    v_mfma_f32_16x16x32_bf16 v[180:183], a[220:223], a[64:67], v[180:183]
    ds_read_b64_tr_b16 a[212:213], v243 offset:10304
    ds_read_b64_tr_b16 a[214:215], v243 offset:15424
    v_mfma_f32_16x16x32_bf16 v[188:191], a[220:223], a[68:71], v[188:191]
    s_waitcnt lgkmcnt(8)
    buffer_load_dwordx4 v15, s[20:23], s53 offen offset:3072 lds
    v_mfma_f32_16x16x32_bf16 v[192:195], a[192:195], a[64:67], v[192:195]
    ds_read_b64_tr_b16 a[216:217], v242 offset:10368
    ds_read_b64_tr_b16 a[218:219], v242 offset:15488
    v_mfma_f32_16x16x32_bf16 v[200:203], a[192:195], a[68:71], v[200:203]
    v_mfma_f32_16x16x32_bf16 v[196:199], a[196:199], a[64:67], v[196:199]
    ds_read_b64_tr_b16 a[220:221], v243 offset:10368
    ds_read_b64_tr_b16 a[222:223], v243 offset:15488
    v_mfma_f32_16x16x32_bf16 v[204:207], a[196:199], a[68:71], v[204:207]
    s_waitcnt vmcnt(32) lgkmcnt(8)
    v_mfma_f32_16x16x32_bf16 v[128:131], a[200:203], a[72:75], v[128:131]
    s_mov_b32 s3, 8192
    ds_read_b64_tr_b16 a[192:193], v242 offset:10432
    ds_read_b64_tr_b16 a[194:195], v242 offset:15552
    v_mfma_f32_16x16x32_bf16 v[136:139], a[200:203], a[76:79], v[136:139]
    buffer_store_dwordx4 v[96:99], v10, s[36:39], s3 offen offset:2048 sc1
    v_mfma_f32_16x16x32_bf16 v[132:135], a[204:207], a[72:75], v[132:135]
    ds_read_b64_tr_b16 a[196:197], v243 offset:10432
    ds_read_b64_tr_b16 a[198:199], v243 offset:15552
    v_mfma_f32_16x16x32_bf16 v[140:143], a[204:207], a[76:79], v[140:143]
    s_waitcnt lgkmcnt(8)
    v_mfma_f32_16x16x32_bf16 v[144:147], a[208:211], a[72:75], v[144:147]
    ds_read_b64_tr_b16 a[200:201], v242 offset:10496
    ds_read_b64_tr_b16 a[202:203], v242 offset:15616
    v_mfma_f32_16x16x32_bf16 v[152:155], a[208:211], a[76:79], v[152:155]
    s_add_u32 m0, s47, 126976
    s_nop 0
    buffer_load_dwordx4 v16, s[20:23], s53 offen offset:0 lds
    v_mfma_f32_16x16x32_bf16 v[148:151], a[212:215], a[72:75], v[148:151]
    ds_read_b64_tr_b16 a[204:205], v243 offset:10496
    ds_read_b64_tr_b16 a[206:207], v243 offset:15616
    v_mfma_f32_16x16x32_bf16 v[156:159], a[212:215], a[76:79], v[156:159]
    s_waitcnt lgkmcnt(8)
    v_mfma_f32_16x16x32_bf16 v[160:163], a[216:219], a[72:75], v[160:163]
    ds_read_b64_tr_b16 a[208:209], v242 offset:20480
    ds_read_b64_tr_b16 a[210:211], v242 offset:25600
    v_mfma_f32_16x16x32_bf16 v[168:171], a[216:219], a[76:79], v[168:171]
    v_mfma_f32_16x16x32_bf16 v[164:167], a[220:223], a[72:75], v[164:167]
    s_mov_b32 s3, 8192
    ds_read_b64_tr_b16 a[212:213], v243 offset:20480
    ds_read_b64_tr_b16 a[214:215], v243 offset:25600
    v_mfma_f32_16x16x32_bf16 v[172:175], a[220:223], a[76:79], v[172:175]
    s_waitcnt lgkmcnt(8)
    buffer_store_dwordx4 v[100:103], v10, s[36:39], s3 offen offset:3072 sc1
    v_mfma_f32_16x16x32_bf16 v[176:179], a[192:195], a[72:75], v[176:179]
    ds_read_b64_tr_b16 a[216:217], v242 offset:20544
    ds_read_b64_tr_b16 a[218:219], v242 offset:25664
    v_mfma_f32_16x16x32_bf16 v[184:187], a[192:195], a[76:79], v[184:187]
    v_mfma_f32_16x16x32_bf16 v[180:183], a[196:199], a[72:75], v[180:183]
    ds_read_b64_tr_b16 a[220:221], v243 offset:20544
    ds_read_b64_tr_b16 a[222:223], v243 offset:25664
    v_mfma_f32_16x16x32_bf16 v[188:191], a[196:199], a[76:79], v[188:191]
    s_waitcnt lgkmcnt(8)
    buffer_load_dwordx4 a[140:143], v11, s[24:27], s54 offen offset:1024 sc1
    v_mfma_f32_16x16x32_bf16 v[192:195], a[200:203], a[72:75], v[192:195]
    ds_read_b64_tr_b16 a[192:193], v242 offset:20608
    ds_read_b64_tr_b16 a[194:195], v242 offset:25728
    v_mfma_f32_16x16x32_bf16 v[200:203], a[200:203], a[76:79], v[200:203]
    v_mfma_f32_16x16x32_bf16 v[196:199], a[204:207], a[72:75], v[196:199]
    ds_read_b64_tr_b16 a[196:197], v243 offset:20608
    ds_read_b64_tr_b16 a[198:199], v243 offset:25728
    v_mfma_f32_16x16x32_bf16 v[204:207], a[204:207], a[76:79], v[204:207]
    s_waitcnt vmcnt(34) lgkmcnt(8)
    v_mfma_f32_16x16x32_bf16 v[128:131], a[208:211], a[80:83], v[128:131]
    s_mov_b32 s3, 401408
    ds_read_b64_tr_b16 a[200:201], v242 offset:20672
    ds_read_b64_tr_b16 a[202:203], v242 offset:25792
    v_mfma_f32_16x16x32_bf16 v[136:139], a[208:211], a[84:87], v[136:139]
    buffer_store_dwordx4 v[104:107], v10, s[36:39], s3 offen offset:2048 sc1
    v_mfma_f32_16x16x32_bf16 v[132:135], a[212:215], a[80:83], v[132:135]
    ds_read_b64_tr_b16 a[204:205], v243 offset:20672
    ds_read_b64_tr_b16 a[206:207], v243 offset:25792
    v_mfma_f32_16x16x32_bf16 v[140:143], a[212:215], a[84:87], v[140:143]
    s_waitcnt lgkmcnt(8)
    v_mfma_f32_16x16x32_bf16 v[144:147], a[216:219], a[80:83], v[144:147]
    ds_read_b64_tr_b16 a[208:209], v242 offset:20736
    ds_read_b64_tr_b16 a[210:211], v242 offset:25856
    v_mfma_f32_16x16x32_bf16 v[152:155], a[216:219], a[84:87], v[152:155]
    s_barrier
    s_mov_b32 s54, 73728
    v_mfma_f32_16x16x32_bf16 v[148:151], a[220:223], a[80:83], v[148:151]
    ds_read_b64_tr_b16 a[212:213], v243 offset:20736
    ds_read_b64_tr_b16 a[214:215], v243 offset:25856
    v_mfma_f32_16x16x32_bf16 v[156:159], a[220:223], a[84:87], v[156:159]
    s_waitcnt lgkmcnt(8)
    buffer_load_dwordx4 a[144:147], v11, s[24:27], s54 offen offset:0 sc1
    v_mfma_f32_16x16x32_bf16 v[160:163], a[192:195], a[80:83], v[160:163]
    ds_read_b64_tr_b16 a[216:217], v242 offset:30720
    ds_read_b64_tr_b16 a[218:219], v242 offset:35840
    v_mfma_f32_16x16x32_bf16 v[168:171], a[192:195], a[84:87], v[168:171]
    v_mfma_f32_16x16x32_bf16 v[164:167], a[196:199], a[80:83], v[164:167]
    ds_read_b64_tr_b16 a[220:221], v243 offset:30720
    ds_read_b64_tr_b16 a[222:223], v243 offset:35840
    v_mfma_f32_16x16x32_bf16 v[172:175], a[196:199], a[84:87], v[172:175]
    s_waitcnt lgkmcnt(8)
    buffer_load_dwordx4 a[148:151], v11, s[24:27], s54 offen offset:1024 sc1
    v_mfma_f32_16x16x32_bf16 v[176:179], a[200:203], a[80:83], v[176:179]
    ds_read_b64_tr_b16 a[192:193], v242 offset:30784
    ds_read_b64_tr_b16 a[194:195], v242 offset:35904
    v_mfma_f32_16x16x32_bf16 v[184:187], a[200:203], a[84:87], v[184:187]
    v_mfma_f32_16x16x32_bf16 v[180:183], a[204:207], a[80:83], v[180:183]
    ds_read_b64_tr_b16 a[196:197], v243 offset:30784
    ds_read_b64_tr_b16 a[198:199], v243 offset:35904
    v_mfma_f32_16x16x32_bf16 v[188:191], a[204:207], a[84:87], v[188:191]
    s_waitcnt lgkmcnt(8)
    s_mov_b32 s3, 401408
    v_mfma_f32_16x16x32_bf16 v[192:195], a[208:211], a[80:83], v[192:195]
    ds_read_b64_tr_b16 a[200:201], v242 offset:30848
    ds_read_b64_tr_b16 a[202:203], v242 offset:35968
    v_mfma_f32_16x16x32_bf16 v[200:203], a[208:211], a[84:87], v[200:203]
    buffer_store_dwordx4 v[108:111], v10, s[36:39], s3 offen offset:3072 sc1
    v_mfma_f32_16x16x32_bf16 v[196:199], a[212:215], a[80:83], v[196:199]
    ds_read_b64_tr_b16 a[204:205], v243 offset:30848
    ds_read_b64_tr_b16 a[206:207], v243 offset:35968
    v_mfma_f32_16x16x32_bf16 v[204:207], a[212:215], a[84:87], v[204:207]
    s_waitcnt vmcnt(36) lgkmcnt(8)
    v_mfma_f32_16x16x32_bf16 v[128:131], a[216:219], a[88:91], v[128:131]
    s_mov_b32 s54, 75776
    ds_read_b64_tr_b16 a[208:209], v242 offset:30912
    ds_read_b64_tr_b16 a[210:211], v242 offset:36032
    v_mfma_f32_16x16x32_bf16 v[136:139], a[216:219], a[92:95], v[136:139]
    buffer_load_dwordx4 a[152:155], v11, s[24:27], s54 offen offset:0 sc1
    v_mfma_f32_16x16x32_bf16 v[132:135], a[220:223], a[88:91], v[132:135]
    ds_read_b64_tr_b16 a[212:213], v243 offset:30912
    ds_read_b64_tr_b16 a[214:215], v243 offset:36032
    v_mfma_f32_16x16x32_bf16 v[140:143], a[220:223], a[92:95], v[140:143]
    s_waitcnt lgkmcnt(8)
    v_mfma_f32_16x16x32_bf16 v[144:147], a[192:195], a[88:91], v[144:147]
    ds_read_b64_tr_b16 a[216:217], v242 offset:30976
    ds_read_b64_tr_b16 a[218:219], v242 offset:36096
    v_mfma_f32_16x16x32_bf16 v[152:155], a[192:195], a[92:95], v[152:155]
    s_add_u32 m0, s47, 143360
    s_add_u32 s53, s44, 1556480
    v_mfma_f32_16x16x32_bf16 v[148:151], a[196:199], a[88:91], v[148:151]
    ds_read_b64_tr_b16 a[220:221], v243 offset:30976
    ds_read_b64_tr_b16 a[222:223], v243 offset:36096
    v_mfma_f32_16x16x32_bf16 v[156:159], a[196:199], a[92:95], v[156:159]
    s_waitcnt lgkmcnt(8)
    buffer_load_dwordx4 v12, s[20:23], s53 offen offset:0 lds
    v_mfma_f32_16x16x32_bf16 v[160:163], a[200:203], a[88:91], v[160:163]
    ds_read_b64_tr_b16 a[192:193], v240 offset:0
    ds_read_b64_tr_b16 a[194:195], v240 offset:5120
    v_mfma_f32_16x16x32_bf16 v[168:171], a[200:203], a[92:95], v[168:171]
    v_mfma_f32_16x16x32_bf16 v[164:167], a[204:207], a[88:91], v[164:167]
    ds_read_b64_tr_b16 a[196:197], v241 offset:0
    ds_read_b64_tr_b16 a[198:199], v241 offset:5120
    v_mfma_f32_16x16x32_bf16 v[172:175], a[204:207], a[92:95], v[172:175]
    s_waitcnt lgkmcnt(8)
    buffer_load_dwordx4 v13, s[20:23], s53 offen offset:1024 lds
    v_mfma_f32_16x16x32_bf16 v[176:179], a[208:211], a[88:91], v[176:179]
    ds_read_b64_tr_b16 a[200:201], v240 offset:64
    ds_read_b64_tr_b16 a[202:203], v240 offset:5184
    v_mfma_f32_16x16x32_bf16 v[184:187], a[208:211], a[92:95], v[184:187]
    v_mfma_f32_16x16x32_bf16 v[180:183], a[212:215], a[88:91], v[180:183]
    ds_read_b64_tr_b16 a[204:205], v241 offset:64
    ds_read_b64_tr_b16 a[206:207], v241 offset:5184
    v_mfma_f32_16x16x32_bf16 v[188:191], a[212:215], a[92:95], v[188:191]
    s_waitcnt lgkmcnt(8)
    buffer_load_dwordx4 v14, s[20:23], s53 offen offset:2048 lds
    v_mfma_f32_16x16x32_bf16 v[192:195], a[216:219], a[88:91], v[192:195]
    ds_read_b64_tr_b16 a[208:209], v240 offset:128
    ds_read_b64_tr_b16 a[210:211], v240 offset:5248
    v_mfma_f32_16x16x32_bf16 v[200:203], a[216:219], a[92:95], v[200:203]
    v_mfma_f32_16x16x32_bf16 v[196:199], a[220:223], a[88:91], v[196:199]
    ds_read_b64_tr_b16 a[212:213], v241 offset:128
    ds_read_b64_tr_b16 a[214:215], v241 offset:5248
    v_mfma_f32_16x16x32_bf16 v[204:207], a[220:223], a[92:95], v[204:207]
    s_waitcnt vmcnt(38) lgkmcnt(8)
    v_mfma_f32_16x16x32_bf16 v[128:131], a[192:195], a[96:99], v[128:131]
    ds_read_b64_tr_b16 a[216:217], v240 offset:192
    ds_read_b64_tr_b16 a[218:219], v240 offset:5312
    v_mfma_f32_16x16x32_bf16 v[136:139], a[192:195], a[100:103], v[136:139]
    buffer_load_dwordx4 v15, s[20:23], s53 offen offset:3072 lds
    v_mfma_f32_16x16x32_bf16 v[132:135], a[196:199], a[96:99], v[132:135]
    ds_read_b64_tr_b16 a[220:221], v241 offset:192
    ds_read_b64_tr_b16 a[222:223], v241 offset:5312
    v_mfma_f32_16x16x32_bf16 v[140:143], a[196:199], a[100:103], v[140:143]
    s_waitcnt lgkmcnt(8)
    v_mfma_f32_16x16x32_bf16 v[144:147], a[200:203], a[96:99], v[144:147]
    ds_read_b64_tr_b16 a[192:193], v240 offset:256
    ds_read_b64_tr_b16 a[194:195], v240 offset:5376
    v_mfma_f32_16x16x32_bf16 v[152:155], a[200:203], a[100:103], v[152:155]
    s_barrier
    s_add_u32 m0, s47, 147456
    v_mfma_f32_16x16x32_bf16 v[148:151], a[204:207], a[96:99], v[148:151]
    ds_read_b64_tr_b16 a[196:197], v241 offset:256
    ds_read_b64_tr_b16 a[198:199], v241 offset:5376
    v_mfma_f32_16x16x32_bf16 v[156:159], a[204:207], a[100:103], v[156:159]
    s_waitcnt lgkmcnt(8)
    buffer_load_dwordx4 v16, s[20:23], s53 offen offset:0 lds
    v_mfma_f32_16x16x32_bf16 v[160:163], a[208:211], a[96:99], v[160:163]
    ds_read_b64_tr_b16 a[200:201], v240 offset:10240
    ds_read_b64_tr_b16 a[202:203], v240 offset:15360
    v_mfma_f32_16x16x32_bf16 v[168:171], a[208:211], a[100:103], v[168:171]
    v_mfma_f32_16x16x32_bf16 v[164:167], a[212:215], a[96:99], v[164:167]
    ds_read_b64_tr_b16 a[204:205], v241 offset:10240
    ds_read_b64_tr_b16 a[206:207], v241 offset:15360
    v_mfma_f32_16x16x32_bf16 v[172:175], a[212:215], a[100:103], v[172:175]
    s_waitcnt lgkmcnt(8)
    buffer_load_dwordx4 a[156:159], v11, s[24:27], s54 offen offset:1024 sc1
    v_mfma_f32_16x16x32_bf16 v[176:179], a[216:219], a[96:99], v[176:179]
    ds_read_b64_tr_b16 a[208:209], v240 offset:10304
    ds_read_b64_tr_b16 a[210:211], v240 offset:15424
    v_mfma_f32_16x16x32_bf16 v[184:187], a[216:219], a[100:103], v[184:187]
    v_mfma_f32_16x16x32_bf16 v[180:183], a[220:223], a[96:99], v[180:183]
    ds_read_b64_tr_b16 a[212:213], v241 offset:10304
    ds_read_b64_tr_b16 a[214:215], v241 offset:15424
    v_mfma_f32_16x16x32_bf16 v[188:191], a[220:223], a[100:103], v[188:191]
    s_waitcnt lgkmcnt(8)
    s_mov_b32 s54, 77824
    v_mfma_f32_16x16x32_bf16 v[192:195], a[192:195], a[96:99], v[192:195]
    ds_read_b64_tr_b16 a[216:217], v240 offset:10368
    ds_read_b64_tr_b16 a[218:219], v240 offset:15488
    v_mfma_f32_16x16x32_bf16 v[200:203], a[192:195], a[100:103], v[200:203]
    buffer_load_dwordx4 a[160:163], v11, s[24:27], s54 offen offset:0 sc1
    v_mfma_f32_16x16x32_bf16 v[196:199], a[196:199], a[96:99], v[196:199]
    ds_read_b64_tr_b16 a[220:221], v241 offset:10368
    ds_read_b64_tr_b16 a[222:223], v241 offset:15488
    v_mfma_f32_16x16x32_bf16 v[204:207], a[196:199], a[100:103], v[204:207]
    s_waitcnt vmcnt(40) lgkmcnt(8)
    v_mfma_f32_16x16x32_bf16 v[128:131], a[200:203], a[104:107], v[128:131]
    ds_read_b64_tr_b16 a[192:193], v240 offset:10432
    ds_read_b64_tr_b16 a[194:195], v240 offset:15552
    v_mfma_f32_16x16x32_bf16 v[136:139], a[200:203], a[108:111], v[136:139]
    buffer_load_dwordx4 a[164:167], v11, s[24:27], s54 offen offset:1024 sc1
    v_mfma_f32_16x16x32_bf16 v[132:135], a[204:207], a[104:107], v[132:135]
    ds_read_b64_tr_b16 a[196:197], v241 offset:10432
    ds_read_b64_tr_b16 a[198:199], v241 offset:15552
    v_mfma_f32_16x16x32_bf16 v[140:143], a[204:207], a[108:111], v[140:143]
    s_waitcnt lgkmcnt(8)
    v_mfma_f32_16x16x32_bf16 v[144:147], a[208:211], a[104:107], v[144:147]
    ds_read_b64_tr_b16 a[200:201], v240 offset:10496
    ds_read_b64_tr_b16 a[202:203], v240 offset:15616
    v_mfma_f32_16x16x32_bf16 v[152:155], a[208:211], a[108:111], v[152:155]
    s_mov_b32 s54, 86016
    buffer_load_dwordx4 a[168:171], v11, s[24:27], s54 offen offset:0 sc1
    v_mfma_f32_16x16x32_bf16 v[148:151], a[212:215], a[104:107], v[148:151]
    ds_read_b64_tr_b16 a[204:205], v241 offset:10496
    ds_read_b64_tr_b16 a[206:207], v241 offset:15616
    v_mfma_f32_16x16x32_bf16 v[156:159], a[212:215], a[108:111], v[156:159]
    s_waitcnt lgkmcnt(8)
    v_mfma_f32_16x16x32_bf16 v[160:163], a[216:219], a[104:107], v[160:163]
    ds_read_b64_tr_b16 a[208:209], v240 offset:20480
    ds_read_b64_tr_b16 a[210:211], v240 offset:25600
    v_mfma_f32_16x16x32_bf16 v[168:171], a[216:219], a[108:111], v[168:171]
    v_mfma_f32_16x16x32_bf16 v[164:167], a[220:223], a[104:107], v[164:167]
    s_add_u32 m0, s47, 40960
    ds_read_b64_tr_b16 a[212:213], v241 offset:20480
    ds_read_b64_tr_b16 a[214:215], v241 offset:25600
    v_mfma_f32_16x16x32_bf16 v[172:175], a[220:223], a[108:111], v[172:175]
    s_waitcnt lgkmcnt(8)
    s_add_u32 s53, s42, 1761280
    v_mfma_f32_16x16x32_bf16 v[176:179], a[192:195], a[104:107], v[176:179]
    ds_read_b64_tr_b16 a[216:217], v240 offset:20544
    ds_read_b64_tr_b16 a[218:219], v240 offset:25664
    v_mfma_f32_16x16x32_bf16 v[184:187], a[192:195], a[108:111], v[184:187]
    buffer_load_dwordx4 v12, s[20:23], s53 offen offset:0 lds
    v_mfma_f32_16x16x32_bf16 v[180:183], a[196:199], a[104:107], v[180:183]
    ds_read_b64_tr_b16 a[220:221], v241 offset:20544
    ds_read_b64_tr_b16 a[222:223], v241 offset:25664
    v_mfma_f32_16x16x32_bf16 v[188:191], a[196:199], a[108:111], v[188:191]
    s_waitcnt lgkmcnt(8)
    buffer_load_dwordx4 v13, s[20:23], s53 offen offset:1024 lds
    v_mfma_f32_16x16x32_bf16 v[192:195], a[200:203], a[104:107], v[192:195]
    ds_read_b64_tr_b16 a[192:193], v240 offset:20608
    ds_read_b64_tr_b16 a[194:195], v240 offset:25728
    v_mfma_f32_16x16x32_bf16 v[200:203], a[200:203], a[108:111], v[200:203]
    v_mfma_f32_16x16x32_bf16 v[196:199], a[204:207], a[104:107], v[196:199]
    ds_read_b64_tr_b16 a[196:197], v241 offset:20608
    ds_read_b64_tr_b16 a[198:199], v241 offset:25728
    v_mfma_f32_16x16x32_bf16 v[204:207], a[204:207], a[108:111], v[204:207]
    s_waitcnt vmcnt(42) lgkmcnt(8)
    v_mfma_f32_16x16x32_bf16 v[128:131], a[208:211], a[112:115], v[128:131]
    ds_read_b64_tr_b16 a[200:201], v240 offset:20672
    ds_read_b64_tr_b16 a[202:203], v240 offset:25792
    v_mfma_f32_16x16x32_bf16 v[136:139], a[208:211], a[116:119], v[136:139]
    buffer_load_dwordx4 v14, s[20:23], s53 offen offset:2048 lds
    v_mfma_f32_16x16x32_bf16 v[132:135], a[212:215], a[112:115], v[132:135]
    ds_read_b64_tr_b16 a[204:205], v241 offset:20672
    ds_read_b64_tr_b16 a[206:207], v241 offset:25792
    v_mfma_f32_16x16x32_bf16 v[140:143], a[212:215], a[116:119], v[140:143]
    s_waitcnt lgkmcnt(8)
    v_mfma_f32_16x16x32_bf16 v[144:147], a[216:219], a[112:115], v[144:147]
    ds_read_b64_tr_b16 a[208:209], v240 offset:20736
    ds_read_b64_tr_b16 a[210:211], v240 offset:25856
    v_mfma_f32_16x16x32_bf16 v[152:155], a[216:219], a[116:119], v[152:155]
    s_waitcnt vmcnt(13)
    s_barrier
    s_cmp_lg_u32 s40, 0
    s_cbranch_scc1 H1B_NF
    global_store_dword v1, v2, s[6:7] offset:32 sc1
H1B_NF:
    v_mfma_f32_16x16x32_bf16 v[148:151], a[220:223], a[112:115], v[148:151]
    ds_read_b64_tr_b16 a[212:213], v241 offset:20736
    ds_read_b64_tr_b16 a[214:215], v241 offset:25856
    v_mfma_f32_16x16x32_bf16 v[156:159], a[220:223], a[116:119], v[156:159]
    s_waitcnt lgkmcnt(8)
    buffer_load_dwordx4 v15, s[20:23], s53 offen offset:3072 lds
    v_mfma_f32_16x16x32_bf16 v[160:163], a[192:195], a[112:115], v[160:163]
    ds_read_b64_tr_b16 a[216:217], v240 offset:30720
    ds_read_b64_tr_b16 a[218:219], v240 offset:35840
    v_mfma_f32_16x16x32_bf16 v[168:171], a[192:195], a[116:119], v[168:171]
    v_mfma_f32_16x16x32_bf16 v[164:167], a[196:199], a[112:115], v[164:167]
    s_add_u32 m0, s47, 45056
    ds_read_b64_tr_b16 a[220:221], v241 offset:30720
    ds_read_b64_tr_b16 a[222:223], v241 offset:35840
    v_mfma_f32_16x16x32_bf16 v[172:175], a[196:199], a[116:119], v[172:175]
    s_waitcnt lgkmcnt(8)
    buffer_load_dwordx4 v16, s[20:23], s53 offen offset:0 lds
    v_mfma_f32_16x16x32_bf16 v[176:179], a[200:203], a[112:115], v[176:179]
    ds_read_b64_tr_b16 a[192:193], v240 offset:30784
    ds_read_b64_tr_b16 a[194:195], v240 offset:35904
    v_mfma_f32_16x16x32_bf16 v[184:187], a[200:203], a[116:119], v[184:187]
    v_mfma_f32_16x16x32_bf16 v[180:183], a[204:207], a[112:115], v[180:183]
    ds_read_b64_tr_b16 a[196:197], v241 offset:30784
    ds_read_b64_tr_b16 a[198:199], v241 offset:35904
    v_mfma_f32_16x16x32_bf16 v[188:191], a[204:207], a[116:119], v[188:191]
    s_waitcnt lgkmcnt(8)
    buffer_load_dwordx4 a[172:175], v11, s[24:27], s54 offen offset:1024 sc1
    v_mfma_f32_16x16x32_bf16 v[192:195], a[208:211], a[112:115], v[192:195]
    ds_read_b64_tr_b16 a[200:201], v240 offset:30848
    ds_read_b64_tr_b16 a[202:203], v240 offset:35968
    v_mfma_f32_16x16x32_bf16 v[200:203], a[208:211], a[116:119], v[200:203]
    v_mfma_f32_16x16x32_bf16 v[196:199], a[212:215], a[112:115], v[196:199]
    ds_read_b64_tr_b16 a[204:205], v241 offset:30848
    ds_read_b64_tr_b16 a[206:207], v241 offset:35968
    v_mfma_f32_16x16x32_bf16 v[204:207], a[212:215], a[116:119], v[204:207]
    s_waitcnt lgkmcnt(8)
    v_mfma_f32_16x16x32_bf16 v[128:131], a[216:219], a[120:123], v[128:131]
    s_mov_b32 s54, 88064
    ds_read_b64_tr_b16 a[208:209], v240 offset:30912
    ds_read_b64_tr_b16 a[210:211], v240 offset:36032
    v_mfma_f32_16x16x32_bf16 v[136:139], a[216:219], a[124:127], v[136:139]
    buffer_load_dwordx4 a[176:179], v11, s[24:27], s54 offen offset:0 sc1
    v_mfma_f32_16x16x32_bf16 v[132:135], a[220:223], a[120:123], v[132:135]
    ds_read_b64_tr_b16 a[212:213], v241 offset:30912
    ds_read_b64_tr_b16 a[214:215], v241 offset:36032
    v_mfma_f32_16x16x32_bf16 v[140:143], a[220:223], a[124:127], v[140:143]
    s_waitcnt lgkmcnt(8)
    v_mfma_f32_16x16x32_bf16 v[144:147], a[192:195], a[120:123], v[144:147]
    ds_read_b64_tr_b16 a[216:217], v240 offset:30976
    ds_read_b64_tr_b16 a[218:219], v240 offset:36096
    v_mfma_f32_16x16x32_bf16 v[152:155], a[192:195], a[124:127], v[152:155]
    buffer_load_dwordx4 a[180:183], v11, s[24:27], s54 offen offset:1024 sc1
    v_mfma_f32_16x16x32_bf16 v[148:151], a[196:199], a[120:123], v[148:151]
    ds_read_b64_tr_b16 a[220:221], v241 offset:30976
    ds_read_b64_tr_b16 a[222:223], v241 offset:36096
    v_mfma_f32_16x16x32_bf16 v[156:159], a[196:199], a[124:127], v[156:159]
    s_waitcnt lgkmcnt(8)
    v_mfma_f32_16x16x32_bf16 v[160:163], a[200:203], a[120:123], v[160:163]
    ds_read_b64_tr_b16 a[192:193], v242 offset:40960
    ds_read_b64_tr_b16 a[194:195], v242 offset:46080
    v_mfma_f32_16x16x32_bf16 v[168:171], a[200:203], a[124:127], v[168:171]
    v_mfma_f32_16x16x32_bf16 v[164:167], a[204:207], a[120:123], v[164:167]
    s_mov_b32 s54, 90112
    ds_read_b64_tr_b16 a[196:197], v243 offset:40960
    ds_read_b64_tr_b16 a[198:199], v243 offset:46080
    v_mfma_f32_16x16x32_bf16 v[172:175], a[204:207], a[124:127], v[172:175]
    s_waitcnt lgkmcnt(8)
    buffer_load_dwordx4 a[184:187], v11, s[24:27], s54 offen offset:0 sc1
    v_mfma_f32_16x16x32_bf16 v[176:179], a[208:211], a[120:123], v[176:179]
    ds_read_b64_tr_b16 a[200:201], v242 offset:41024
    ds_read_b64_tr_b16 a[202:203], v242 offset:46144
    v_mfma_f32_16x16x32_bf16 v[184:187], a[208:211], a[124:127], v[184:187]
    v_mfma_f32_16x16x32_bf16 v[180:183], a[212:215], a[120:123], v[180:183]
    ds_read_b64_tr_b16 a[204:205], v243 offset:41024
    ds_read_b64_tr_b16 a[206:207], v243 offset:46144
    v_mfma_f32_16x16x32_bf16 v[188:191], a[212:215], a[124:127], v[188:191]
    s_waitcnt lgkmcnt(8)
    s_add_u32 m0, s47, 61440
    s_add_u32 s53, s42, 122880
    v_mfma_f32_16x16x32_bf16 v[192:195], a[216:219], a[120:123], v[192:195]
    ds_read_b64_tr_b16 a[208:209], v242 offset:41088
    ds_read_b64_tr_b16 a[210:211], v242 offset:46208
    v_mfma_f32_16x16x32_bf16 v[200:203], a[216:219], a[124:127], v[200:203]
    buffer_load_dwordx4 v12, s[20:23], s53 offen offset:0 lds
    v_mfma_f32_16x16x32_bf16 v[196:199], a[220:223], a[120:123], v[196:199]
    ds_read_b64_tr_b16 a[212:213], v243 offset:41088
    ds_read_b64_tr_b16 a[214:215], v243 offset:46208
    v_mfma_f32_16x16x32_bf16 v[204:207], a[220:223], a[124:127], v[204:207]
    s_waitcnt lgkmcnt(8)
    v_mfma_f32_16x16x32_bf16 v[128:131], a[192:195], a[128:131], v[128:131]
    ds_read_b64_tr_b16 a[216:217], v242 offset:41152
    ds_read_b64_tr_b16 a[218:219], v242 offset:46272
    v_mfma_f32_16x16x32_bf16 v[136:139], a[192:195], a[132:135], v[136:139]
    buffer_load_dwordx4 v13, s[20:23], s53 offen offset:1024 lds
    v_mfma_f32_16x16x32_bf16 v[132:135], a[196:199], a[128:131], v[132:135]
    ds_read_b64_tr_b16 a[220:221], v243 offset:41152
    ds_read_b64_tr_b16 a[222:223], v243 offset:46272
    v_mfma_f32_16x16x32_bf16 v[140:143], a[196:199], a[132:135], v[140:143]
    s_waitcnt lgkmcnt(8)
    v_mfma_f32_16x16x32_bf16 v[144:147], a[200:203], a[128:131], v[144:147]
    ds_read_b64_tr_b16 a[192:193], v242 offset:41216
    ds_read_b64_tr_b16 a[194:195], v242 offset:46336
    v_mfma_f32_16x16x32_bf16 v[152:155], a[200:203], a[132:135], v[152:155]
    s_barrier
    v_mfma_f32_16x16x32_bf16 v[148:151], a[204:207], a[128:131], v[148:151]
    ds_read_b64_tr_b16 a[196:197], v243 offset:41216
    ds_read_b64_tr_b16 a[198:199], v243 offset:46336
    v_mfma_f32_16x16x32_bf16 v[156:159], a[204:207], a[132:135], v[156:159]
    s_waitcnt lgkmcnt(8)
    buffer_load_dwordx4 v14, s[20:23], s53 offen offset:2048 lds
    v_mfma_f32_16x16x32_bf16 v[160:163], a[208:211], a[128:131], v[160:163]
    ds_read_b64_tr_b16 a[200:201], v242 offset:51200
    ds_read_b64_tr_b16 a[202:203], v242 offset:56320
    v_mfma_f32_16x16x32_bf16 v[168:171], a[208:211], a[132:135], v[168:171]
    v_mfma_f32_16x16x32_bf16 v[164:167], a[212:215], a[128:131], v[164:167]
    ds_read_b64_tr_b16 a[204:205], v243 offset:51200
    ds_read_b64_tr_b16 a[206:207], v243 offset:56320
    v_mfma_f32_16x16x32_bf16 v[172:175], a[212:215], a[132:135], v[172:175]
    s_waitcnt lgkmcnt(8)
    buffer_load_dwordx4 v15, s[20:23], s53 offen offset:3072 lds
    v_mfma_f32_16x16x32_bf16 v[176:179], a[216:219], a[128:131], v[176:179]
    ds_read_b64_tr_b16 a[208:209], v242 offset:51264
    ds_read_b64_tr_b16 a[210:211], v242 offset:56384
    v_mfma_f32_16x16x32_bf16 v[184:187], a[216:219], a[132:135], v[184:187]
    v_mfma_f32_16x16x32_bf16 v[180:183], a[220:223], a[128:131], v[180:183]
    ds_read_b64_tr_b16 a[212:213], v243 offset:51264
    ds_read_b64_tr_b16 a[214:215], v243 offset:56384
    v_mfma_f32_16x16x32_bf16 v[188:191], a[220:223], a[132:135], v[188:191]
    s_waitcnt lgkmcnt(8)
    s_add_u32 m0, s47, 65536
    v_mfma_f32_16x16x32_bf16 v[192:195], a[192:195], a[128:131], v[192:195]
    ds_read_b64_tr_b16 a[216:217], v242 offset:51328
    ds_read_b64_tr_b16 a[218:219], v242 offset:56448
    v_mfma_f32_16x16x32_bf16 v[200:203], a[192:195], a[132:135], v[200:203]
    buffer_load_dwordx4 v16, s[20:23], s53 offen offset:0 lds
    v_mfma_f32_16x16x32_bf16 v[196:199], a[196:199], a[128:131], v[196:199]
    ds_read_b64_tr_b16 a[220:221], v243 offset:51328
    ds_read_b64_tr_b16 a[222:223], v243 offset:56448
    v_mfma_f32_16x16x32_bf16 v[204:207], a[196:199], a[132:135], v[204:207]
    s_waitcnt lgkmcnt(8)
    v_mfma_f32_16x16x32_bf16 v[128:131], a[200:203], a[136:139], v[128:131]
    ds_read_b64_tr_b16 a[192:193], v242 offset:51392
    ds_read_b64_tr_b16 a[194:195], v242 offset:56512
    v_mfma_f32_16x16x32_bf16 v[136:139], a[200:203], a[140:143], v[136:139]
    buffer_load_dwordx4 a[188:191], v11, s[24:27], s54 offen offset:1024 sc1
    v_mfma_f32_16x16x32_bf16 v[132:135], a[204:207], a[136:139], v[132:135]
    ds_read_b64_tr_b16 a[196:197], v243 offset:51392
    ds_read_b64_tr_b16 a[198:199], v243 offset:56512
    v_mfma_f32_16x16x32_bf16 v[140:143], a[204:207], a[140:143], v[140:143]
    s_waitcnt lgkmcnt(8)
    v_mfma_f32_16x16x32_bf16 v[144:147], a[208:211], a[136:139], v[144:147]
    ds_read_b64_tr_b16 a[200:201], v242 offset:51456
    ds_read_b64_tr_b16 a[202:203], v242 offset:56576
    v_mfma_f32_16x16x32_bf16 v[152:155], a[208:211], a[140:143], v[152:155]
    s_add_u32 m0, s47, 81920
    s_add_u32 s53, s44, 204800
    v_mfma_f32_16x16x32_bf16 v[148:151], a[212:215], a[136:139], v[148:151]
    ds_read_b64_tr_b16 a[204:205], v243 offset:51456
    ds_read_b64_tr_b16 a[206:207], v243 offset:56576
    v_mfma_f32_16x16x32_bf16 v[156:159], a[212:215], a[140:143], v[156:159]
    s_waitcnt lgkmcnt(8)
    buffer_load_dwordx4 v12, s[20:23], s53 offen offset:0 lds
    v_mfma_f32_16x16x32_bf16 v[160:163], a[216:219], a[136:139], v[160:163]
    ds_read_b64_tr_b16 a[208:209], v244 offset:0
    ds_read_b64_tr_b16 a[210:211], v244 offset:5120
    v_mfma_f32_16x16x32_bf16 v[168:171], a[216:219], a[140:143], v[168:171]
    v_mfma_f32_16x16x32_bf16 v[164:167], a[220:223], a[136:139], v[164:167]
    ds_read_b64_tr_b16 a[212:213], v245 offset:0
    ds_read_b64_tr_b16 a[214:215], v245 offset:5120
    v_mfma_f32_16x16x32_bf16 v[172:175], a[220:223], a[140:143], v[172:175]
    s_waitcnt lgkmcnt(8)
    buffer_load_dwordx4 v13, s[20:23], s53 offen offset:1024 lds
    v_mfma_f32_16x16x32_bf16 v[176:179], a[192:195], a[136:139], v[176:179]
    ds_read_b64_tr_b16 a[216:217], v244 offset:64
    ds_read_b64_tr_b16 a[218:219], v244 offset:5184
    v_mfma_f32_16x16x32_bf16 v[184:187], a[192:195], a[140:143], v[184:187]
    v_mfma_f32_16x16x32_bf16 v[180:183], a[196:199], a[136:139], v[180:183]
    ds_read_b64_tr_b16 a[220:221], v245 offset:64
    ds_read_b64_tr_b16 a[222:223], v245 offset:5184
    v_mfma_f32_16x16x32_bf16 v[188:191], a[196:199], a[140:143], v[188:191]
    s_waitcnt lgkmcnt(8)
    buffer_load_dwordx4 v14, s[20:23], s53 offen offset:2048 lds
    v_mfma_f32_16x16x32_bf16 v[192:195], a[200:203], a[136:139], v[192:195]
    ds_read_b64_tr_b16 a[192:193], v244 offset:128
    ds_read_b64_tr_b16 a[194:195], v244 offset:5248
    v_mfma_f32_16x16x32_bf16 v[200:203], a[200:203], a[140:143], v[200:203]
    v_mfma_f32_16x16x32_bf16 v[196:199], a[204:207], a[136:139], v[196:199]
    ds_read_b64_tr_b16 a[196:197], v245 offset:128
    ds_read_b64_tr_b16 a[198:199], v245 offset:5248
    v_mfma_f32_16x16x32_bf16 v[204:207], a[204:207], a[140:143], v[204:207]
    s_waitcnt lgkmcnt(8)
    v_mfma_f32_16x16x32_bf16 v[128:131], a[208:211], a[144:147], v[128:131]
    ds_read_b64_tr_b16 a[200:201], v244 offset:192
    ds_read_b64_tr_b16 a[202:203], v244 offset:5312
    v_mfma_f32_16x16x32_bf16 v[136:139], a[208:211], a[148:151], v[136:139]
    buffer_load_dwordx4 v15, s[20:23], s53 offen offset:3072 lds
    v_mfma_f32_16x16x32_bf16 v[132:135], a[212:215], a[144:147], v[132:135]
    ds_read_b64_tr_b16 a[204:205], v245 offset:192
    ds_read_b64_tr_b16 a[206:207], v245 offset:5312
    v_mfma_f32_16x16x32_bf16 v[140:143], a[212:215], a[148:151], v[140:143]
    s_waitcnt lgkmcnt(8)
    v_mfma_f32_16x16x32_bf16 v[144:147], a[216:219], a[144:147], v[144:147]
    ds_read_b64_tr_b16 a[208:209], v244 offset:256
    ds_read_b64_tr_b16 a[210:211], v244 offset:5376
    v_mfma_f32_16x16x32_bf16 v[152:155], a[216:219], a[148:151], v[152:155]
    s_waitcnt vmcnt(23)
    s_barrier
    v_mfma_f32_16x16x32_bf16 v[148:151], a[220:223], a[144:147], v[148:151]
    ds_read_b64_tr_b16 a[212:213], v245 offset:256
    ds_read_b64_tr_b16 a[214:215], v245 offset:5376
    v_mfma_f32_16x16x32_bf16 v[156:159], a[220:223], a[148:151], v[156:159]
    s_waitcnt lgkmcnt(8)
    global_load_dword v48, v3, s[6:7] offset:32 sc1
    v_mfma_f32_16x16x32_bf16 v[160:163], a[192:195], a[144:147], v[160:163]
    ds_read_b64_tr_b16 a[216:217], v244 offset:10240
    ds_read_b64_tr_b16 a[218:219], v244 offset:15360
    v_mfma_f32_16x16x32_bf16 v[168:171], a[192:195], a[148:151], v[168:171]
    v_mfma_f32_16x16x32_bf16 v[164:167], a[196:199], a[144:147], v[164:167]
    s_add_u32 m0, s47, 86016
    ds_read_b64_tr_b16 a[220:221], v245 offset:10240
    ds_read_b64_tr_b16 a[222:223], v245 offset:15360
    v_mfma_f32_16x16x32_bf16 v[172:175], a[196:199], a[148:151], v[172:175]
    s_waitcnt lgkmcnt(8)
    buffer_load_dwordx4 v16, s[20:23], s53 offen offset:0 lds
    v_mfma_f32_16x16x32_bf16 v[176:179], a[200:203], a[144:147], v[176:179]
    ds_read_b64_tr_b16 a[192:193], v244 offset:10304
    ds_read_b64_tr_b16 a[194:195], v244 offset:15424
    v_mfma_f32_16x16x32_bf16 v[184:187], a[200:203], a[148:151], v[184:187]
    v_mfma_f32_16x16x32_bf16 v[180:183], a[204:207], a[144:147], v[180:183]
    ds_read_b64_tr_b16 a[196:197], v245 offset:10304
    ds_read_b64_tr_b16 a[198:199], v245 offset:15424
    v_mfma_f32_16x16x32_bf16 v[188:191], a[204:207], a[148:151], v[188:191]
    s_waitcnt lgkmcnt(8)
    s_add_u32 m0, s47, 0
    s_add_u32 s53, s42, 409600
    v_mfma_f32_16x16x32_bf16 v[192:195], a[208:211], a[144:147], v[192:195]
    ds_read_b64_tr_b16 a[200:201], v244 offset:10368
    ds_read_b64_tr_b16 a[202:203], v244 offset:15488
    v_mfma_f32_16x16x32_bf16 v[200:203], a[208:211], a[148:151], v[200:203]
    buffer_load_dwordx4 v12, s[20:23], s53 offen offset:0 lds
    v_mfma_f32_16x16x32_bf16 v[196:199], a[212:215], a[144:147], v[196:199]
    ds_read_b64_tr_b16 a[204:205], v245 offset:10368
    ds_read_b64_tr_b16 a[206:207], v245 offset:15488
    v_mfma_f32_16x16x32_bf16 v[204:207], a[212:215], a[148:151], v[204:207]
    s_waitcnt vmcnt(25) lgkmcnt(8)
    v_mfma_f32_16x16x32_bf16 v[128:131], a[216:219], a[152:155], v[128:131]
    ds_read_b64_tr_b16 a[208:209], v244 offset:10432
    ds_read_b64_tr_b16 a[210:211], v244 offset:15552
    v_mfma_f32_16x16x32_bf16 v[136:139], a[216:219], a[156:159], v[136:139]
    buffer_load_dwordx4 v13, s[20:23], s53 offen offset:1024 lds
    v_mfma_f32_16x16x32_bf16 v[132:135], a[220:223], a[152:155], v[132:135]
    ds_read_b64_tr_b16 a[212:213], v245 offset:10432
    ds_read_b64_tr_b16 a[214:215], v245 offset:15552
    v_mfma_f32_16x16x32_bf16 v[140:143], a[220:223], a[156:159], v[140:143]
    s_waitcnt lgkmcnt(8)
    v_mfma_f32_16x16x32_bf16 v[144:147], a[192:195], a[152:155], v[144:147]
    ds_read_b64_tr_b16 a[216:217], v244 offset:10496
    ds_read_b64_tr_b16 a[218:219], v244 offset:15616
    v_mfma_f32_16x16x32_bf16 v[152:155], a[192:195], a[156:159], v[152:155]
    buffer_load_dwordx4 v14, s[20:23], s53 offen offset:2048 lds
    v_mfma_f32_16x16x32_bf16 v[148:151], a[196:199], a[152:155], v[148:151]
    ds_read_b64_tr_b16 a[220:221], v245 offset:10496
    ds_read_b64_tr_b16 a[222:223], v245 offset:15616
    v_mfma_f32_16x16x32_bf16 v[156:159], a[196:199], a[156:159], v[156:159]
    s_waitcnt lgkmcnt(8)
    v_mfma_f32_16x16x32_bf16 v[160:163], a[200:203], a[152:155], v[160:163]
    ds_read_b64_tr_b16 a[192:193], v244 offset:20480
    ds_read_b64_tr_b16 a[194:195], v244 offset:25600
    v_mfma_f32_16x16x32_bf16 v[168:171], a[200:203], a[156:159], v[168:171]
    v_mfma_f32_16x16x32_bf16 v[164:167], a[204:207], a[152:155], v[164:167]
    ds_read_b64_tr_b16 a[196:197], v245 offset:20480
    ds_read_b64_tr_b16 a[198:199], v245 offset:25600
    v_mfma_f32_16x16x32_bf16 v[172:175], a[204:207], a[156:159], v[172:175]
    s_waitcnt lgkmcnt(8)
    buffer_load_dwordx4 v15, s[20:23], s53 offen offset:3072 lds
    v_mfma_f32_16x16x32_bf16 v[176:179], a[208:211], a[152:155], v[176:179]
    ds_read_b64_tr_b16 a[200:201], v244 offset:20544
    ds_read_b64_tr_b16 a[202:203], v244 offset:25664
    v_mfma_f32_16x16x32_bf16 v[184:187], a[208:211], a[156:159], v[184:187]
    v_mfma_f32_16x16x32_bf16 v[180:183], a[212:215], a[152:155], v[180:183]
    ds_read_b64_tr_b16 a[204:205], v245 offset:20544
    ds_read_b64_tr_b16 a[206:207], v245 offset:25664
    v_mfma_f32_16x16x32_bf16 v[188:191], a[212:215], a[156:159], v[188:191]
    s_waitcnt lgkmcnt(8)
    s_add_u32 m0, s47, 4096
    v_mfma_f32_16x16x32_bf16 v[192:195], a[216:219], a[152:155], v[192:195]
    ds_read_b64_tr_b16 a[208:209], v244 offset:20608
    ds_read_b64_tr_b16 a[210:211], v244 offset:25728
    v_mfma_f32_16x16x32_bf16 v[200:203], a[216:219], a[156:159], v[200:203]
    buffer_load_dwordx4 v16, s[20:23], s53 offen offset:0 lds
    v_mfma_f32_16x16x32_bf16 v[196:199], a[220:223], a[152:155], v[196:199]
    ds_read_b64_tr_b16 a[212:213], v245 offset:20608
    ds_read_b64_tr_b16 a[214:215], v245 offset:25728
    v_mfma_f32_16x16x32_bf16 v[204:207], a[220:223], a[156:159], v[204:207]
    s_waitcnt vmcnt(27) lgkmcnt(8)
    v_mfma_f32_16x16x32_bf16 v[128:131], a[192:195], a[160:163], v[128:131]
    s_add_u32 m0, s47, 20480
    ds_read_b64_tr_b16 a[216:217], v244 offset:20672
    ds_read_b64_tr_b16 a[218:219], v244 offset:25792
    v_mfma_f32_16x16x32_bf16 v[136:139], a[192:195], a[164:167], v[136:139]
    s_add_u32 s53, s42, 614400
    s_waitcnt vmcnt(6)
    v_cmp_ne_u32 vcc, s5, v48
    v_mfma_f32_16x16x32_bf16 v[132:135], a[196:199], a[160:163], v[132:135]
    s_cbranch_vccnz H1B_SLOW
H1B_OK:
    ds_read_b64_tr_b16 a[220:221], v245 offset:20672
    ds_read_b64_tr_b16 a[222:223], v245 offset:25792
    v_mfma_f32_16x16x32_bf16 v[140:143], a[196:199], a[164:167], v[140:143]
    s_waitcnt lgkmcnt(8)
    buffer_load_dwordx4 v12, s[20:23], s53 offen offset:0 lds
    v_mfma_f32_16x16x32_bf16 v[144:147], a[200:203], a[160:163], v[144:147]
    ds_read_b64_tr_b16 a[192:193], v244 offset:20736
    ds_read_b64_tr_b16 a[194:195], v244 offset:25856
    v_mfma_f32_16x16x32_bf16 v[152:155], a[200:203], a[164:167], v[152:155]
    s_barrier
    s_mov_b32 s54, 6144
    v_mfma_f32_16x16x32_bf16 v[148:151], a[204:207], a[160:163], v[148:151]
    ds_read_b64_tr_b16 a[196:197], v245 offset:20736
    ds_read_b64_tr_b16 a[198:199], v245 offset:25856
    v_mfma_f32_16x16x32_bf16 v[156:159], a[204:207], a[164:167], v[156:159]
    s_waitcnt lgkmcnt(8)
    buffer_load_dwordx4 a[0:3], v11, s[24:27], s54 offen offset:0 sc1
    v_mfma_f32_16x16x32_bf16 v[160:163], a[208:211], a[160:163], v[160:163]
    ds_read_b64_tr_b16 a[200:201], v244 offset:30720
    ds_read_b64_tr_b16 a[202:203], v244 offset:35840
    v_mfma_f32_16x16x32_bf16 v[168:171], a[208:211], a[164:167], v[168:171]
    v_mfma_f32_16x16x32_bf16 v[164:167], a[212:215], a[160:163], v[164:167]
    ds_read_b64_tr_b16 a[204:205], v245 offset:30720
    ds_read_b64_tr_b16 a[206:207], v245 offset:35840
    v_mfma_f32_16x16x32_bf16 v[172:175], a[212:215], a[164:167], v[172:175]
    s_waitcnt lgkmcnt(8)
    buffer_load_dwordx4 a[4:7], v11, s[24:27], s54 offen offset:1024 sc1
    v_mfma_f32_16x16x32_bf16 v[176:179], a[216:219], a[160:163], v[176:179]
    ds_read_b64_tr_b16 a[208:209], v244 offset:30784
    ds_read_b64_tr_b16 a[210:211], v244 offset:35904
    v_mfma_f32_16x16x32_bf16 v[184:187], a[216:219], a[164:167], v[184:187]
    v_mfma_f32_16x16x32_bf16 v[180:183], a[220:223], a[160:163], v[180:183]
    ds_read_b64_tr_b16 a[212:213], v245 offset:30784
    ds_read_b64_tr_b16 a[214:215], v245 offset:35904
    v_mfma_f32_16x16x32_bf16 v[188:191], a[220:223], a[164:167], v[188:191]
    s_waitcnt lgkmcnt(8)
    s_mov_b32 s54, 8192
    v_mfma_f32_16x16x32_bf16 v[192:195], a[192:195], a[160:163], v[192:195]
    ds_read_b64_tr_b16 a[216:217], v244 offset:30848
    ds_read_b64_tr_b16 a[218:219], v244 offset:35968
    v_mfma_f32_16x16x32_bf16 v[200:203], a[192:195], a[164:167], v[200:203]
    buffer_load_dwordx4 a[8:11], v11, s[24:27], s54 offen offset:0 sc1
    v_mfma_f32_16x16x32_bf16 v[196:199], a[196:199], a[160:163], v[196:199]
    ds_read_b64_tr_b16 a[220:221], v245 offset:30848
    ds_read_b64_tr_b16 a[222:223], v245 offset:35968
    v_mfma_f32_16x16x32_bf16 v[204:207], a[196:199], a[164:167], v[204:207]
    s_waitcnt lgkmcnt(8)
    v_mfma_f32_16x16x32_bf16 v[128:131], a[200:203], a[168:171], v[128:131]
    ds_read_b64_tr_b16 a[192:193], v244 offset:30912
    ds_read_b64_tr_b16 a[194:195], v244 offset:36032
    v_mfma_f32_16x16x32_bf16 v[136:139], a[200:203], a[172:175], v[136:139]
    buffer_load_dwordx4 a[12:15], v11, s[24:27], s54 offen offset:1024 sc1
    v_mfma_f32_16x16x32_bf16 v[132:135], a[204:207], a[168:171], v[132:135]
    ds_read_b64_tr_b16 a[196:197], v245 offset:30912
    ds_read_b64_tr_b16 a[198:199], v245 offset:36032
    v_mfma_f32_16x16x32_bf16 v[140:143], a[204:207], a[172:175], v[140:143]
    s_waitcnt lgkmcnt(8)
    v_mfma_f32_16x16x32_bf16 v[144:147], a[208:211], a[168:171], v[144:147]
    ds_read_b64_tr_b16 a[200:201], v244 offset:30976
    ds_read_b64_tr_b16 a[202:203], v244 offset:36096
    v_mfma_f32_16x16x32_bf16 v[152:155], a[208:211], a[172:175], v[152:155]
    s_mov_b32 s54, 10240
    buffer_load_dwordx4 a[16:19], v11, s[24:27], s54 offen offset:0 sc1
    v_mfma_f32_16x16x32_bf16 v[148:151], a[212:215], a[168:171], v[148:151]
    ds_read_b64_tr_b16 a[204:205], v245 offset:30976
    ds_read_b64_tr_b16 a[206:207], v245 offset:36096
    v_mfma_f32_16x16x32_bf16 v[156:159], a[212:215], a[172:175], v[156:159]
    s_waitcnt lgkmcnt(8)
    v_mfma_f32_16x16x32_bf16 v[160:163], a[216:219], a[168:171], v[160:163]
    ds_read_b64_tr_b16 a[208:209], v240 offset:40960
    ds_read_b64_tr_b16 a[210:211], v240 offset:46080
    v_mfma_f32_16x16x32_bf16 v[168:171], a[216:219], a[172:175], v[168:171]
    v_mfma_f32_16x16x32_bf16 v[164:167], a[220:223], a[168:171], v[164:167]
    ds_read_b64_tr_b16 a[212:213], v241 offset:40960
    ds_read_b64_tr_b16 a[214:215], v241 offset:46080
    v_mfma_f32_16x16x32_bf16 v[172:175], a[220:223], a[172:175], v[172:175]
    s_waitcnt lgkmcnt(8)
    buffer_load_dwordx4 a[20:23], v11, s[24:27], s54 offen offset:1024 sc1
    v_mfma_f32_16x16x32_bf16 v[176:179], a[192:195], a[168:171], v[176:179]
    ds_read_b64_tr_b16 a[216:217], v240 offset:41024
    ds_read_b64_tr_b16 a[218:219], v240 offset:46144
    v_mfma_f32_16x16x32_bf16 v[184:187], a[192:195], a[172:175], v[184:187]
    v_mfma_f32_16x16x32_bf16 v[180:183], a[196:199], a[168:171], v[180:183]
    ds_read_b64_tr_b16 a[220:221], v241 offset:41024
    ds_read_b64_tr_b16 a[222:223], v241 offset:46144
    v_mfma_f32_16x16x32_bf16 v[188:191], a[196:199], a[172:175], v[188:191]
    s_waitcnt lgkmcnt(8)
    s_mov_b32 s54, 18432
    v_mfma_f32_16x16x32_bf16 v[192:195], a[200:203], a[168:171], v[192:195]
    ds_read_b64_tr_b16 a[192:193], v240 offset:41088
    ds_read_b64_tr_b16 a[194:195], v240 offset:46208
    v_mfma_f32_16x16x32_bf16 v[200:203], a[200:203], a[172:175], v[200:203]
    buffer_load_dwordx4 a[24:27], v11, s[24:27], s54 offen offset:0 sc1
    v_mfma_f32_16x16x32_bf16 v[196:199], a[204:207], a[168:171], v[196:199]
    ds_read_b64_tr_b16 a[196:197], v241 offset:41088
    ds_read_b64_tr_b16 a[198:199], v241 offset:46208
    v_mfma_f32_16x16x32_bf16 v[204:207], a[204:207], a[172:175], v[204:207]
    s_waitcnt lgkmcnt(8)
    v_mfma_f32_16x16x32_bf16 v[128:131], a[208:211], a[176:179], v[128:131]
    ds_read_b64_tr_b16 a[200:201], v240 offset:41152
    ds_read_b64_tr_b16 a[202:203], v240 offset:46272
    v_mfma_f32_16x16x32_bf16 v[136:139], a[208:211], a[180:183], v[136:139]
    buffer_load_dwordx4 a[28:31], v11, s[24:27], s54 offen offset:1024 sc1
    v_mfma_f32_16x16x32_bf16 v[132:135], a[212:215], a[176:179], v[132:135]
    ds_read_b64_tr_b16 a[204:205], v241 offset:41152
    ds_read_b64_tr_b16 a[206:207], v241 offset:46272
    v_mfma_f32_16x16x32_bf16 v[140:143], a[212:215], a[180:183], v[140:143]
    s_waitcnt lgkmcnt(8)
    v_mfma_f32_16x16x32_bf16 v[144:147], a[216:219], a[176:179], v[144:147]
    ds_read_b64_tr_b16 a[208:209], v240 offset:41216
    ds_read_b64_tr_b16 a[210:211], v240 offset:46336
    v_mfma_f32_16x16x32_bf16 v[152:155], a[216:219], a[180:183], v[152:155]
    s_barrier
    s_mov_b32 s54, 20480
    v_mfma_f32_16x16x32_bf16 v[148:151], a[220:223], a[176:179], v[148:151]
    ds_read_b64_tr_b16 a[212:213], v241 offset:41216
    ds_read_b64_tr_b16 a[214:215], v241 offset:46336
    v_mfma_f32_16x16x32_bf16 v[156:159], a[220:223], a[180:183], v[156:159]
    s_waitcnt lgkmcnt(8)
    buffer_load_dwordx4 a[32:35], v11, s[24:27], s54 offen offset:0 sc1
    v_mfma_f32_16x16x32_bf16 v[160:163], a[192:195], a[176:179], v[160:163]
    ds_read_b64_tr_b16 a[216:217], v240 offset:51200
    ds_read_b64_tr_b16 a[218:219], v240 offset:56320
    v_mfma_f32_16x16x32_bf16 v[168:171], a[192:195], a[180:183], v[168:171]
    v_mfma_f32_16x16x32_bf16 v[164:167], a[196:199], a[176:179], v[164:167]
    ds_read_b64_tr_b16 a[220:221], v241 offset:51200
    ds_read_b64_tr_b16 a[222:223], v241 offset:56320
    v_mfma_f32_16x16x32_bf16 v[172:175], a[196:199], a[180:183], v[172:175]
    s_waitcnt lgkmcnt(8)
    buffer_load_dwordx4 a[36:39], v11, s[24:27], s54 offen offset:1024 sc1
    v_mfma_f32_16x16x32_bf16 v[176:179], a[200:203], a[176:179], v[176:179]
    ds_read_b64_tr_b16 a[192:193], v240 offset:51264
    ds_read_b64_tr_b16 a[194:195], v240 offset:56384
    v_mfma_f32_16x16x32_bf16 v[184:187], a[200:203], a[180:183], v[184:187]
    v_mfma_f32_16x16x32_bf16 v[180:183], a[204:207], a[176:179], v[180:183]
    ds_read_b64_tr_b16 a[196:197], v241 offset:51264
    ds_read_b64_tr_b16 a[198:199], v241 offset:56384
    v_mfma_f32_16x16x32_bf16 v[188:191], a[204:207], a[180:183], v[188:191]
    s_waitcnt lgkmcnt(8)
    s_mov_b32 s54, 22528
    v_mfma_f32_16x16x32_bf16 v[192:195], a[208:211], a[176:179], v[192:195]
    ds_read_b64_tr_b16 a[200:201], v240 offset:51328
    ds_read_b64_tr_b16 a[202:203], v240 offset:56448
    v_mfma_f32_16x16x32_bf16 v[200:203], a[208:211], a[180:183], v[200:203]
    buffer_load_dwordx4 a[40:43], v11, s[24:27], s54 offen offset:0 sc1
    v_mfma_f32_16x16x32_bf16 v[196:199], a[212:215], a[176:179], v[196:199]
    ds_read_b64_tr_b16 a[204:205], v241 offset:51328
    ds_read_b64_tr_b16 a[206:207], v241 offset:56448
    v_mfma_f32_16x16x32_bf16 v[204:207], a[212:215], a[180:183], v[204:207]
    s_waitcnt lgkmcnt(8)
    v_mfma_f32_16x16x32_bf16 v[128:131], a[216:219], a[184:187], v[128:131]
    ds_read_b64_tr_b16 a[208:209], v240 offset:51392
    ds_read_b64_tr_b16 a[210:211], v240 offset:56512
    v_mfma_f32_16x16x32_bf16 v[136:139], a[216:219], a[188:191], v[136:139]
    buffer_load_dwordx4 v13, s[20:23], s53 offen offset:1024 lds
    v_mfma_f32_16x16x32_bf16 v[132:135], a[220:223], a[184:187], v[132:135]
    ds_read_b64_tr_b16 a[212:213], v241 offset:51392
    ds_read_b64_tr_b16 a[214:215], v241 offset:56512
    v_mfma_f32_16x16x32_bf16 v[140:143], a[220:223], a[188:191], v[140:143]
    s_waitcnt lgkmcnt(8)
    v_mfma_f32_16x16x32_bf16 v[144:147], a[192:195], a[184:187], v[144:147]
    ds_read_b64_tr_b16 a[216:217], v240 offset:51456
    ds_read_b64_tr_b16 a[218:219], v240 offset:56576
    v_mfma_f32_16x16x32_bf16 v[152:155], a[192:195], a[188:191], v[152:155]
    buffer_load_dwordx4 v14, s[20:23], s53 offen offset:2048 lds
    v_mfma_f32_16x16x32_bf16 v[148:151], a[196:199], a[184:187], v[148:151]
    ds_read_b64_tr_b16 a[220:221], v241 offset:51456
    ds_read_b64_tr_b16 a[222:223], v241 offset:56576
    v_mfma_f32_16x16x32_bf16 v[156:159], a[196:199], a[188:191], v[156:159]
    s_waitcnt lgkmcnt(8)
    v_mfma_f32_16x16x32_bf16 v[160:163], a[200:203], a[184:187], v[160:163]
    ds_read_b64_tr_b16 a[192:193], v242 offset:0
    ds_read_b64_tr_b16 a[194:195], v242 offset:5120
    v_mfma_f32_16x16x32_bf16 v[168:171], a[200:203], a[188:191], v[168:171]
    v_mfma_f32_16x16x32_bf16 v[164:167], a[204:207], a[184:187], v[164:167]
    ds_read_b64_tr_b16 a[196:197], v243 offset:0
    ds_read_b64_tr_b16 a[198:199], v243 offset:5120
    v_mfma_f32_16x16x32_bf16 v[172:175], a[204:207], a[188:191], v[172:175]
    s_waitcnt lgkmcnt(8)
    buffer_load_dwordx4 v15, s[20:23], s53 offen offset:3072 lds
    v_mfma_f32_16x16x32_bf16 v[176:179], a[208:211], a[184:187], v[176:179]
    ds_read_b64_tr_b16 a[200:201], v242 offset:64
    ds_read_b64_tr_b16 a[202:203], v242 offset:5184
    v_mfma_f32_16x16x32_bf16 v[184:187], a[208:211], a[188:191], v[184:187]
    v_mfma_f32_16x16x32_bf16 v[180:183], a[212:215], a[184:187], v[180:183]
    ds_read_b64_tr_b16 a[204:205], v243 offset:64
    ds_read_b64_tr_b16 a[206:207], v243 offset:5184
    v_mfma_f32_16x16x32_bf16 v[188:191], a[212:215], a[188:191], v[188:191]
    s_waitcnt lgkmcnt(8)
    s_add_u32 m0, s47, 24576
    v_mfma_f32_16x16x32_bf16 v[192:195], a[216:219], a[184:187], v[192:195]
    ds_read_b64_tr_b16 a[208:209], v242 offset:128
    ds_read_b64_tr_b16 a[210:211], v242 offset:5248
    v_mfma_f32_16x16x32_bf16 v[200:203], a[216:219], a[188:191], v[200:203]
    buffer_load_dwordx4 v16, s[20:23], s53 offen offset:0 lds
    v_mfma_f32_16x16x32_bf16 v[196:199], a[220:223], a[184:187], v[196:199]
    ds_read_b64_tr_b16 a[212:213], v243 offset:128
    ds_read_b64_tr_b16 a[214:215], v243 offset:5248
    v_mfma_f32_16x16x32_bf16 v[204:207], a[220:223], a[188:191], v[204:207]
    s_waitcnt vmcnt(13) lgkmcnt(8)
    v_mfma_f32_16x16x32_bf16 v[128:131], a[192:195], a[0:3], v[128:131]
    ds_read_b64_tr_b16 a[216:217], v242 offset:192
    ds_read_b64_tr_b16 a[218:219], v242 offset:5312
    v_mfma_f32_16x16x32_bf16 v[136:139], a[192:195], a[4:7], v[136:139]
    buffer_load_dwordx4 a[44:47], v11, s[24:27], s54 offen offset:1024 sc1
    v_mfma_f32_16x16x32_bf16 v[132:135], a[196:199], a[0:3], v[132:135]
    ds_read_b64_tr_b16 a[220:221], v243 offset:192
    ds_read_b64_tr_b16 a[222:223], v243 offset:5312
    v_mfma_f32_16x16x32_bf16 v[140:143], a[196:199], a[4:7], v[140:143]
    s_waitcnt lgkmcnt(8)
    v_mfma_f32_16x16x32_bf16 v[144:147], a[200:203], a[0:3], v[144:147]
    ds_read_b64_tr_b16 a[192:193], v242 offset:256
    ds_read_b64_tr_b16 a[194:195], v242 offset:5376
    v_mfma_f32_16x16x32_bf16 v[152:155], a[200:203], a[4:7], v[152:155]
    s_barrier
    s_mov_b32 s54, 30720
    v_mfma_f32_16x16x32_bf16 v[148:151], a[204:207], a[0:3], v[148:151]
    ds_read_b64_tr_b16 a[196:197], v243 offset:256
    ds_read_b64_tr_b16 a[198:199], v243 offset:5376
    v_mfma_f32_16x16x32_bf16 v[156:159], a[204:207], a[4:7], v[156:159]
    s_waitcnt lgkmcnt(8)
    buffer_load_dwordx4 a[48:51], v11, s[24:27], s54 offen offset:0 sc1
    v_mfma_f32_16x16x32_bf16 v[160:163], a[208:211], a[0:3], v[160:163]
    ds_read_b64_tr_b16 a[200:201], v242 offset:10240
    ds_read_b64_tr_b16 a[202:203], v242 offset:15360
    v_mfma_f32_16x16x32_bf16 v[168:171], a[208:211], a[4:7], v[168:171]
    v_mfma_f32_16x16x32_bf16 v[164:167], a[212:215], a[0:3], v[164:167]
    ds_read_b64_tr_b16 a[204:205], v243 offset:10240
    ds_read_b64_tr_b16 a[206:207], v243 offset:15360
    v_mfma_f32_16x16x32_bf16 v[172:175], a[212:215], a[4:7], v[172:175]
    s_waitcnt lgkmcnt(8)
    buffer_load_dwordx4 a[52:55], v11, s[24:27], s54 offen offset:1024 sc1
    v_mfma_f32_16x16x32_bf16 v[176:179], a[216:219], a[0:3], v[176:179]
    ds_read_b64_tr_b16 a[208:209], v242 offset:10304
    ds_read_b64_tr_b16 a[210:211], v242 offset:15424
    v_mfma_f32_16x16x32_bf16 v[184:187], a[216:219], a[4:7], v[184:187]
    v_mfma_f32_16x16x32_bf16 v[180:183], a[220:223], a[0:3], v[180:183]
    ds_read_b64_tr_b16 a[212:213], v243 offset:10304
    ds_read_b64_tr_b16 a[214:215], v243 offset:15424
    v_mfma_f32_16x16x32_bf16 v[188:191], a[220:223], a[4:7], v[188:191]
    s_waitcnt lgkmcnt(8)
    s_mov_b32 s54, 32768
    v_mfma_f32_16x16x32_bf16 v[192:195], a[192:195], a[0:3], v[192:195]
    ds_read_b64_tr_b16 a[216:217], v242 offset:10368
    ds_read_b64_tr_b16 a[218:219], v242 offset:15488
    v_mfma_f32_16x16x32_bf16 v[200:203], a[192:195], a[4:7], v[200:203]
    buffer_load_dwordx4 a[56:59], v11, s[24:27], s54 offen offset:0 sc1
    v_mfma_f32_16x16x32_bf16 v[196:199], a[196:199], a[0:3], v[196:199]
    ds_read_b64_tr_b16 a[220:221], v243 offset:10368
    ds_read_b64_tr_b16 a[222:223], v243 offset:15488
    v_mfma_f32_16x16x32_bf16 v[204:207], a[196:199], a[4:7], v[204:207]
    s_waitcnt vmcnt(15) lgkmcnt(8)
    v_mfma_f32_16x16x32_bf16 v[128:131], a[200:203], a[8:11], v[128:131]
    s_add_u32 m0, s47, 102400
    ds_read_b64_tr_b16 a[192:193], v242 offset:10432
    ds_read_b64_tr_b16 a[194:195], v242 offset:15552
    v_mfma_f32_16x16x32_bf16 v[136:139], a[200:203], a[12:15], v[136:139]
    s_add_u32 s53, s44, 696320
    buffer_load_dwordx4 v12, s[20:23], s53 offen offset:0 lds
    v_mfma_f32_16x16x32_bf16 v[132:135], a[204:207], a[8:11], v[132:135]
    ds_read_b64_tr_b16 a[196:197], v243 offset:10432
    ds_read_b64_tr_b16 a[198:199], v243 offset:15552
    v_mfma_f32_16x16x32_bf16 v[140:143], a[204:207], a[12:15], v[140:143]
    s_waitcnt lgkmcnt(8)
    v_mfma_f32_16x16x32_bf16 v[144:147], a[208:211], a[8:11], v[144:147]
    ds_read_b64_tr_b16 a[200:201], v242 offset:10496
    ds_read_b64_tr_b16 a[202:203], v242 offset:15616
    v_mfma_f32_16x16x32_bf16 v[152:155], a[208:211], a[12:15], v[152:155]
    buffer_load_dwordx4 v13, s[20:23], s53 offen offset:1024 lds
    v_mfma_f32_16x16x32_bf16 v[148:151], a[212:215], a[8:11], v[148:151]
    ds_read_b64_tr_b16 a[204:205], v243 offset:10496
    ds_read_b64_tr_b16 a[206:207], v243 offset:15616
    v_mfma_f32_16x16x32_bf16 v[156:159], a[212:215], a[12:15], v[156:159]
    s_waitcnt lgkmcnt(8)
    v_mfma_f32_16x16x32_bf16 v[160:163], a[216:219], a[8:11], v[160:163]
    ds_read_b64_tr_b16 a[208:209], v242 offset:20480
    ds_read_b64_tr_b16 a[210:211], v242 offset:25600
    v_mfma_f32_16x16x32_bf16 v[168:171], a[216:219], a[12:15], v[168:171]
    v_mfma_f32_16x16x32_bf16 v[164:167], a[220:223], a[8:11], v[164:167]
    ds_read_b64_tr_b16 a[212:213], v243 offset:20480
    ds_read_b64_tr_b16 a[214:215], v243 offset:25600
    v_mfma_f32_16x16x32_bf16 v[172:175], a[220:223], a[12:15], v[172:175]
    s_waitcnt lgkmcnt(8)
    buffer_load_dwordx4 v14, s[20:23], s53 offen offset:2048 lds
    v_mfma_f32_16x16x32_bf16 v[176:179], a[192:195], a[8:11], v[176:179]
    ds_read_b64_tr_b16 a[216:217], v242 offset:20544
    ds_read_b64_tr_b16 a[218:219], v242 offset:25664
    v_mfma_f32_16x16x32_bf16 v[184:187], a[192:195], a[12:15], v[184:187]
    v_mfma_f32_16x16x32_bf16 v[180:183], a[196:199], a[8:11], v[180:183]
    ds_read_b64_tr_b16 a[220:221], v243 offset:20544
    ds_read_b64_tr_b16 a[222:223], v243 offset:25664
    v_mfma_f32_16x16x32_bf16 v[188:191], a[196:199], a[12:15], v[188:191]
    s_waitcnt lgkmcnt(8)
    buffer_load_dwordx4 v15, s[20:23], s53 offen offset:3072 lds
    v_mfma_f32_16x16x32_bf16 v[192:195], a[200:203], a[8:11], v[192:195]
    ds_read_b64_tr_b16 a[192:193], v242 offset:20608
    ds_read_b64_tr_b16 a[194:195], v242 offset:25728
    v_mfma_f32_16x16x32_bf16 v[200:203], a[200:203], a[12:15], v[200:203]
    v_mfma_f32_16x16x32_bf16 v[196:199], a[204:207], a[8:11], v[196:199]
    ds_read_b64_tr_b16 a[196:197], v243 offset:20608
    ds_read_b64_tr_b16 a[198:199], v243 offset:25728
    v_mfma_f32_16x16x32_bf16 v[204:207], a[204:207], a[12:15], v[204:207]
    s_waitcnt vmcnt(17) lgkmcnt(8)
    v_mfma_f32_16x16x32_bf16 v[128:131], a[208:211], a[16:19], v[128:131]
    s_add_u32 m0, s47, 106496
    ds_read_b64_tr_b16 a[200:201], v242 offset:20672
    ds_read_b64_tr_b16 a[202:203], v242 offset:25792
    v_mfma_f32_16x16x32_bf16 v[136:139], a[208:211], a[20:23], v[136:139]
    s_sub_u32 s51, s48, s40
    buffer_load_dwordx4 v16, s[20:23], s53 offen offset:0 lds
    v_mfma_f32_16x16x32_bf16 v[132:135], a[212:215], a[16:19], v[132:135]
    s_and_b32 s51, s51, 3
    ds_read_b64_tr_b16 a[204:205], v243 offset:20672
    ds_read_b64_tr_b16 a[206:207], v243 offset:25792
    v_mfma_f32_16x16x32_bf16 v[140:143], a[212:215], a[20:23], v[140:143]
    s_waitcnt lgkmcnt(8)
    s_mul_i32 s50, s48, 10240
    s_mov_b32 s49, 20480
    v_mfma_f32_16x16x32_bf16 v[144:147], a[216:219], a[16:19], v[144:147]
    s_lshl_b32 s3, s48, 7
    ds_read_b64_tr_b16 a[208:209], v242 offset:20736
    ds_read_b64_tr_b16 a[210:211], v242 offset:25856
    v_mfma_f32_16x16x32_bf16 v[152:155], a[216:219], a[20:23], v[152:155]
    s_barrier
    s_add_u32 s3, s3, s46
    v_mfma_f32_16x16x32_bf16 v[148:151], a[220:223], a[16:19], v[148:151]
    ds_read_b64_tr_b16 a[212:213], v243 offset:20736
    ds_read_b64_tr_b16 a[214:215], v243 offset:25856
    v_mfma_f32_16x16x32_bf16 v[156:159], a[220:223], a[20:23], v[156:159]
    s_waitcnt lgkmcnt(8)
    buffer_load_dwordx4 a[60:63], v11, s[24:27], s54 offen offset:1024 sc1
    v_mfma_f32_16x16x32_bf16 v[160:163], a[192:195], a[16:19], v[160:163]
    ds_read_b64_tr_b16 a[216:217], v242 offset:30720
    ds_read_b64_tr_b16 a[218:219], v242 offset:35840
    v_mfma_f32_16x16x32_bf16 v[168:171], a[192:195], a[20:23], v[168:171]
    v_mov_b32 v1, s3
    v_and_b32 v3, 48, v0
    v_mfma_f32_16x16x32_bf16 v[164:167], a[196:199], a[16:19], v[164:167]
    s_mov_b32 s54, 34816
    ds_read_b64_tr_b16 a[220:221], v243 offset:30720
    ds_read_b64_tr_b16 a[222:223], v243 offset:35840
    v_mfma_f32_16x16x32_bf16 v[172:175], a[196:199], a[20:23], v[172:175]
    s_waitcnt lgkmcnt(8)
    buffer_load_dwordx4 a[64:67], v11, s[24:27], s54 offen offset:0 sc1
    v_mfma_f32_16x16x32_bf16 v[176:179], a[200:203], a[16:19], v[176:179]
    ds_read_b64_tr_b16 a[192:193], v242 offset:30784
    ds_read_b64_tr_b16 a[194:195], v242 offset:35904
    v_mfma_f32_16x16x32_bf16 v[184:187], a[200:203], a[20:23], v[184:187]
    v_lshl_add_u32 v3, v3, 3, s46
    v_mov_b32 v38, 0x3f80
    v_mfma_f32_16x16x32_bf16 v[180:183], a[204:207], a[16:19], v[180:183]
    ds_read_b64_tr_b16 a[196:197], v243 offset:30784
    ds_read_b64_tr_b16 a[198:199], v243 offset:35904
    v_mfma_f32_16x16x32_bf16 v[188:191], a[204:207], a[20:23], v[188:191]
    s_waitcnt lgkmcnt(8)
    buffer_load_dwordx4 a[68:71], v11, s[24:27], s54 offen offset:1024 sc1
    v_mfma_f32_16x16x32_bf16 v[192:195], a[208:211], a[16:19], v[192:195]
    ds_read_b64_tr_b16 a[200:201], v242 offset:30848
    ds_read_b64_tr_b16 a[202:203], v242 offset:35968
    v_mfma_f32_16x16x32_bf16 v[200:203], a[208:211], a[20:23], v[200:203]
    v_mov_b32 v39, 0x3f800000
    v_mfma_f32_16x16x32_bf16 v[196:199], a[212:215], a[16:19], v[196:199]
    ds_read_b64_tr_b16 a[204:205], v243 offset:30848
    ds_read_b64_tr_b16 a[206:207], v243 offset:35968
    v_mfma_f32_16x16x32_bf16 v[204:207], a[212:215], a[20:23], v[204:207]
    s_waitcnt vmcnt(19) lgkmcnt(8)
    v_mfma_f32_16x16x32_bf16 v[128:131], a[216:219], a[24:27], v[128:131]
    s_mov_b32 s54, 43008
    ds_read_b64_tr_b16 a[208:209], v242 offset:30912
    ds_read_b64_tr_b16 a[210:211], v242 offset:36032
    v_mfma_f32_16x16x32_bf16 v[136:139], a[216:219], a[28:31], v[136:139]
    buffer_load_dwordx4 a[72:75], v11, s[24:27], s54 offen offset:0 sc1
    v_mfma_f32_16x16x32_bf16 v[132:135], a[220:223], a[24:27], v[132:135]
    ds_read_b64_tr_b16 a[212:213], v243 offset:30912
    ds_read_b64_tr_b16 a[214:215], v243 offset:36032
    v_mfma_f32_16x16x32_bf16 v[140:143], a[220:223], a[28:31], v[140:143]
    s_waitcnt lgkmcnt(8)
    v_mfma_f32_16x16x32_bf16 v[144:147], a[192:195], a[24:27], v[144:147]
    ds_read_b64_tr_b16 a[216:217], v242 offset:30976
    ds_read_b64_tr_b16 a[218:219], v242 offset:36096
    v_mfma_f32_16x16x32_bf16 v[152:155], a[192:195], a[28:31], v[152:155]
    s_add_u32 m0, s47, 122880
    s_add_u32 s53, s42, 901120
    v_mfma_f32_16x16x32_bf16 v[148:151], a[196:199], a[24:27], v[148:151]
    ds_read_b64_tr_b16 a[220:221], v243 offset:30976
    ds_read_b64_tr_b16 a[222:223], v243 offset:36096
    v_mfma_f32_16x16x32_bf16 v[156:159], a[196:199], a[28:31], v[156:159]
    s_waitcnt lgkmcnt(8)
    buffer_load_dwordx4 v12, s[20:23], s53 offen offset:0 lds
    v_mfma_f32_16x16x32_bf16 v[160:163], a[200:203], a[24:27], v[160:163]
    ds_read_b64_tr_b16 a[192:193], v240 offset:0
    ds_read_b64_tr_b16 a[194:195], v240 offset:5120
    v_mfma_f32_16x16x32_bf16 v[168:171], a[200:203], a[28:31], v[168:171]
    v_mfma_f32_16x16x32_bf16 v[164:167], a[204:207], a[24:27], v[164:167]
    ds_read_b64_tr_b16 a[196:197], v241 offset:0
    ds_read_b64_tr_b16 a[198:199], v241 offset:5120
    v_mfma_f32_16x16x32_bf16 v[172:175], a[204:207], a[28:31], v[172:175]
    s_waitcnt lgkmcnt(8)
    buffer_load_dwordx4 v13, s[20:23], s53 offen offset:1024 lds
    v_mfma_f32_16x16x32_bf16 v[176:179], a[208:211], a[24:27], v[176:179]
    ds_read_b64_tr_b16 a[200:201], v240 offset:64
    ds_read_b64_tr_b16 a[202:203], v240 offset:5184
    v_mfma_f32_16x16x32_bf16 v[184:187], a[208:211], a[28:31], v[184:187]
    v_mfma_f32_16x16x32_bf16 v[180:183], a[212:215], a[24:27], v[180:183]
    ds_read_b64_tr_b16 a[204:205], v241 offset:64
    ds_read_b64_tr_b16 a[206:207], v241 offset:5184
    v_mfma_f32_16x16x32_bf16 v[188:191], a[212:215], a[28:31], v[188:191]
    s_waitcnt lgkmcnt(8)
    buffer_load_dwordx4 v14, s[20:23], s53 offen offset:2048 lds
    v_mfma_f32_16x16x32_bf16 v[192:195], a[216:219], a[24:27], v[192:195]
    ds_read_b64_tr_b16 a[208:209], v240 offset:128
    ds_read_b64_tr_b16 a[210:211], v240 offset:5248
    v_mfma_f32_16x16x32_bf16 v[200:203], a[216:219], a[28:31], v[200:203]
    v_mfma_f32_16x16x32_bf16 v[196:199], a[220:223], a[24:27], v[196:199]
    ds_read_b64_tr_b16 a[212:213], v241 offset:128
    ds_read_b64_tr_b16 a[214:215], v241 offset:5248
    v_mfma_f32_16x16x32_bf16 v[204:207], a[220:223], a[28:31], v[204:207]
    s_waitcnt vmcnt(21) lgkmcnt(8)
    v_mfma_f32_16x16x32_bf16 v[128:131], a[192:195], a[32:35], v[128:131]
    ds_read_b64_tr_b16 a[216:217], v240 offset:192
    ds_read_b64_tr_b16 a[218:219], v240 offset:5312
    v_mfma_f32_16x16x32_bf16 v[136:139], a[192:195], a[36:39], v[136:139]
    buffer_load_dwordx4 v15, s[20:23], s53 offen offset:3072 lds
    v_mfma_f32_16x16x32_bf16 v[132:135], a[196:199], a[32:35], v[132:135]
    ds_read_b64_tr_b16 a[220:221], v241 offset:192
    ds_read_b64_tr_b16 a[222:223], v241 offset:5312
    v_mfma_f32_16x16x32_bf16 v[140:143], a[196:199], a[36:39], v[140:143]
    s_waitcnt lgkmcnt(8)
    v_mfma_f32_16x16x32_bf16 v[144:147], a[200:203], a[32:35], v[144:147]
    ds_read_b64_tr_b16 a[192:193], v240 offset:256
    ds_read_b64_tr_b16 a[194:195], v240 offset:5376
    v_mfma_f32_16x16x32_bf16 v[152:155], a[200:203], a[36:39], v[152:155]
    s_waitcnt vmcnt(17)
    s_barrier
    s_add_u32 m0, s47, 126976
    v_mfma_f32_16x16x32_bf16 v[148:151], a[204:207], a[32:35], v[148:151]
    ds_read_b64_tr_b16 a[196:197], v241 offset:256
    ds_read_b64_tr_b16 a[198:199], v241 offset:5376
    v_mfma_f32_16x16x32_bf16 v[156:159], a[204:207], a[36:39], v[156:159]
    s_waitcnt lgkmcnt(8)
    buffer_load_dwordx4 v16, s[20:23], s53 offen offset:0 lds
    v_mfma_f32_16x16x32_bf16 v[160:163], a[208:211], a[32:35], v[160:163]
    ds_read_b64_tr_b16 a[200:201], v240 offset:10240
    ds_read_b64_tr_b16 a[202:203], v240 offset:15360
    v_mfma_f32_16x16x32_bf16 v[168:171], a[208:211], a[36:39], v[168:171]
    v_mfma_f32_16x16x32_bf16 v[164:167], a[212:215], a[32:35], v[164:167]
    ds_read_b64_tr_b16 a[204:205], v241 offset:10240
    ds_read_b64_tr_b16 a[206:207], v241 offset:15360
    v_mfma_f32_16x16x32_bf16 v[172:175], a[212:215], a[36:39], v[172:175]
    s_waitcnt lgkmcnt(8)
    buffer_load_dwordx4 a[76:79], v11, s[24:27], s54 offen offset:1024 sc1
    v_mfma_f32_16x16x32_bf16 v[176:179], a[216:219], a[32:35], v[176:179]
    ds_read_b64_tr_b16 a[208:209], v240 offset:10304
    ds_read_b64_tr_b16 a[210:211], v240 offset:15424
    v_mfma_f32_16x16x32_bf16 v[184:187], a[216:219], a[36:39], v[184:187]
    v_mfma_f32_16x16x32_bf16 v[180:183], a[220:223], a[32:35], v[180:183]
    ds_read_b64_tr_b16 a[212:213], v241 offset:10304
    ds_read_b64_tr_b16 a[214:215], v241 offset:15424
    v_mfma_f32_16x16x32_bf16 v[188:191], a[220:223], a[36:39], v[188:191]
    s_waitcnt lgkmcnt(8)
    s_mov_b32 s54, 45056
    v_mfma_f32_16x16x32_bf16 v[192:195], a[192:195], a[32:35], v[192:195]
    ds_read_b64_tr_b16 a[216:217], v240 offset:10368
    ds_read_b64_tr_b16 a[218:219], v240 offset:15488
    v_mfma_f32_16x16x32_bf16 v[200:203], a[192:195], a[36:39], v[200:203]
    buffer_load_dwordx4 a[80:83], v11, s[24:27], s54 offen offset:0 sc1
    v_mfma_f32_16x16x32_bf16 v[196:199], a[196:199], a[32:35], v[196:199]
    ds_read_b64_tr_b16 a[220:221], v241 offset:10368
    ds_read_b64_tr_b16 a[222:223], v241 offset:15488
    v_mfma_f32_16x16x32_bf16 v[204:207], a[196:199], a[36:39], v[204:207]
    s_waitcnt vmcnt(19) lgkmcnt(8)
    v_mfma_f32_16x16x32_bf16 v[128:131], a[200:203], a[40:43], v[128:131]
    ds_read_b64_tr_b16 a[192:193], v240 offset:10432
    ds_read_b64_tr_b16 a[194:195], v240 offset:15552
    v_mfma_f32_16x16x32_bf16 v[136:139], a[200:203], a[44:47], v[136:139]
    buffer_load_dwordx4 a[84:87], v11, s[24:27], s54 offen offset:1024 sc1
    v_mfma_f32_16x16x32_bf16 v[132:135], a[204:207], a[40:43], v[132:135]
    ds_read_b64_tr_b16 a[196:197], v241 offset:10432
    ds_read_b64_tr_b16 a[198:199], v241 offset:15552
    v_mfma_f32_16x16x32_bf16 v[140:143], a[204:207], a[44:47], v[140:143]
    s_waitcnt lgkmcnt(8)
    v_mfma_f32_16x16x32_bf16 v[144:147], a[208:211], a[40:43], v[144:147]
    ds_read_b64_tr_b16 a[200:201], v240 offset:10496
    ds_read_b64_tr_b16 a[202:203], v240 offset:15616
    v_mfma_f32_16x16x32_bf16 v[152:155], a[208:211], a[44:47], v[152:155]
    s_mov_b32 s54, 47104
    buffer_load_dwordx4 a[88:91], v11, s[24:27], s54 offen offset:0 sc1
    v_mfma_f32_16x16x32_bf16 v[148:151], a[212:215], a[40:43], v[148:151]
    ds_read_b64_tr_b16 a[204:205], v241 offset:10496
    ds_read_b64_tr_b16 a[206:207], v241 offset:15616
    v_mfma_f32_16x16x32_bf16 v[156:159], a[212:215], a[44:47], v[156:159]
    s_waitcnt lgkmcnt(8)
    v_mfma_f32_16x16x32_bf16 v[160:163], a[216:219], a[40:43], v[160:163]
    ds_read_b64_tr_b16 a[208:209], v240 offset:20480
    ds_read_b64_tr_b16 a[210:211], v240 offset:25600
    v_mfma_f32_16x16x32_bf16 v[168:171], a[216:219], a[44:47], v[168:171]
    v_mfma_f32_16x16x32_bf16 v[164:167], a[220:223], a[40:43], v[164:167]
    s_add_u32 m0, s47, 143360
    ds_read_b64_tr_b16 a[212:213], v241 offset:20480
    ds_read_b64_tr_b16 a[214:215], v241 offset:25600
    v_mfma_f32_16x16x32_bf16 v[172:175], a[220:223], a[44:47], v[172:175]
    s_waitcnt lgkmcnt(8)
    s_add_u32 s53, s42, 1105920
    v_mfma_f32_16x16x32_bf16 v[176:179], a[192:195], a[40:43], v[176:179]
    ds_read_b64_tr_b16 a[216:217], v240 offset:20544
    ds_read_b64_tr_b16 a[218:219], v240 offset:25664
    v_mfma_f32_16x16x32_bf16 v[184:187], a[192:195], a[44:47], v[184:187]
    buffer_load_dwordx4 v12, s[20:23], s53 offen offset:0 lds
    v_mfma_f32_16x16x32_bf16 v[180:183], a[196:199], a[40:43], v[180:183]
    ds_read_b64_tr_b16 a[220:221], v241 offset:20544
    ds_read_b64_tr_b16 a[222:223], v241 offset:25664
    v_mfma_f32_16x16x32_bf16 v[188:191], a[196:199], a[44:47], v[188:191]
    s_waitcnt lgkmcnt(8)
    buffer_load_dwordx4 v13, s[20:23], s53 offen offset:1024 lds
    v_mfma_f32_16x16x32_bf16 v[192:195], a[200:203], a[40:43], v[192:195]
    ds_read_b64_tr_b16 a[192:193], v240 offset:20608
    ds_read_b64_tr_b16 a[194:195], v240 offset:25728
    v_mfma_f32_16x16x32_bf16 v[200:203], a[200:203], a[44:47], v[200:203]
    v_mfma_f32_16x16x32_bf16 v[196:199], a[204:207], a[40:43], v[196:199]
    ds_read_b64_tr_b16 a[196:197], v241 offset:20608
    ds_read_b64_tr_b16 a[198:199], v241 offset:25728
    v_mfma_f32_16x16x32_bf16 v[204:207], a[204:207], a[44:47], v[204:207]
    s_waitcnt vmcnt(21) lgkmcnt(8)
    v_mfma_f32_16x16x32_bf16 v[128:131], a[208:211], a[48:51], v[128:131]
    ds_read_b64_tr_b16 a[200:201], v240 offset:20672
    ds_read_b64_tr_b16 a[202:203], v240 offset:25792
    v_mfma_f32_16x16x32_bf16 v[136:139], a[208:211], a[52:55], v[136:139]
    buffer_load_dwordx4 v14, s[20:23], s53 offen offset:2048 lds
    v_mfma_f32_16x16x32_bf16 v[132:135], a[212:215], a[48:51], v[132:135]
    ds_read_b64_tr_b16 a[204:205], v241 offset:20672
    ds_read_b64_tr_b16 a[206:207], v241 offset:25792
    v_mfma_f32_16x16x32_bf16 v[140:143], a[212:215], a[52:55], v[140:143]
    s_waitcnt lgkmcnt(8)
    v_mfma_f32_16x16x32_bf16 v[144:147], a[216:219], a[48:51], v[144:147]
    ds_read_b64_tr_b16 a[208:209], v240 offset:20736
    ds_read_b64_tr_b16 a[210:211], v240 offset:25856
    v_mfma_f32_16x16x32_bf16 v[152:155], a[216:219], a[52:55], v[152:155]
    s_waitcnt vmcnt(16)
    s_barrier
    v_mfma_f32_16x16x32_bf16 v[148:151], a[220:223], a[48:51], v[148:151]
    ds_read_b64_tr_b16 a[212:213], v241 offset:20736
    ds_read_b64_tr_b16 a[214:215], v241 offset:25856
    v_mfma_f32_16x16x32_bf16 v[156:159], a[220:223], a[52:55], v[156:159]
    s_waitcnt lgkmcnt(8)
    buffer_load_dwordx4 v15, s[20:23], s53 offen offset:3072 lds
    v_mfma_f32_16x16x32_bf16 v[160:163], a[192:195], a[48:51], v[160:163]
    ds_read_b64_tr_b16 a[216:217], v240 offset:30720
    ds_read_b64_tr_b16 a[218:219], v240 offset:35840
    v_mfma_f32_16x16x32_bf16 v[168:171], a[192:195], a[52:55], v[168:171]
    v_mfma_f32_16x16x32_bf16 v[164:167], a[196:199], a[48:51], v[164:167]
    s_add_u32 m0, s47, 147456
    ds_read_b64_tr_b16 a[220:221], v241 offset:30720
    ds_read_b64_tr_b16 a[222:223], v241 offset:35840
    v_mfma_f32_16x16x32_bf16 v[172:175], a[196:199], a[52:55], v[172:175]
    s_waitcnt lgkmcnt(8)
    buffer_load_dwordx4 v16, s[20:23], s53 offen offset:0 lds
    v_mfma_f32_16x16x32_bf16 v[176:179], a[200:203], a[48:51], v[176:179]
    ds_read_b64_tr_b16 a[192:193], v240 offset:30784
    ds_read_b64_tr_b16 a[194:195], v240 offset:35904
    v_mfma_f32_16x16x32_bf16 v[184:187], a[200:203], a[52:55], v[184:187]
    v_mfma_f32_16x16x32_bf16 v[180:183], a[204:207], a[48:51], v[180:183]
    ds_read_b64_tr_b16 a[196:197], v241 offset:30784
    ds_read_b64_tr_b16 a[198:199], v241 offset:35904
    v_mfma_f32_16x16x32_bf16 v[188:191], a[204:207], a[52:55], v[188:191]
    s_waitcnt lgkmcnt(8)
    buffer_load_dwordx4 a[92:95], v11, s[24:27], s54 offen offset:1024 sc1
    v_mfma_f32_16x16x32_bf16 v[192:195], a[208:211], a[48:51], v[192:195]
    ds_read_b64_tr_b16 a[200:201], v240 offset:30848
    ds_read_b64_tr_b16 a[202:203], v240 offset:35968
    v_mfma_f32_16x16x32_bf16 v[200:203], a[208:211], a[52:55], v[200:203]
    v_mfma_f32_16x16x32_bf16 v[196:199], a[212:215], a[48:51], v[196:199]
    ds_read_b64_tr_b16 a[204:205], v241 offset:30848
    ds_read_b64_tr_b16 a[206:207], v241 offset:35968
    v_mfma_f32_16x16x32_bf16 v[204:207], a[212:215], a[52:55], v[204:207]
    s_waitcnt vmcnt(18) lgkmcnt(8)
    v_mfma_f32_16x16x32_bf16 v[128:131], a[216:219], a[56:59], v[128:131]
    s_mov_b32 s54, 55296
    ds_read_b64_tr_b16 a[208:209], v240 offset:30912
    ds_read_b64_tr_b16 a[210:211], v240 offset:36032
    v_mfma_f32_16x16x32_bf16 v[136:139], a[216:219], a[60:63], v[136:139]
    buffer_load_dwordx4 a[96:99], v11, s[24:27], s54 offen offset:0 sc1
    v_mfma_f32_16x16x32_bf16 v[132:135], a[220:223], a[56:59], v[132:135]
    ds_read_b64_tr_b16 a[212:213], v241 offset:30912
    ds_read_b64_tr_b16 a[214:215], v241 offset:36032
    v_mfma_f32_16x16x32_bf16 v[140:143], a[220:223], a[60:63], v[140:143]
    s_waitcnt lgkmcnt(8)
    v_mfma_f32_16x16x32_bf16 v[144:147], a[192:195], a[56:59], v[144:147]
    ds_read_b64_tr_b16 a[216:217], v240 offset:30976
    ds_read_b64_tr_b16 a[218:219], v240 offset:36096
    v_mfma_f32_16x16x32_bf16 v[152:155], a[192:195], a[60:63], v[152:155]
    buffer_load_dwordx4 a[100:103], v11, s[24:27], s54 offen offset:1024 sc1
    v_mfma_f32_16x16x32_bf16 v[148:151], a[196:199], a[56:59], v[148:151]
    ds_read_b64_tr_b16 a[220:221], v241 offset:30976
    ds_read_b64_tr_b16 a[222:223], v241 offset:36096
    v_mfma_f32_16x16x32_bf16 v[156:159], a[196:199], a[60:63], v[156:159]
    s_waitcnt lgkmcnt(8)
    v_mfma_f32_16x16x32_bf16 v[160:163], a[200:203], a[56:59], v[160:163]
    ds_read_b64_tr_b16 a[192:193], v242 offset:40960
    ds_read_b64_tr_b16 a[194:195], v242 offset:46080
    v_mfma_f32_16x16x32_bf16 v[168:171], a[200:203], a[60:63], v[168:171]
    v_mfma_f32_16x16x32_bf16 v[164:167], a[204:207], a[56:59], v[164:167]
    s_mov_b32 s54, 57344
    ds_read_b64_tr_b16 a[196:197], v243 offset:40960
    ds_read_b64_tr_b16 a[198:199], v243 offset:46080
    v_mfma_f32_16x16x32_bf16 v[172:175], a[204:207], a[60:63], v[172:175]
    s_waitcnt lgkmcnt(8)
    buffer_load_dwordx4 a[104:107], v11, s[24:27], s54 offen offset:0 sc1
    v_mfma_f32_16x16x32_bf16 v[176:179], a[208:211], a[56:59], v[176:179]
    ds_read_b64_tr_b16 a[200:201], v242 offset:41024
    ds_read_b64_tr_b16 a[202:203], v242 offset:46144
    v_mfma_f32_16x16x32_bf16 v[184:187], a[208:211], a[60:63], v[184:187]
    v_mfma_f32_16x16x32_bf16 v[180:183], a[212:215], a[56:59], v[180:183]
    ds_read_b64_tr_b16 a[204:205], v243 offset:41024
    ds_read_b64_tr_b16 a[206:207], v243 offset:46144
    v_mfma_f32_16x16x32_bf16 v[188:191], a[212:215], a[60:63], v[188:191]
    s_waitcnt lgkmcnt(8)
    s_add_u32 m0, s47, 40960
    s_add_u32 s53, s44, 1187840
    v_mfma_f32_16x16x32_bf16 v[192:195], a[216:219], a[56:59], v[192:195]
    ds_read_b64_tr_b16 a[208:209], v242 offset:41088
    ds_read_b64_tr_b16 a[210:211], v242 offset:46208
    v_mfma_f32_16x16x32_bf16 v[200:203], a[216:219], a[60:63], v[200:203]
    buffer_load_dwordx4 v12, s[20:23], s53 offen offset:0 lds
    v_mfma_f32_16x16x32_bf16 v[196:199], a[220:223], a[56:59], v[196:199]
    ds_read_b64_tr_b16 a[212:213], v243 offset:41088
    ds_read_b64_tr_b16 a[214:215], v243 offset:46208
    v_mfma_f32_16x16x32_bf16 v[204:207], a[220:223], a[60:63], v[204:207]
    s_waitcnt vmcnt(20) lgkmcnt(8)
    v_mfma_f32_16x16x32_bf16 v[128:131], a[192:195], a[64:67], v[128:131]
    ds_read_b64_tr_b16 a[216:217], v242 offset:41152
    ds_read_b64_tr_b16 a[218:219], v242 offset:46272
    v_mfma_f32_16x16x32_bf16 v[136:139], a[192:195], a[68:71], v[136:139]
    buffer_load_dwordx4 v13, s[20:23], s53 offen offset:1024 lds
    v_mfma_f32_16x16x32_bf16 v[132:135], a[196:199], a[64:67], v[132:135]
    ds_read_b64_tr_b16 a[220:221], v243 offset:41152
    ds_read_b64_tr_b16 a[222:223], v243 offset:46272
    v_mfma_f32_16x16x32_bf16 v[140:143], a[196:199], a[68:71], v[140:143]
    s_waitcnt lgkmcnt(8)
    v_mfma_f32_16x16x32_bf16 v[144:147], a[200:203], a[64:67], v[144:147]
    ds_read_b64_tr_b16 a[192:193], v242 offset:41216
    ds_read_b64_tr_b16 a[194:195], v242 offset:46336
    v_mfma_f32_16x16x32_bf16 v[152:155], a[200:203], a[68:71], v[152:155]
    s_waitcnt vmcnt(15)
    s_barrier
    v_mfma_f32_16x16x32_bf16 v[148:151], a[204:207], a[64:67], v[148:151]
    ds_read_b64_tr_b16 a[196:197], v243 offset:41216
    ds_read_b64_tr_b16 a[198:199], v243 offset:46336
    v_mfma_f32_16x16x32_bf16 v[156:159], a[204:207], a[68:71], v[156:159]
    s_waitcnt lgkmcnt(8)
    buffer_load_dwordx4 v14, s[20:23], s53 offen offset:2048 lds
    v_mfma_f32_16x16x32_bf16 v[160:163], a[208:211], a[64:67], v[160:163]
    ds_read_b64_tr_b16 a[200:201], v242 offset:51200
    ds_read_b64_tr_b16 a[202:203], v242 offset:56320
    v_mfma_f32_16x16x32_bf16 v[168:171], a[208:211], a[68:71], v[168:171]
    v_mfma_f32_16x16x32_bf16 v[164:167], a[212:215], a[64:67], v[164:167]
    ds_read_b64_tr_b16 a[204:205], v243 offset:51200
    ds_read_b64_tr_b16 a[206:207], v243 offset:56320
    v_mfma_f32_16x16x32_bf16 v[172:175], a[212:215], a[68:71], v[172:175]
    s_waitcnt lgkmcnt(8)
    buffer_load_dwordx4 v15, s[20:23], s53 offen offset:3072 lds
    v_mfma_f32_16x16x32_bf16 v[176:179], a[216:219], a[64:67], v[176:179]
    ds_read_b64_tr_b16 a[208:209], v242 offset:51264
    ds_read_b64_tr_b16 a[210:211], v242 offset:56384
    v_mfma_f32_16x16x32_bf16 v[184:187], a[216:219], a[68:71], v[184:187]
    v_mfma_f32_16x16x32_bf16 v[180:183], a[220:223], a[64:67], v[180:183]
    ds_read_b64_tr_b16 a[212:213], v243 offset:51264
    ds_read_b64_tr_b16 a[214:215], v243 offset:56384
    v_mfma_f32_16x16x32_bf16 v[188:191], a[220:223], a[68:71], v[188:191]
    s_waitcnt lgkmcnt(8)
    s_add_u32 m0, s47, 45056
    v_mfma_f32_16x16x32_bf16 v[192:195], a[192:195], a[64:67], v[192:195]
    ds_read_b64_tr_b16 a[216:217], v242 offset:51328
    ds_read_b64_tr_b16 a[218:219], v242 offset:56448
    v_mfma_f32_16x16x32_bf16 v[200:203], a[192:195], a[68:71], v[200:203]
    buffer_load_dwordx4 v16, s[20:23], s53 offen offset:0 lds
    v_mfma_f32_16x16x32_bf16 v[196:199], a[196:199], a[64:67], v[196:199]
    ds_read_b64_tr_b16 a[220:221], v243 offset:51328
    ds_read_b64_tr_b16 a[222:223], v243 offset:56448
    v_mfma_f32_16x16x32_bf16 v[204:207], a[196:199], a[68:71], v[204:207]
    s_waitcnt vmcnt(17) lgkmcnt(8)
    v_mfma_f32_16x16x32_bf16 v[128:131], a[200:203], a[72:75], v[128:131]
    ds_read_b64_tr_b16 a[192:193], v242 offset:51392
    ds_read_b64_tr_b16 a[194:195], v242 offset:56512
    v_mfma_f32_16x16x32_bf16 v[136:139], a[200:203], a[76:79], v[136:139]
    buffer_load_dwordx4 a[108:111], v11, s[24:27], s54 offen offset:1024 sc1
    v_mfma_f32_16x16x32_bf16 v[132:135], a[204:207], a[72:75], v[132:135]
    ds_read_b64_tr_b16 a[196:197], v243 offset:51392
    ds_read_b64_tr_b16 a[198:199], v243 offset:56512
    v_mfma_f32_16x16x32_bf16 v[140:143], a[204:207], a[76:79], v[140:143]
    s_waitcnt lgkmcnt(8)
    v_mfma_f32_16x16x32_bf16 v[144:147], a[208:211], a[72:75], v[144:147]
    ds_read_b64_tr_b16 a[200:201], v242 offset:51456
    ds_read_b64_tr_b16 a[202:203], v242 offset:56576
    v_mfma_f32_16x16x32_bf16 v[152:155], a[208:211], a[76:79], v[152:155]
    s_mov_b32 s54, 59392
    buffer_load_dwordx4 a[112:115], v11, s[24:27], s54 offen offset:0 sc1
    v_mfma_f32_16x16x32_bf16 v[148:151], a[212:215], a[72:75], v[148:151]
    ds_read_b64_tr_b16 a[204:205], v243 offset:51456
    ds_read_b64_tr_b16 a[206:207], v243 offset:56576
    v_mfma_f32_16x16x32_bf16 v[156:159], a[212:215], a[76:79], v[156:159]
    s_waitcnt lgkmcnt(8)
    v_mfma_f32_16x16x32_bf16 v[160:163], a[216:219], a[72:75], v[160:163]
    ds_read_b64_tr_b16 a[208:209], v244 offset:0
    ds_read_b64_tr_b16 a[210:211], v244 offset:5120
    v_mfma_f32_16x16x32_bf16 v[168:171], a[216:219], a[76:79], v[168:171]
    v_mfma_f32_16x16x32_bf16 v[164:167], a[220:223], a[72:75], v[164:167]
    ds_read_b64_tr_b16 a[212:213], v245 offset:0
    ds_read_b64_tr_b16 a[214:215], v245 offset:5120
    v_mfma_f32_16x16x32_bf16 v[172:175], a[220:223], a[76:79], v[172:175]
    s_waitcnt lgkmcnt(8)
    buffer_load_dwordx4 a[116:119], v11, s[24:27], s54 offen offset:1024 sc1
    v_mfma_f32_16x16x32_bf16 v[176:179], a[192:195], a[72:75], v[176:179]
    ds_read_b64_tr_b16 a[216:217], v244 offset:64
    ds_read_b64_tr_b16 a[218:219], v244 offset:5184
    v_mfma_f32_16x16x32_bf16 v[184:187], a[192:195], a[76:79], v[184:187]
    v_mfma_f32_16x16x32_bf16 v[180:183], a[196:199], a[72:75], v[180:183]
    ds_read_b64_tr_b16 a[220:221], v245 offset:64
    ds_read_b64_tr_b16 a[222:223], v245 offset:5184
    v_mfma_f32_16x16x32_bf16 v[188:191], a[196:199], a[76:79], v[188:191]
    s_waitcnt lgkmcnt(8)
    s_mov_b32 s54, 67584
    v_mfma_f32_16x16x32_bf16 v[192:195], a[200:203], a[72:75], v[192:195]
    ds_read_b64_tr_b16 a[192:193], v244 offset:128
    ds_read_b64_tr_b16 a[194:195], v244 offset:5248
    v_mfma_f32_16x16x32_bf16 v[200:203], a[200:203], a[76:79], v[200:203]
    buffer_load_dwordx4 a[120:123], v11, s[24:27], s54 offen offset:0 sc1
    v_mfma_f32_16x16x32_bf16 v[196:199], a[204:207], a[72:75], v[196:199]
    ds_read_b64_tr_b16 a[196:197], v245 offset:128
    ds_read_b64_tr_b16 a[198:199], v245 offset:5248
    v_mfma_f32_16x16x32_bf16 v[204:207], a[204:207], a[76:79], v[204:207]
    s_waitcnt vmcnt(19) lgkmcnt(8)
    v_mfma_f32_16x16x32_bf16 v[128:131], a[208:211], a[80:83], v[128:131]
    s_add_u32 m0, s47, 61440
    ds_read_b64_tr_b16 a[200:201], v244 offset:192
    ds_read_b64_tr_b16 a[202:203], v244 offset:5312
    v_mfma_f32_16x16x32_bf16 v[136:139], a[208:211], a[84:87], v[136:139]
    s_add_u32 s53, s42, 1392640
    buffer_load_dwordx4 v12, s[20:23], s53 offen offset:0 lds
    v_mfma_f32_16x16x32_bf16 v[132:135], a[212:215], a[80:83], v[132:135]
    ds_read_b64_tr_b16 a[204:205], v245 offset:192
    ds_read_b64_tr_b16 a[206:207], v245 offset:5312
    v_mfma_f32_16x16x32_bf16 v[140:143], a[212:215], a[84:87], v[140:143]
    s_waitcnt lgkmcnt(8)
    v_mfma_f32_16x16x32_bf16 v[144:147], a[216:219], a[80:83], v[144:147]
    ds_read_b64_tr_b16 a[208:209], v244 offset:256
    ds_read_b64_tr_b16 a[210:211], v244 offset:5376
    v_mfma_f32_16x16x32_bf16 v[152:155], a[216:219], a[84:87], v[152:155]
    s_waitcnt vmcnt(14)
    s_barrier
    v_mfma_f32_16x16x32_bf16 v[148:151], a[220:223], a[80:83], v[148:151]
    ds_read_b64_tr_b16 a[212:213], v245 offset:256
    ds_read_b64_tr_b16 a[214:215], v245 offset:5376
    v_mfma_f32_16x16x32_bf16 v[156:159], a[220:223], a[84:87], v[156:159]
    s_waitcnt lgkmcnt(8)
    buffer_load_dwordx4 v13, s[20:23], s53 offen offset:1024 lds
    v_mfma_f32_16x16x32_bf16 v[160:163], a[192:195], a[80:83], v[160:163]
    ds_read_b64_tr_b16 a[216:217], v244 offset:10240
    ds_read_b64_tr_b16 a[218:219], v244 offset:15360
    v_mfma_f32_16x16x32_bf16 v[168:171], a[192:195], a[84:87], v[168:171]
    v_mfma_f32_16x16x32_bf16 v[164:167], a[196:199], a[80:83], v[164:167]
    ds_read_b64_tr_b16 a[220:221], v245 offset:10240
    ds_read_b64_tr_b16 a[222:223], v245 offset:15360
    v_mfma_f32_16x16x32_bf16 v[172:175], a[196:199], a[84:87], v[172:175]
    s_waitcnt lgkmcnt(8)
    buffer_load_dwordx4 v14, s[20:23], s53 offen offset:2048 lds
    v_mfma_f32_16x16x32_bf16 v[176:179], a[200:203], a[80:83], v[176:179]
    ds_read_b64_tr_b16 a[192:193], v244 offset:10304
    ds_read_b64_tr_b16 a[194:195], v244 offset:15424
    v_mfma_f32_16x16x32_bf16 v[184:187], a[200:203], a[84:87], v[184:187]
    v_mfma_f32_16x16x32_bf16 v[180:183], a[204:207], a[80:83], v[180:183]
    ds_read_b64_tr_b16 a[196:197], v245 offset:10304
    ds_read_b64_tr_b16 a[198:199], v245 offset:15424
    v_mfma_f32_16x16x32_bf16 v[188:191], a[204:207], a[84:87], v[188:191]
    s_waitcnt lgkmcnt(8)
    buffer_load_dwordx4 v15, s[20:23], s53 offen offset:3072 lds
    v_mfma_f32_16x16x32_bf16 v[192:195], a[208:211], a[80:83], v[192:195]
    ds_read_b64_tr_b16 a[200:201], v244 offset:10368
    ds_read_b64_tr_b16 a[202:203], v244 offset:15488
    v_mfma_f32_16x16x32_bf16 v[200:203], a[208:211], a[84:87], v[200:203]
    v_mfma_f32_16x16x32_bf16 v[196:199], a[212:215], a[80:83], v[196:199]
    ds_read_b64_tr_b16 a[204:205], v245 offset:10368
    ds_read_b64_tr_b16 a[206:207], v245 offset:15488
    v_mfma_f32_16x16x32_bf16 v[204:207], a[212:215], a[84:87], v[204:207]
    s_waitcnt vmcnt(16) lgkmcnt(8)
    v_mfma_f32_16x16x32_bf16 v[128:131], a[216:219], a[88:91], v[128:131]
    s_add_u32 m0, s47, 65536
    ds_read_b64_tr_b16 a[208:209], v244 offset:10432
    ds_read_b64_tr_b16 a[210:211], v244 offset:15552
    v_mfma_f32_16x16x32_bf16 v[136:139], a[216:219], a[92:95], v[136:139]
    buffer_load_dwordx4 v16, s[20:23], s53 offen offset:0 lds
    v_mfma_f32_16x16x32_bf16 v[132:135], a[220:223], a[88:91], v[132:135]
    ds_read_b64_tr_b16 a[212:213], v245 offset:10432
    ds_read_b64_tr_b16 a[214:215], v245 offset:15552
    v_mfma_f32_16x16x32_bf16 v[140:143], a[220:223], a[92:95], v[140:143]
    s_waitcnt lgkmcnt(8)
    v_mfma_f32_16x16x32_bf16 v[144:147], a[192:195], a[88:91], v[144:147]
    ds_read_b64_tr_b16 a[216:217], v244 offset:10496
    ds_read_b64_tr_b16 a[218:219], v244 offset:15616
    v_mfma_f32_16x16x32_bf16 v[152:155], a[192:195], a[92:95], v[152:155]
    buffer_load_dwordx4 a[124:127], v11, s[24:27], s54 offen offset:1024 sc1
    v_mfma_f32_16x16x32_bf16 v[148:151], a[196:199], a[88:91], v[148:151]
    ds_read_b64_tr_b16 a[220:221], v245 offset:10496
    ds_read_b64_tr_b16 a[222:223], v245 offset:15616
    v_mfma_f32_16x16x32_bf16 v[156:159], a[196:199], a[92:95], v[156:159]
    s_waitcnt lgkmcnt(8)
    v_mfma_f32_16x16x32_bf16 v[160:163], a[200:203], a[88:91], v[160:163]
    ds_read_b64_tr_b16 a[192:193], v244 offset:20480
    ds_read_b64_tr_b16 a[194:195], v244 offset:25600
    v_mfma_f32_16x16x32_bf16 v[168:171], a[200:203], a[92:95], v[168:171]
    v_mfma_f32_16x16x32_bf16 v[164:167], a[204:207], a[88:91], v[164:167]
    s_mov_b32 s54, 69632
    ds_read_b64_tr_b16 a[196:197], v245 offset:20480
    ds_read_b64_tr_b16 a[198:199], v245 offset:25600
    v_mfma_f32_16x16x32_bf16 v[172:175], a[204:207], a[92:95], v[172:175]
    s_waitcnt lgkmcnt(8)
    buffer_load_dwordx4 a[128:131], v11, s[24:27], s54 offen offset:0 sc1
    v_mfma_f32_16x16x32_bf16 v[176:179], a[208:211], a[88:91], v[176:179]
    ds_read_b64_tr_b16 a[200:201], v244 offset:20544
    ds_read_b64_tr_b16 a[202:203], v244 offset:25664
    v_mfma_f32_16x16x32_bf16 v[184:187], a[208:211], a[92:95], v[184:187]
    v_mfma_f32_16x16x32_bf16 v[180:183], a[212:215], a[88:91], v[180:183]
    ds_read_b64_tr_b16 a[204:205], v245 offset:20544
    ds_read_b64_tr_b16 a[206:207], v245 offset:25664
    v_mfma_f32_16x16x32_bf16 v[188:191], a[212:215], a[92:95], v[188:191]
    s_waitcnt lgkmcnt(8)
    buffer_load_dwordx4 a[132:135], v11, s[24:27], s54 offen offset:1024 sc1
    v_mfma_f32_16x16x32_bf16 v[192:195], a[216:219], a[88:91], v[192:195]
    ds_read_b64_tr_b16 a[208:209], v244 offset:20608
    ds_read_b64_tr_b16 a[210:211], v244 offset:25728
    v_mfma_f32_16x16x32_bf16 v[200:203], a[216:219], a[92:95], v[200:203]
    v_mfma_f32_16x16x32_bf16 v[196:199], a[220:223], a[88:91], v[196:199]
    ds_read_b64_tr_b16 a[212:213], v245 offset:20608
    ds_read_b64_tr_b16 a[214:215], v245 offset:25728
    v_mfma_f32_16x16x32_bf16 v[204:207], a[220:223], a[92:95], v[204:207]
    s_waitcnt vmcnt(18) lgkmcnt(8)
    v_mfma_f32_16x16x32_bf16 v[128:131], a[192:195], a[96:99], v[128:131]
    s_mov_b32 s54, 71680
    ds_read_b64_tr_b16 a[216:217], v244 offset:20672
    ds_read_b64_tr_b16 a[218:219], v244 offset:25792
    v_mfma_f32_16x16x32_bf16 v[136:139], a[192:195], a[100:103], v[136:139]
    buffer_load_dwordx4 a[136:139], v11, s[24:27], s54 offen offset:0 sc1
    v_mfma_f32_16x16x32_bf16 v[132:135], a[196:199], a[96:99], v[132:135]
    ds_read_b64_tr_b16 a[220:221], v245 offset:20672
    ds_read_b64_tr_b16 a[222:223], v245 offset:25792
    v_mfma_f32_16x16x32_bf16 v[140:143], a[196:199], a[100:103], v[140:143]
    s_waitcnt lgkmcnt(8)
    v_mfma_f32_16x16x32_bf16 v[144:147], a[200:203], a[96:99], v[144:147]
    ds_read_b64_tr_b16 a[192:193], v244 offset:20736
    ds_read_b64_tr_b16 a[194:195], v244 offset:25856
    v_mfma_f32_16x16x32_bf16 v[152:155], a[200:203], a[100:103], v[152:155]
    s_waitcnt vmcnt(13)
    s_barrier
    s_add_u32 m0, s47, 81920
    v_mfma_f32_16x16x32_bf16 v[148:151], a[204:207], a[96:99], v[148:151]
    s_add_u32 s53, s42, 1597440
    ds_read_b64_tr_b16 a[196:197], v245 offset:20736
    ds_read_b64_tr_b16 a[198:199], v245 offset:25856
    v_mfma_f32_16x16x32_bf16 v[156:159], a[204:207], a[100:103], v[156:159]
    s_waitcnt lgkmcnt(8)
    buffer_load_dwordx4 v12, s[20:23], s53 offen offset:0 lds
    v_mfma_f32_16x16x32_bf16 v[160:163], a[208:211], a[96:99], v[160:163]
    ds_read_b64_tr_b16 a[200:201], v244 offset:30720
    ds_read_b64_tr_b16 a[202:203], v244 offset:35840
    v_mfma_f32_16x16x32_bf16 v[168:171], a[208:211], a[100:103], v[168:171]
    v_mfma_f32_16x16x32_bf16 v[164:167], a[212:215], a[96:99], v[164:167]
    ds_read_b64_tr_b16 a[204:205], v245 offset:30720
    ds_read_b64_tr_b16 a[206:207], v245 offset:35840
    v_mfma_f32_16x16x32_bf16 v[172:175], a[212:215], a[100:103], v[172:175]
    s_waitcnt lgkmcnt(8)
    buffer_load_dwordx4 v13, s[20:23], s53 offen offset:1024 lds
    v_mfma_f32_16x16x32_bf16 v[176:179], a[216:219], a[96:99], v[176:179]
    ds_read_b64_tr_b16 a[208:209], v244 offset:30784
    ds_read_b64_tr_b16 a[210:211], v244 offset:35904
    v_mfma_f32_16x16x32_bf16 v[184:187], a[216:219], a[100:103], v[184:187]
    v_mfma_f32_16x16x32_bf16 v[180:183], a[220:223], a[96:99], v[180:183]
    ds_read_b64_tr_b16 a[212:213], v245 offset:30784
    ds_read_b64_tr_b16 a[214:215], v245 offset:35904
    v_mfma_f32_16x16x32_bf16 v[188:191], a[220:223], a[100:103], v[188:191]
    s_waitcnt lgkmcnt(8)
    buffer_load_dwordx4 v14, s[20:23], s53 offen offset:2048 lds
    v_mfma_f32_16x16x32_bf16 v[192:195], a[192:195], a[96:99], v[192:195]
    ds_read_b64_tr_b16 a[216:217], v244 offset:30848
    ds_read_b64_tr_b16 a[218:219], v244 offset:35968
    v_mfma_f32_16x16x32_bf16 v[200:203], a[192:195], a[100:103], v[200:203]
    v_mfma_f32_16x16x32_bf16 v[196:199], a[196:199], a[96:99], v[196:199]
    ds_read_b64_tr_b16 a[220:221], v245 offset:30848
    ds_read_b64_tr_b16 a[222:223], v245 offset:35968
    v_mfma_f32_16x16x32_bf16 v[204:207], a[196:199], a[100:103], v[204:207]
    s_waitcnt vmcnt(15) lgkmcnt(8)
    v_mfma_f32_16x16x32_bf16 v[128:131], a[200:203], a[104:107], v[128:131]
    ds_read_b64_tr_b16 a[192:193], v244 offset:30912
    ds_read_b64_tr_b16 a[194:195], v244 offset:36032
    v_mfma_f32_16x16x32_bf16 v[136:139], a[200:203], a[108:111], v[136:139]
    buffer_load_dwordx4 v15, s[20:23], s53 offen offset:3072 lds
    v_mfma_f32_16x16x32_bf16 v[132:135], a[204:207], a[104:107], v[132:135]
    ds_read_b64_tr_b16 a[196:197], v245 offset:30912
    ds_read_b64_tr_b16 a[198:199], v245 offset:36032
    v_mfma_f32_16x16x32_bf16 v[140:143], a[204:207], a[108:111], v[140:143]
    s_waitcnt lgkmcnt(8)
    v_mfma_f32_16x16x32_bf16 v[144:147], a[208:211], a[104:107], v[144:147]
    ds_read_b64_tr_b16 a[200:201], v244 offset:30976
    ds_read_b64_tr_b16 a[202:203], v244 offset:36096
    v_mfma_f32_16x16x32_bf16 v[152:155], a[208:211], a[108:111], v[152:155]
    s_add_u32 m0, s47, 86016
    s_nop 0
    buffer_load_dwordx4 v16, s[20:23], s53 offen offset:0 lds
    v_mfma_f32_16x16x32_bf16 v[148:151], a[212:215], a[104:107], v[148:151]
    ds_read_b64_tr_b16 a[204:205], v245 offset:30976
    ds_read_b64_tr_b16 a[206:207], v245 offset:36096
    v_mfma_f32_16x16x32_bf16 v[156:159], a[212:215], a[108:111], v[156:159]
    s_waitcnt lgkmcnt(8)
    v_mfma_f32_16x16x32_bf16 v[160:163], a[216:219], a[104:107], v[160:163]
    ds_read_b64_tr_b16 a[208:209], v240 offset:40960
    ds_read_b64_tr_b16 a[210:211], v240 offset:46080
    v_mfma_f32_16x16x32_bf16 v[168:171], a[216:219], a[108:111], v[168:171]
    v_mfma_f32_16x16x32_bf16 v[164:167], a[220:223], a[104:107], v[164:167]
    ds_read_b64_tr_b16 a[212:213], v241 offset:40960
    ds_read_b64_tr_b16 a[214:215], v241 offset:46080
    v_mfma_f32_16x16x32_bf16 v[172:175], a[220:223], a[108:111], v[172:175]
    s_waitcnt lgkmcnt(8)
    buffer_load_dwordx4 a[140:143], v11, s[24:27], s54 offen offset:1024 sc1
    v_mfma_f32_16x16x32_bf16 v[176:179], a[192:195], a[104:107], v[176:179]
    ds_read_b64_tr_b16 a[216:217], v240 offset:41024
    ds_read_b64_tr_b16 a[218:219], v240 offset:46144
    v_mfma_f32_16x16x32_bf16 v[184:187], a[192:195], a[108:111], v[184:187]
    v_mfma_f32_16x16x32_bf16 v[180:183], a[196:199], a[104:107], v[180:183]
    ds_read_b64_tr_b16 a[220:221], v241 offset:41024
    ds_read_b64_tr_b16 a[222:223], v241 offset:46144
    v_mfma_f32_16x16x32_bf16 v[188:191], a[196:199], a[108:111], v[188:191]
    s_waitcnt lgkmcnt(8)
    s_mov_b32 s54, 79872
    v_mfma_f32_16x16x32_bf16 v[192:195], a[200:203], a[104:107], v[192:195]
    ds_read_b64_tr_b16 a[192:193], v240 offset:41088
    ds_read_b64_tr_b16 a[194:195], v240 offset:46208
    v_mfma_f32_16x16x32_bf16 v[200:203], a[200:203], a[108:111], v[200:203]
    buffer_load_dwordx4 a[144:147], v11, s[24:27], s54 offen offset:0 sc1
    v_mfma_f32_16x16x32_bf16 v[196:199], a[204:207], a[104:107], v[196:199]
    ds_read_b64_tr_b16 a[196:197], v241 offset:41088
    ds_read_b64_tr_b16 a[198:199], v241 offset:46208
    v_mfma_f32_16x16x32_bf16 v[204:207], a[204:207], a[108:111], v[204:207]
    s_waitcnt vmcnt(17) lgkmcnt(8)
    v_mfma_f32_16x16x32_bf16 v[128:131], a[208:211], a[112:115], v[128:131]
    ds_read_b64_tr_b16 a[200:201], v240 offset:41152
    ds_read_b64_tr_b16 a[202:203], v240 offset:46272
    v_mfma_f32_16x16x32_bf16 v[136:139], a[208:211], a[116:119], v[136:139]
    buffer_load_dwordx4 a[148:151], v11, s[24:27], s54 offen offset:1024 sc1
    v_mfma_f32_16x16x32_bf16 v[132:135], a[212:215], a[112:115], v[132:135]
    ds_read_b64_tr_b16 a[204:205], v241 offset:41152
    ds_read_b64_tr_b16 a[206:207], v241 offset:46272
    v_mfma_f32_16x16x32_bf16 v[140:143], a[212:215], a[116:119], v[140:143]
    s_waitcnt lgkmcnt(8)
    v_mfma_f32_16x16x32_bf16 v[144:147], a[216:219], a[112:115], v[144:147]
    ds_read_b64_tr_b16 a[208:209], v240 offset:41216
    ds_read_b64_tr_b16 a[210:211], v240 offset:46336
    v_mfma_f32_16x16x32_bf16 v[152:155], a[216:219], a[116:119], v[152:155]
    s_waitcnt vmcnt(12)
    s_barrier
    s_mov_b32 s54, 81920
    v_mfma_f32_16x16x32_bf16 v[148:151], a[220:223], a[112:115], v[148:151]
    ds_read_b64_tr_b16 a[212:213], v241 offset:41216
    ds_read_b64_tr_b16 a[214:215], v241 offset:46336
    v_mfma_f32_16x16x32_bf16 v[156:159], a[220:223], a[116:119], v[156:159]
    s_waitcnt lgkmcnt(8)
    buffer_load_dwordx4 a[152:155], v11, s[24:27], s54 offen offset:0 sc1
    v_mfma_f32_16x16x32_bf16 v[160:163], a[192:195], a[112:115], v[160:163]
    ds_read_b64_tr_b16 a[216:217], v240 offset:51200
    ds_read_b64_tr_b16 a[218:219], v240 offset:56320
    v_mfma_f32_16x16x32_bf16 v[168:171], a[192:195], a[116:119], v[168:171]
    v_mfma_f32_16x16x32_bf16 v[164:167], a[196:199], a[112:115], v[164:167]
    s_add_u32 m0, s47, 0
    ds_read_b64_tr_b16 a[220:221], v241 offset:51200
    ds_read_b64_tr_b16 a[222:223], v241 offset:56320
    v_mfma_f32_16x16x32_bf16 v[172:175], a[196:199], a[116:119], v[172:175]
    s_waitcnt lgkmcnt(8)
    s_add_u32 s53, s44, 1679360
    v_mfma_f32_16x16x32_bf16 v[176:179], a[200:203], a[112:115], v[176:179]
    ds_read_b64_tr_b16 a[192:193], v240 offset:51264
    ds_read_b64_tr_b16 a[194:195], v240 offset:56384
    v_mfma_f32_16x16x32_bf16 v[184:187], a[200:203], a[116:119], v[184:187]
    buffer_load_dwordx4 v12, s[20:23], s53 offen offset:0 lds
    v_mfma_f32_16x16x32_bf16 v[180:183], a[204:207], a[112:115], v[180:183]
    ds_read_b64_tr_b16 a[196:197], v241 offset:51264
    ds_read_b64_tr_b16 a[198:199], v241 offset:56384
    v_mfma_f32_16x16x32_bf16 v[188:191], a[204:207], a[116:119], v[188:191]
    s_waitcnt lgkmcnt(8)
    buffer_load_dwordx4 v13, s[20:23], s53 offen offset:1024 lds
    v_mfma_f32_16x16x32_bf16 v[192:195], a[208:211], a[112:115], v[192:195]
    ds_read_b64_tr_b16 a[200:201], v240 offset:51328
    ds_read_b64_tr_b16 a[202:203], v240 offset:56448
    v_mfma_f32_16x16x32_bf16 v[200:203], a[208:211], a[116:119], v[200:203]
    v_mfma_f32_16x16x32_bf16 v[196:199], a[212:215], a[112:115], v[196:199]
    ds_read_b64_tr_b16 a[204:205], v241 offset:51328
    ds_read_b64_tr_b16 a[206:207], v241 offset:56448
    v_mfma_f32_16x16x32_bf16 v[204:207], a[212:215], a[116:119], v[204:207]
    s_waitcnt vmcnt(14) lgkmcnt(8)
    v_mfma_f32_16x16x32_bf16 v[128:131], a[216:219], a[120:123], v[128:131]
    ds_read_b64_tr_b16 a[208:209], v240 offset:51392
    ds_read_b64_tr_b16 a[210:211], v240 offset:56512
    v_mfma_f32_16x16x32_bf16 v[136:139], a[216:219], a[124:127], v[136:139]
    buffer_load_dwordx4 v14, s[20:23], s53 offen offset:2048 lds
    v_mfma_f32_16x16x32_bf16 v[132:135], a[220:223], a[120:123], v[132:135]
    ds_read_b64_tr_b16 a[212:213], v241 offset:51392
    ds_read_b64_tr_b16 a[214:215], v241 offset:56512
    v_mfma_f32_16x16x32_bf16 v[140:143], a[220:223], a[124:127], v[140:143]
    s_waitcnt lgkmcnt(8)
    v_mfma_f32_16x16x32_bf16 v[144:147], a[192:195], a[120:123], v[144:147]
    ds_read_b64_tr_b16 a[216:217], v240 offset:51456
    ds_read_b64_tr_b16 a[218:219], v240 offset:56576
    v_mfma_f32_16x16x32_bf16 v[152:155], a[192:195], a[124:127], v[152:155]
    buffer_load_dwordx4 v15, s[20:23], s53 offen offset:3072 lds
    v_mfma_f32_16x16x32_bf16 v[148:151], a[196:199], a[120:123], v[148:151]
    ds_read_b64_tr_b16 a[220:221], v241 offset:51456
    ds_read_b64_tr_b16 a[222:223], v241 offset:56576
    v_mfma_f32_16x16x32_bf16 v[156:159], a[196:199], a[124:127], v[156:159]
    s_waitcnt lgkmcnt(8)
    v_mfma_f32_16x16x32_bf16 v[160:163], a[200:203], a[120:123], v[160:163]
    ds_read_b64_tr_b16 a[192:193], v242 offset:0
    ds_read_b64_tr_b16 a[194:195], v242 offset:5120
    v_mfma_f32_16x16x32_bf16 v[168:171], a[200:203], a[124:127], v[168:171]
    v_mfma_f32_16x16x32_bf16 v[164:167], a[204:207], a[120:123], v[164:167]
    s_add_u32 m0, s47, 4096
    ds_read_b64_tr_b16 a[196:197], v243 offset:0
    ds_read_b64_tr_b16 a[198:199], v243 offset:5120
    v_mfma_f32_16x16x32_bf16 v[172:175], a[204:207], a[124:127], v[172:175]
    s_waitcnt lgkmcnt(8)
    buffer_load_dwordx4 v16, s[20:23], s53 offen offset:0 lds
    v_mfma_f32_16x16x32_bf16 v[176:179], a[208:211], a[120:123], v[176:179]
    ds_read_b64_tr_b16 a[200:201], v242 offset:64
    ds_read_b64_tr_b16 a[202:203], v242 offset:5184
    v_mfma_f32_16x16x32_bf16 v[184:187], a[208:211], a[124:127], v[184:187]
    v_mfma_f32_16x16x32_bf16 v[180:183], a[212:215], a[120:123], v[180:183]
    ds_read_b64_tr_b16 a[204:205], v243 offset:64
    ds_read_b64_tr_b16 a[206:207], v243 offset:5184
    v_mfma_f32_16x16x32_bf16 v[188:191], a[212:215], a[124:127], v[188:191]
    s_waitcnt lgkmcnt(8)
    buffer_load_dwordx4 a[156:159], v11, s[24:27], s54 offen offset:1024 sc1
    v_mfma_f32_16x16x32_bf16 v[192:195], a[216:219], a[120:123], v[192:195]
    ds_read_b64_tr_b16 a[208:209], v242 offset:128
    ds_read_b64_tr_b16 a[210:211], v242 offset:5248
    v_mfma_f32_16x16x32_bf16 v[200:203], a[216:219], a[124:127], v[200:203]
    v_mfma_f32_16x16x32_bf16 v[196:199], a[220:223], a[120:123], v[196:199]
    ds_read_b64_tr_b16 a[212:213], v243 offset:128
    ds_read_b64_tr_b16 a[214:215], v243 offset:5248
    v_mfma_f32_16x16x32_bf16 v[204:207], a[220:223], a[124:127], v[204:207]
    s_waitcnt vmcnt(16) lgkmcnt(8)
    v_mfma_f32_16x16x32_bf16 v[128:131], a[192:195], a[128:131], v[128:131]
    s_mov_b32 s54, 83968
    ds_read_b64_tr_b16 a[216:217], v242 offset:192
    ds_read_b64_tr_b16 a[218:219], v242 offset:5312
    v_mfma_f32_16x16x32_bf16 v[136:139], a[192:195], a[132:135], v[136:139]
    buffer_load_dwordx4 a[160:163], v11, s[24:27], s54 offen offset:0 sc1
    v_mfma_f32_16x16x32_bf16 v[132:135], a[196:199], a[128:131], v[132:135]
    ds_read_b64_tr_b16 a[220:221], v243 offset:192
    ds_read_b64_tr_b16 a[222:223], v243 offset:5312
    v_mfma_f32_16x16x32_bf16 v[140:143], a[196:199], a[132:135], v[140:143]
    s_waitcnt lgkmcnt(8)
    v_mfma_f32_16x16x32_bf16 v[144:147], a[200:203], a[128:131], v[144:147]
    ds_read_b64_tr_b16 a[192:193], v242 offset:256
    ds_read_b64_tr_b16 a[194:195], v242 offset:5376
    v_mfma_f32_16x16x32_bf16 v[152:155], a[200:203], a[132:135], v[152:155]
    s_waitcnt vmcnt(11)
    s_barrier
    v_mfma_f32_16x16x32_bf16 v[148:151], a[204:207], a[128:131], v[148:151]
    ds_read_b64_tr_b16 a[196:197], v243 offset:256
    ds_read_b64_tr_b16 a[198:199], v243 offset:5376
    v_mfma_f32_16x16x32_bf16 v[156:159], a[204:207], a[132:135], v[156:159]
    s_waitcnt lgkmcnt(8)
    buffer_load_dwordx4 a[164:167], v11, s[24:27], s54 offen offset:1024 sc1
    v_mfma_f32_16x16x32_bf16 v[160:163], a[208:211], a[128:131], v[160:163]
    ds_read_b64_tr_b16 a[200:201], v242 offset:10240
    ds_read_b64_tr_b16 a[202:203], v242 offset:15360
    v_mfma_f32_16x16x32_bf16 v[168:171], a[208:211], a[132:135], v[168:171]
    v_mfma_f32_16x16x32_bf16 v[164:167], a[212:215], a[128:131], v[164:167]
    s_mov_b32 s54, 92160
    ds_read_b64_tr_b16 a[204:205], v243 offset:10240
    ds_read_b64_tr_b16 a[206:207], v243 offset:15360
    v_mfma_f32_16x16x32_bf16 v[172:175], a[212:215], a[132:135], v[172:175]
    s_waitcnt lgkmcnt(8)
    buffer_load_dwordx4 a[168:171], v11, s[24:27], s54 offen offset:0 sc1
    v_mfma_f32_16x16x32_bf16 v[176:179], a[216:219], a[128:131], v[176:179]
    ds_read_b64_tr_b16 a[208:209], v242 offset:10304
    ds_read_b64_tr_b16 a[210:211], v242 offset:15424
    v_mfma_f32_16x16x32_bf16 v[184:187], a[216:219], a[132:135], v[184:187]
    v_mfma_f32_16x16x32_bf16 v[180:183], a[220:223], a[128:131], v[180:183]
    ds_read_b64_tr_b16 a[212:213], v243 offset:10304
    ds_read_b64_tr_b16 a[214:215], v243 offset:15424
    v_mfma_f32_16x16x32_bf16 v[188:191], a[220:223], a[132:135], v[188:191]
    s_waitcnt lgkmcnt(8)
    s_add_u32 m0, s47, 20480
    s_add_u32 s53, s42, 1884160
    v_mfma_f32_16x16x32_bf16 v[192:195], a[192:195], a[128:131], v[192:195]
    ds_read_b64_tr_b16 a[216:217], v242 offset:10368
    ds_read_b64_tr_b16 a[218:219], v242 offset:15488
    v_mfma_f32_16x16x32_bf16 v[200:203], a[192:195], a[132:135], v[200:203]
    buffer_load_dwordx4 v12, s[20:23], s53 offen offset:0 lds
    v_mfma_f32_16x16x32_bf16 v[196:199], a[196:199], a[128:131], v[196:199]
    ds_read_b64_tr_b16 a[220:221], v243 offset:10368
    ds_read_b64_tr_b16 a[222:223], v243 offset:15488
    v_mfma_f32_16x16x32_bf16 v[204:207], a[196:199], a[132:135], v[204:207]
    s_waitcnt vmcnt(13) lgkmcnt(8)
    v_mfma_f32_16x16x32_bf16 v[128:131], a[200:203], a[136:139], v[128:131]
    ds_read_b64_tr_b16 a[192:193], v242 offset:10432
    ds_read_b64_tr_b16 a[194:195], v242 offset:15552
    v_mfma_f32_16x16x32_bf16 v[136:139], a[200:203], a[140:143], v[136:139]
    buffer_load_dwordx4 v13, s[20:23], s53 offen offset:1024 lds
    v_mfma_f32_16x16x32_bf16 v[132:135], a[204:207], a[136:139], v[132:135]
    ds_read_b64_tr_b16 a[196:197], v243 offset:10432
    ds_read_b64_tr_b16 a[198:199], v243 offset:15552
    v_mfma_f32_16x16x32_bf16 v[140:143], a[204:207], a[140:143], v[140:143]
    s_waitcnt lgkmcnt(8)
    v_mfma_f32_16x16x32_bf16 v[144:147], a[208:211], a[136:139], v[144:147]
    ds_read_b64_tr_b16 a[200:201], v242 offset:10496
    ds_read_b64_tr_b16 a[202:203], v242 offset:15616
    v_mfma_f32_16x16x32_bf16 v[152:155], a[208:211], a[140:143], v[152:155]
    buffer_load_dwordx4 v14, s[20:23], s53 offen offset:2048 lds
    v_mfma_f32_16x16x32_bf16 v[148:151], a[212:215], a[136:139], v[148:151]
    ds_read_b64_tr_b16 a[204:205], v243 offset:10496
    ds_read_b64_tr_b16 a[206:207], v243 offset:15616
    v_mfma_f32_16x16x32_bf16 v[156:159], a[212:215], a[140:143], v[156:159]
    s_waitcnt lgkmcnt(8)
    v_mfma_f32_16x16x32_bf16 v[160:163], a[216:219], a[136:139], v[160:163]
    ds_read_b64_tr_b16 a[208:209], v242 offset:20480
    ds_read_b64_tr_b16 a[210:211], v242 offset:25600
    v_mfma_f32_16x16x32_bf16 v[168:171], a[216:219], a[140:143], v[168:171]
    v_mfma_f32_16x16x32_bf16 v[164:167], a[220:223], a[136:139], v[164:167]
    ds_read_b64_tr_b16 a[212:213], v243 offset:20480
    ds_read_b64_tr_b16 a[214:215], v243 offset:25600
    v_mfma_f32_16x16x32_bf16 v[172:175], a[220:223], a[140:143], v[172:175]
    s_waitcnt lgkmcnt(8)
    buffer_load_dwordx4 v15, s[20:23], s53 offen offset:3072 lds
    v_mfma_f32_16x16x32_bf16 v[176:179], a[192:195], a[136:139], v[176:179]
    ds_read_b64_tr_b16 a[216:217], v242 offset:20544
    ds_read_b64_tr_b16 a[218:219], v242 offset:25664
    v_mfma_f32_16x16x32_bf16 v[184:187], a[192:195], a[140:143], v[184:187]
    v_mfma_f32_16x16x32_bf16 v[180:183], a[196:199], a[136:139], v[180:183]
    ds_read_b64_tr_b16 a[220:221], v243 offset:20544
    ds_read_b64_tr_b16 a[222:223], v243 offset:25664
    v_mfma_f32_16x16x32_bf16 v[188:191], a[196:199], a[140:143], v[188:191]
    s_waitcnt lgkmcnt(8)
    s_add_u32 m0, s47, 24576
    v_mfma_f32_16x16x32_bf16 v[192:195], a[200:203], a[136:139], v[192:195]
    ds_read_b64_tr_b16 a[192:193], v242 offset:20608
    ds_read_b64_tr_b16 a[194:195], v242 offset:25728
    v_mfma_f32_16x16x32_bf16 v[200:203], a[200:203], a[140:143], v[200:203]
    buffer_load_dwordx4 v16, s[20:23], s53 offen offset:0 lds
    v_mfma_f32_16x16x32_bf16 v[196:199], a[204:207], a[136:139], v[196:199]
    ds_read_b64_tr_b16 a[196:197], v243 offset:20608
    ds_read_b64_tr_b16 a[198:199], v243 offset:25728
    v_mfma_f32_16x16x32_bf16 v[204:207], a[204:207], a[140:143], v[204:207]
    s_waitcnt vmcnt(15) lgkmcnt(8)
    v_mfma_f32_16x16x32_bf16 v[128:131], a[208:211], a[144:147], v[128:131]
    ds_read_b64_tr_b16 a[200:201], v242 offset:20672
    ds_read_b64_tr_b16 a[202:203], v242 offset:25792
    v_mfma_f32_16x16x32_bf16 v[136:139], a[208:211], a[148:151], v[136:139]
    buffer_load_dwordx4 a[172:175], v11, s[24:27], s54 offen offset:1024 sc1
    v_mfma_f32_16x16x32_bf16 v[132:135], a[212:215], a[144:147], v[132:135]
    ds_read_b64_tr_b16 a[204:205], v243 offset:20672
    ds_read_b64_tr_b16 a[206:207], v243 offset:25792
    v_mfma_f32_16x16x32_bf16 v[140:143], a[212:215], a[148:151], v[140:143]
    s_waitcnt lgkmcnt(8)
    v_mfma_f32_16x16x32_bf16 v[144:147], a[216:219], a[144:147], v[144:147]
    ds_read_b64_tr_b16 a[208:209], v242 offset:20736
    ds_read_b64_tr_b16 a[210:211], v242 offset:25856
    v_mfma_f32_16x16x32_bf16 v[152:155], a[216:219], a[148:151], v[152:155]
    s_waitcnt vmcnt(10)
    s_barrier
    s_mov_b32 s54, 94208
    v_mfma_f32_16x16x32_bf16 v[148:151], a[220:223], a[144:147], v[148:151]
    ds_read_b64_tr_b16 a[212:213], v243 offset:20736
    ds_read_b64_tr_b16 a[214:215], v243 offset:25856
    v_mfma_f32_16x16x32_bf16 v[156:159], a[220:223], a[148:151], v[156:159]
    s_waitcnt lgkmcnt(8)
    buffer_load_dwordx4 a[176:179], v11, s[24:27], s54 offen offset:0 sc1
    v_mfma_f32_16x16x32_bf16 v[160:163], a[192:195], a[144:147], v[160:163]
    ds_read_b64_tr_b16 a[216:217], v242 offset:30720
    ds_read_b64_tr_b16 a[218:219], v242 offset:35840
    v_mfma_f32_16x16x32_bf16 v[168:171], a[192:195], a[148:151], v[168:171]
    v_mfma_f32_16x16x32_bf16 v[164:167], a[196:199], a[144:147], v[164:167]
    ds_read_b64_tr_b16 a[220:221], v243 offset:30720
    ds_read_b64_tr_b16 a[222:223], v243 offset:35840
    v_mfma_f32_16x16x32_bf16 v[172:175], a[196:199], a[148:151], v[172:175]
    s_waitcnt lgkmcnt(8)
    buffer_load_dwordx4 a[180:183], v11, s[24:27], s54 offen offset:1024 sc1
    v_mfma_f32_16x16x32_bf16 v[176:179], a[200:203], a[144:147], v[176:179]
    ds_read_b64_tr_b16 a[192:193], v242 offset:30784
    ds_read_b64_tr_b16 a[194:195], v242 offset:35904
    v_mfma_f32_16x16x32_bf16 v[184:187], a[200:203], a[148:151], v[184:187]
    v_mfma_f32_16x16x32_bf16 v[180:183], a[204:207], a[144:147], v[180:183]
    ds_read_b64_tr_b16 a[196:197], v243 offset:30784
    ds_read_b64_tr_b16 a[198:199], v243 offset:35904
    v_mfma_f32_16x16x32_bf16 v[188:191], a[204:207], a[148:151], v[188:191]
    s_waitcnt lgkmcnt(8)
    s_mov_b32 s54, 96256
    v_mfma_f32_16x16x32_bf16 v[192:195], a[208:211], a[144:147], v[192:195]
    ds_read_b64_tr_b16 a[200:201], v242 offset:30848
    ds_read_b64_tr_b16 a[202:203], v242 offset:35968
    v_mfma_f32_16x16x32_bf16 v[200:203], a[208:211], a[148:151], v[200:203]
    buffer_load_dwordx4 a[184:187], v11, s[24:27], s54 offen offset:0 sc1
    v_mfma_f32_16x16x32_bf16 v[196:199], a[212:215], a[144:147], v[196:199]
    ds_read_b64_tr_b16 a[204:205], v243 offset:30848
    ds_read_b64_tr_b16 a[206:207], v243 offset:35968
    v_mfma_f32_16x16x32_bf16 v[204:207], a[212:215], a[148:151], v[204:207]
    s_waitcnt vmcnt(12) lgkmcnt(8)
    v_mfma_f32_16x16x32_bf16 v[128:131], a[216:219], a[152:155], v[128:131]
    ds_read_b64_tr_b16 a[208:209], v242 offset:30912
    ds_read_b64_tr_b16 a[210:211], v242 offset:36032
    v_mfma_f32_16x16x32_bf16 v[136:139], a[216:219], a[156:159], v[136:139]
    buffer_load_dwordx4 a[188:191], v11, s[24:27], s54 offen offset:1024 sc1
    v_mfma_f32_16x16x32_bf16 v[132:135], a[220:223], a[152:155], v[132:135]
    ds_read_b64_tr_b16 a[212:213], v243 offset:30912
    ds_read_b64_tr_b16 a[214:215], v243 offset:36032
    v_mfma_f32_16x16x32_bf16 v[140:143], a[220:223], a[156:159], v[140:143]
    s_waitcnt lgkmcnt(8)
    v_mfma_f32_16x16x32_bf16 v[144:147], a[192:195], a[152:155], v[144:147]
    ds_read_b64_tr_b16 a[216:217], v242 offset:30976
    ds_read_b64_tr_b16 a[218:219], v242 offset:36096
    v_mfma_f32_16x16x32_bf16 v[152:155], a[192:195], a[156:159], v[152:155]
    v_mfma_f32_16x16x32_bf16 v[148:151], a[196:199], a[152:155], v[148:151]
    ds_read_b64_tr_b16 a[220:221], v243 offset:30976
    ds_read_b64_tr_b16 a[222:223], v243 offset:36096
    v_mfma_f32_16x16x32_bf16 v[156:159], a[196:199], a[156:159], v[156:159]
    s_waitcnt lgkmcnt(8)
    v_mfma_f32_16x16x32_bf16 v[160:163], a[200:203], a[152:155], v[160:163]
    ds_read_b64_tr_b16 a[192:193], v240 offset:0
    ds_read_b64_tr_b16 a[194:195], v240 offset:5120
    v_mfma_f32_16x16x32_bf16 v[168:171], a[200:203], a[156:159], v[168:171]
    v_mfma_f32_16x16x32_bf16 v[164:167], a[204:207], a[152:155], v[164:167]
    ds_read_b64_tr_b16 a[196:197], v241 offset:0
    ds_read_b64_tr_b16 a[198:199], v241 offset:5120
    v_mfma_f32_16x16x32_bf16 v[172:175], a[204:207], a[156:159], v[172:175]
    s_waitcnt lgkmcnt(8)
    v_mfma_f32_16x16x32_bf16 v[176:179], a[208:211], a[152:155], v[176:179]
    ds_read_b64_tr_b16 a[200:201], v240 offset:64
    ds_read_b64_tr_b16 a[202:203], v240 offset:5184
    v_mfma_f32_16x16x32_bf16 v[184:187], a[208:211], a[156:159], v[184:187]
    v_mfma_f32_16x16x32_bf16 v[180:183], a[212:215], a[152:155], v[180:183]
    ds_read_b64_tr_b16 a[204:205], v241 offset:64
    ds_read_b64_tr_b16 a[206:207], v241 offset:5184
    v_mfma_f32_16x16x32_bf16 v[188:191], a[212:215], a[156:159], v[188:191]
    s_waitcnt lgkmcnt(8)
    v_mfma_f32_16x16x32_bf16 v[192:195], a[216:219], a[152:155], v[192:195]
    ds_read_b64_tr_b16 a[208:209], v240 offset:128
    ds_read_b64_tr_b16 a[210:211], v240 offset:5248
    v_mfma_f32_16x16x32_bf16 v[200:203], a[216:219], a[156:159], v[200:203]
    v_mfma_f32_16x16x32_bf16 v[196:199], a[220:223], a[152:155], v[196:199]
    ds_read_b64_tr_b16 a[212:213], v241 offset:128
    ds_read_b64_tr_b16 a[214:215], v241 offset:5248
    v_mfma_f32_16x16x32_bf16 v[204:207], a[220:223], a[156:159], v[204:207]
    s_waitcnt vmcnt(11) lgkmcnt(8)
    v_mfma_f32_16x16x32_bf16 v[128:131], a[192:195], a[160:163], v[128:131]
    ds_read_b64_tr_b16 a[216:217], v240 offset:192
    ds_read_b64_tr_b16 a[218:219], v240 offset:5312
    v_mfma_f32_16x16x32_bf16 v[136:139], a[192:195], a[164:167], v[136:139]
    v_mfma_f32_16x16x32_bf16 v[132:135], a[196:199], a[160:163], v[132:135]
    ds_read_b64_tr_b16 a[220:221], v241 offset:192
    ds_read_b64_tr_b16 a[222:223], v241 offset:5312
    v_mfma_f32_16x16x32_bf16 v[140:143], a[196:199], a[164:167], v[140:143]
    s_waitcnt lgkmcnt(8)
    v_mfma_f32_16x16x32_bf16 v[144:147], a[200:203], a[160:163], v[144:147]
    ds_read_b64_tr_b16 a[192:193], v240 offset:256
    ds_read_b64_tr_b16 a[194:195], v240 offset:5376
    v_mfma_f32_16x16x32_bf16 v[152:155], a[200:203], a[164:167], v[152:155]
    s_waitcnt vmcnt(5)
    s_barrier
    v_mfma_f32_16x16x32_bf16 v[148:151], a[204:207], a[160:163], v[148:151]
    ds_read_b64_tr_b16 a[196:197], v241 offset:256
    ds_read_b64_tr_b16 a[198:199], v241 offset:5376
    v_mfma_f32_16x16x32_bf16 v[156:159], a[204:207], a[164:167], v[156:159]
    s_waitcnt lgkmcnt(8)
    v_mfma_f32_16x16x32_bf16 v[160:163], a[208:211], a[160:163], v[160:163]
    ds_read_b64_tr_b16 a[200:201], v240 offset:10240
    ds_read_b64_tr_b16 a[202:203], v240 offset:15360
    v_mfma_f32_16x16x32_bf16 v[168:171], a[208:211], a[164:167], v[168:171]
    v_mfma_f32_16x16x32_bf16 v[164:167], a[212:215], a[160:163], v[164:167]
    ds_read_b64_tr_b16 a[204:205], v241 offset:10240
    ds_read_b64_tr_b16 a[206:207], v241 offset:15360
    v_mfma_f32_16x16x32_bf16 v[172:175], a[212:215], a[164:167], v[172:175]
    s_waitcnt lgkmcnt(8)
    v_mfma_f32_16x16x32_bf16 v[176:179], a[216:219], a[160:163], v[176:179]
    ds_read_b64_tr_b16 a[208:209], v240 offset:10304
    ds_read_b64_tr_b16 a[210:211], v240 offset:15424
    v_mfma_f32_16x16x32_bf16 v[184:187], a[216:219], a[164:167], v[184:187]
    v_mfma_f32_16x16x32_bf16 v[180:183], a[220:223], a[160:163], v[180:183]
    ds_read_b64_tr_b16 a[212:213], v241 offset:10304
    ds_read_b64_tr_b16 a[214:215], v241 offset:15424
    v_mfma_f32_16x16x32_bf16 v[188:191], a[220:223], a[164:167], v[188:191]
    s_waitcnt lgkmcnt(8)
    v_mfma_f32_16x16x32_bf16 v[192:195], a[192:195], a[160:163], v[192:195]
    ds_read_b64_tr_b16 a[216:217], v240 offset:10368
    ds_read_b64_tr_b16 a[218:219], v240 offset:15488
    v_mfma_f32_16x16x32_bf16 v[200:203], a[192:195], a[164:167], v[200:203]
    v_mfma_f32_16x16x32_bf16 v[196:199], a[196:199], a[160:163], v[196:199]
    ds_read_b64_tr_b16 a[220:221], v241 offset:10368
    ds_read_b64_tr_b16 a[222:223], v241 offset:15488
    v_mfma_f32_16x16x32_bf16 v[204:207], a[196:199], a[164:167], v[204:207]
    s_waitcnt vmcnt(4) lgkmcnt(8)
    v_mfma_f32_16x16x32_bf16 v[128:131], a[200:203], a[168:171], v[128:131]
    ds_read_b64_tr_b16 a[192:193], v240 offset:10432
    ds_read_b64_tr_b16 a[194:195], v240 offset:15552
    v_mfma_f32_16x16x32_bf16 v[136:139], a[200:203], a[172:175], v[136:139]
    v_mfma_f32_16x16x32_bf16 v[132:135], a[204:207], a[168:171], v[132:135]
    ds_read_b64_tr_b16 a[196:197], v241 offset:10432
    ds_read_b64_tr_b16 a[198:199], v241 offset:15552
    v_mfma_f32_16x16x32_bf16 v[140:143], a[204:207], a[172:175], v[140:143]
    s_waitcnt lgkmcnt(8)
    v_mfma_f32_16x16x32_bf16 v[144:147], a[208:211], a[168:171], v[144:147]
    ds_read_b64_tr_b16 a[200:201], v240 offset:10496
    ds_read_b64_tr_b16 a[202:203], v240 offset:15616
    v_mfma_f32_16x16x32_bf16 v[152:155], a[208:211], a[172:175], v[152:155]
    v_mfma_f32_16x16x32_bf16 v[148:151], a[212:215], a[168:171], v[148:151]
    ds_read_b64_tr_b16 a[204:205], v241 offset:10496
    ds_read_b64_tr_b16 a[206:207], v241 offset:15616
    v_mfma_f32_16x16x32_bf16 v[156:159], a[212:215], a[172:175], v[156:159]
    s_waitcnt lgkmcnt(8)
    v_mfma_f32_16x16x32_bf16 v[160:163], a[216:219], a[168:171], v[160:163]
    ds_read_b64_tr_b16 a[208:209], v240 offset:20480
    ds_read_b64_tr_b16 a[210:211], v240 offset:25600
    v_mfma_f32_16x16x32_bf16 v[168:171], a[216:219], a[172:175], v[168:171]
    v_mfma_f32_16x16x32_bf16 v[164:167], a[220:223], a[168:171], v[164:167]
    ds_read_b64_tr_b16 a[212:213], v241 offset:20480
    ds_read_b64_tr_b16 a[214:215], v241 offset:25600
    v_mfma_f32_16x16x32_bf16 v[172:175], a[220:223], a[172:175], v[172:175]
    s_waitcnt lgkmcnt(8)
    v_mfma_f32_16x16x32_bf16 v[176:179], a[192:195], a[168:171], v[176:179]
    ds_read_b64_tr_b16 a[216:217], v240 offset:30720
    ds_read_b64_tr_b16 a[218:219], v240 offset:35840
    v_mfma_f32_16x16x32_bf16 v[184:187], a[192:195], a[172:175], v[184:187]
    v_mfma_f32_16x16x32_bf16 v[180:183], a[196:199], a[168:171], v[180:183]
    ds_read_b64_tr_b16 a[220:221], v241 offset:30720
    ds_read_b64_tr_b16 a[222:223], v241 offset:35840
    v_mfma_f32_16x16x32_bf16 v[188:191], a[196:199], a[172:175], v[188:191]
    s_waitcnt lgkmcnt(8)
    v_mfma_f32_16x16x32_bf16 v[192:195], a[200:203], a[168:171], v[192:195]
    ds_read_b64_tr_b16 a[192:193], v240 offset:20544
    ds_read_b64_tr_b16 a[194:195], v240 offset:25664
    v_mfma_f32_16x16x32_bf16 v[200:203], a[200:203], a[172:175], v[200:203]
    v_mfma_f32_16x16x32_bf16 v[196:199], a[204:207], a[168:171], v[196:199]
    ds_read_b64_tr_b16 a[196:197], v241 offset:20544
    ds_read_b64_tr_b16 a[198:199], v241 offset:25664
    v_mfma_f32_16x16x32_bf16 v[204:207], a[204:207], a[172:175], v[204:207]
    s_waitcnt vmcnt(2) lgkmcnt(8)
    v_mfma_f32_16x16x32_bf16 v[128:131], a[208:211], a[176:179], v[128:131]
    ds_read_b64_tr_b16 a[200:201], v240 offset:30784
    ds_read_b64_tr_b16 a[202:203], v240 offset:35904
    v_mfma_f32_16x16x32_bf16 v[136:139], a[208:211], a[180:183], v[136:139]
    v_mfma_f32_16x16x32_bf16 v[132:135], a[212:215], a[176:179], v[132:135]
    ds_read_b64_tr_b16 a[204:205], v241 offset:30784
    ds_read_b64_tr_b16 a[206:207], v241 offset:35904
    v_mfma_f32_16x16x32_bf16 v[140:143], a[212:215], a[180:183], v[140:143]
    s_waitcnt vmcnt(0) lgkmcnt(8)
    v_mfma_f32_16x16x32_bf16 v[128:131], a[216:219], a[184:187], v[128:131]
    ds_read_b64_tr_b16 a[208:209], v240 offset:20608
    ds_read_b64_tr_b16 a[210:211], v240 offset:25728
    v_mfma_f32_16x16x32_bf16 v[136:139], a[216:219], a[188:191], v[136:139]
    v_mfma_f32_16x16x32_bf16 v[132:135], a[220:223], a[184:187], v[132:135]
    ds_read_b64_tr_b16 a[212:213], v241 offset:20608
    ds_read_b64_tr_b16 a[214:215], v241 offset:25728
    v_mfma_f32_16x16x32_bf16 v[140:143], a[220:223], a[188:191], v[140:143]
    s_waitcnt lgkmcnt(8)
    v_mfma_f32_16x16x32_bf16 v[144:147], a[192:195], a[176:179], v[144:147]
    ds_read_b64_tr_b16 a[216:217], v240 offset:30848
    ds_read_b64_tr_b16 a[218:219], v240 offset:35968
    v_mfma_f32_16x16x32_bf16 v[152:155], a[192:195], a[180:183], v[152:155]
    v_mfma_f32_16x16x32_bf16 v[148:151], a[196:199], a[176:179], v[148:151]
    ds_read_b64_tr_b16 a[220:221], v241 offset:30848
    ds_read_b64_tr_b16 a[222:223], v241 offset:35968
    v_mfma_f32_16x16x32_bf16 v[156:159], a[196:199], a[180:183], v[156:159]
    s_waitcnt lgkmcnt(8)
    v_cvt_pk_bf16_f32 v64, v128, v129
    v_cvt_pk_bf16_f32 v65, v130, v131
    v_cvt_pk_bf16_f32 v66, v132, v133
    v_mfma_f32_16x16x32_bf16 v[144:147], a[200:203], a[184:187], v[144:147]
    ds_read_b64_tr_b16 a[192:193], v240 offset:20672
    ds_read_b64_tr_b16 a[194:195], v240 offset:25792
    v_cvt_pk_bf16_f32 v67, v134, v135
    v_mfma_f32_16x16x32_bf16 v[152:155], a[200:203], a[188:191], v[152:155]
    s_add_u32 s3, s50, 0
    s_cmp_eq_u32 s51, 0
    s_cselect_b32 s3, 0xa000, s3
    v_mfma_f32_16x16x32_bf16 v[148:151], a[204:207], a[184:187], v[148:151]
    ds_read_b64_tr_b16 a[196:197], v241 offset:20672
    ds_read_b64_tr_b16 a[198:199], v241 offset:25792
    v_mfma_f32_16x16x32_bf16 v[156:159], a[204:207], a[188:191], v[156:159]
    s_waitcnt lgkmcnt(8)
    buffer_store_dwordx4 v[64:67], v11, s[28:31], s3 offen offset:0 sc1
    v_cvt_pk_bf16_f32 v68, v136, v137
    v_mfma_f32_16x16x32_bf16 v[160:163], a[208:211], a[176:179], v[160:163]
    ds_read_b64_tr_b16 a[200:201], v240 offset:30912
    ds_read_b64_tr_b16 a[202:203], v240 offset:36032
    v_cvt_pk_bf16_f32 v69, v138, v139
    v_mfma_f32_16x16x32_bf16 v[168:171], a[208:211], a[180:183], v[168:171]
    v_cvt_pk_bf16_f32 v70, v140, v141
    v_cvt_pk_bf16_f32 v71, v142, v143
    v_mfma_f32_16x16x32_bf16 v[164:167], a[212:215], a[176:179], v[164:167]
    ds_read_b64_tr_b16 a[204:205], v241 offset:30912
    ds_read_b64_tr_b16 a[206:207], v241 offset:36032
    v_mfma_f32_16x16x32_bf16 v[172:175], a[212:215], a[180:183], v[172:175]
    s_waitcnt lgkmcnt(8)
    buffer_store_dwordx4 v[68:71], v11, s[28:31], s3 offen offset:1024 sc1
    v_cvt_pk_bf16_f32 v72, v144, v145
    v_mfma_f32_16x16x32_bf16 v[160:163], a[216:219], a[184:187], v[160:163]
    ds_read_b64_tr_b16 a[208:209], v240 offset:20736
    ds_read_b64_tr_b16 a[210:211], v240 offset:25856
    v_cvt_pk_bf16_f32 v73, v146, v147
    v_mfma_f32_16x16x32_bf16 v[168:171], a[216:219], a[188:191], v[168:171]
    v_cvt_pk_bf16_f32 v74, v148, v149
    v_cvt_pk_bf16_f32 v75, v150, v151
    v_mfma_f32_16x16x32_bf16 v[164:167], a[220:223], a[184:187], v[164:167]
    ds_read_b64_tr_b16 a[212:213], v241 offset:20736
    ds_read_b64_tr_b16 a[214:215], v241 offset:25856
    v_mfma_f32_16x16x32_bf16 v[172:175], a[220:223], a[188:191], v[172:175]
    s_waitcnt lgkmcnt(8)
    buffer_store_dwordx4 v[72:75], v11, s[28:31], s3 offen offset:2048 sc1
    v_cvt_pk_bf16_f32 v76, v152, v153
    v_mfma_f32_16x16x32_bf16 v[176:179], a[192:195], a[176:179], v[176:179]
    ds_read_b64_tr_b16 a[216:217], v240 offset:30976
    ds_read_b64_tr_b16 a[218:219], v240 offset:36096
    v_cvt_pk_bf16_f32 v77, v154, v155
    v_mfma_f32_16x16x32_bf16 v[184:187], a[192:195], a[180:183], v[184:187]
    v_cvt_pk_bf16_f32 v78, v156, v157
    v_cvt_pk_bf16_f32 v79, v158, v159
    v_mfma_f32_16x16x32_bf16 v[180:183], a[196:199], a[176:179], v[180:183]
    s_add_u32 s3, s50, 3072
    ds_read_b64_tr_b16 a[220:221], v241 offset:30976
    ds_read_b64_tr_b16 a[222:223], v241 offset:36096
    v_mfma_f32_16x16x32_bf16 v[188:191], a[196:199], a[180:183], v[188:191]
    s_waitcnt lgkmcnt(8)
    s_cmp_eq_u32 s51, 1
    s_cselect_b32 s3, 0xa000, s3
    v_mfma_f32_16x16x32_bf16 v[176:179], a[200:203], a[184:187], v[176:179]
    buffer_store_dwordx4 v[76:79], v11, s[28:31], s3 offen offset:0 sc1
    v_cvt_pk_bf16_f32 v80, v160, v161
    v_mfma_f32_16x16x32_bf16 v[184:187], a[200:203], a[188:191], v[184:187]
    v_cvt_pk_bf16_f32 v81, v162, v163
    v_cvt_pk_bf16_f32 v82, v164, v165
    v_cvt_pk_bf16_f32 v83, v166, v167
    v_mfma_f32_16x16x32_bf16 v[180:183], a[204:207], a[184:187], v[180:183]
    buffer_store_dwordx4 v[80:83], v11, s[28:31], s3 offen offset:1024 sc1
    v_cvt_pk_bf16_f32 v84, v168, v169
    v_mfma_f32_16x16x32_bf16 v[188:191], a[204:207], a[188:191], v[188:191]
    s_waitcnt lgkmcnt(4)
    v_cvt_pk_bf16_f32 v85, v170, v171
    v_cvt_pk_bf16_f32 v86, v172, v173
    v_cvt_pk_bf16_f32 v87, v174, v175
    v_mfma_f32_16x16x32_bf16 v[192:195], a[208:211], a[176:179], v[192:195]
    buffer_store_dwordx4 v[84:87], v11, s[28:31], s3 offen offset:2048 sc1
    v_mfma_f32_16x16x32_bf16 v[200:203], a[208:211], a[180:183], v[200:203]
    v_mfma_f32_16x16x32_bf16 v[196:199], a[212:215], a[176:179], v[196:199]
    v_mfma_f32_16x16x32_bf16 v[204:207], a[212:215], a[180:183], v[204:207]
    s_waitcnt lgkmcnt(0)
    v_cvt_pk_bf16_f32 v88, v176, v177
    v_cvt_pk_bf16_f32 v89, v178, v179
    v_cvt_pk_bf16_f32 v90, v180, v181
    v_mfma_f32_16x16x32_bf16 v[192:195], a[216:219], a[184:187], v[192:195]
    v_cvt_pk_bf16_f32 v91, v182, v183
    v_mfma_f32_16x16x32_bf16 v[200:203], a[216:219], a[188:191], v[200:203]
    s_add_u32 s3, s50, 6144
    s_cmp_eq_u32 s51, 2
    s_cselect_b32 s3, 0xa000, s3
    v_mfma_f32_16x16x32_bf16 v[196:199], a[220:223], a[184:187], v[196:199]
    buffer_store_dwordx4 v[88:91], v11, s[28:31], s3 offen offset:0 sc1
    v_cvt_pk_bf16_f32 v92, v184, v185
    v_mfma_f32_16x16x32_bf16 v[204:207], a[220:223], a[188:191], v[204:207]
    v_cvt_pk_bf16_f32 v93, v186, v187
    v_cvt_pk_bf16_f32 v94, v188, v189
    v_cvt_pk_bf16_f32 v95, v190, v191
    buffer_store_dwordx4 v[92:95], v11, s[28:31], s3 offen offset:1024 sc1
    v_cvt_pk_bf16_f32 v96, v192, v193
    v_cvt_pk_bf16_f32 v97, v194, v195
    v_cvt_pk_bf16_f32 v98, v196, v197
    v_cvt_pk_bf16_f32 v99, v198, v199
    s_add_u32 s3, s50, 8192
    s_cmp_eq_u32 s51, 3
    s_cselect_b32 s3, 0xa000, s3
    buffer_store_dwordx4 v[96:99], v11, s[28:31], s3 offen offset:0 sc1
    v_cvt_pk_bf16_f32 v100, v200, v201
    v_cvt_pk_bf16_f32 v101, v202, v203
    v_cvt_pk_bf16_f32 v102, v204, v205
    v_cvt_pk_bf16_f32 v103, v206, v207
    buffer_store_dwordx4 v[100:103], v11, s[28:31], s3 offen offset:1024 sc1
    s_waitcnt vmcnt(0)
    s_barrier
    s_cmp_lg_u32 s40, 0
    s_cbranch_scc1 H2_NF
    global_store_dword v1, v2, s[6:7] sc1
H2_NF:
    s_mov_b32 s52, 262144
H2_POLL:
    global_load_dword v48, v3, s[6:7] offset:0 sc1
    s_sub_u32 s52, s52, 1
    s_waitcnt vmcnt(0)
    s_cbranch_scc1 H2_OK
    v_cmp_ne_u32 vcc, s5, v48
    s_cbranch_vccz H2_OK
    s_sleep 1
    s_branch H2_POLL
H2_OK:
    s_cmp_eq_u32 s51, 0
    s_cbranch_scc1 X_V0
    s_cmp_eq_u32 s51, 1
    s_cbranch_scc1 X_V1
    s_cmp_eq_u32 s51, 2
    s_cbranch_scc1 X_V2
    s_branch X_V3
X_V0:
    s_add_u32 s53, s48, 1
    s_and_b32 s53, s53, 3
    s_mul_i32 s53, s53, 10240
    s_add_u32 s53, s53, 0
    buffer_load_dwordx4 v[64:67], v11, s[28:31], s53 offen offset:0 sc1
    buffer_load_dwordx4 v[68:71], v11, s[28:31], s53 offen offset:1024 sc1
    buffer_load_dwordx4 v[72:75], v11, s[28:31], s53 offen offset:2048 sc1
    s_add_u32 s53, s48, 2
    s_and_b32 s53, s53, 3
    s_mul_i32 s53, s53, 10240
    s_add_u32 s53, s53, 0
    buffer_load_dwordx4 v[76:79], v11, s[28:31], s53 offen offset:0 sc1
    buffer_load_dwordx4 v[80:83], v11, s[28:31], s53 offen offset:1024 sc1
    buffer_load_dwordx4 v[84:87], v11, s[28:31], s53 offen offset:2048 sc1
    s_add_u32 s53, s48, 3
    s_and_b32 s53, s53, 3
    s_mul_i32 s53, s53, 10240
    s_add_u32 s53, s53, 0
    buffer_load_dwordx4 v[88:91], v11, s[28:31], s53 offen offset:0 sc1
    buffer_load_dwordx4 v[92:95], v11, s[28:31], s53 offen offset:1024 sc1
    buffer_load_dwordx4 v[96:99], v11, s[28:31], s53 offen offset:2048 sc1
    s_waitcnt vmcnt(8)
    v_lshlrev_b32 v38, 16, v64
    v_and_b32 v39, 0xffff0000, v64
    v_add_f32 v128, v128, v38
    v_add_f32 v129, v129, v39
    v_lshlrev_b32 v38, 16, v65
    v_and_b32 v39, 0xffff0000, v65
    v_add_f32 v130, v130, v38
    v_add_f32 v131, v131, v39
    v_lshlrev_b32 v38, 16, v66
    v_and_b32 v39, 0xffff0000, v66
    v_add_f32 v132, v132, v38
    v_add_f32 v133, v133, v39
    v_lshlrev_b32 v38, 16, v67
    v_and_b32 v39, 0xffff0000, v67
    v_add_f32 v134, v134, v38
    v_add_f32 v135, v135, v39
    s_waitcnt vmcnt(7)
    v_lshlrev_b32 v38, 16, v68
    v_and_b32 v39, 0xffff0000, v68
    v_add_f32 v136, v136, v38
    v_add_f32 v137, v137, v39
    v_lshlrev_b32 v38, 16, v69
    v_and_b32 v39, 0xffff0000, v69
    v_add_f32 v138, v138, v38
    v_add_f32 v139, v139, v39
    v_lshlrev_b32 v38, 16, v70
    v_and_b32 v39, 0xffff0000, v70
    v_add_f32 v140, v140, v38
    v_add_f32 v141, v141, v39
    v_lshlrev_b32 v38, 16, v71
    v_and_b32 v39, 0xffff0000, v71
    v_add_f32 v142, v142, v38
    v_add_f32 v143, v143, v39
    s_waitcnt vmcnt(6)
    v_lshlrev_b32 v38, 16, v72
    v_and_b32 v39, 0xffff0000, v72
    v_add_f32 v144, v144, v38
    v_add_f32 v145, v145, v39
    v_lshlrev_b32 v38, 16, v73
    v_and_b32 v39, 0xffff0000, v73
    v_add_f32 v146, v146, v38
    v_add_f32 v147, v147, v39
    v_lshlrev_b32 v38, 16, v74
    v_and_b32 v39, 0xffff0000, v74
    v_add_f32 v148, v148, v38
    v_add_f32 v149, v149, v39
    v_lshlrev_b32 v38, 16, v75
    v_and_b32 v39, 0xffff0000, v75
    v_add_f32 v150, v150, v38
    v_add_f32 v151, v151, v39
    s_waitcnt vmcnt(5)
    v_lshlrev_b32 v38, 16, v76
    v_and_b32 v39, 0xffff0000, v76
    v_add_f32 v128, v128, v38
    v_add_f32 v129, v129, v39
    v_lshlrev_b32 v38, 16, v77
    v_and_b32 v39, 0xffff0000, v77
    v_add_f32 v130, v130, v38
    v_add_f32 v131, v131, v39
    v_lshlrev_b32 v38, 16, v78
    v_and_b32 v39, 0xffff0000, v78
    v_add_f32 v132, v132, v38
    v_add_f32 v133, v133, v39
    v_lshlrev_b32 v38, 16, v79
    v_and_b32 v39, 0xffff0000, v79
    v_add_f32 v134, v134, v38
    v_add_f32 v135, v135, v39
    s_waitcnt vmcnt(4)
    v_lshlrev_b32 v38, 16, v80
    v_and_b32 v39, 0xffff0000, v80
    v_add_f32 v136, v136, v38
    v_add_f32 v137, v137, v39
    v_lshlrev_b32 v38, 16, v81
    v_and_b32 v39, 0xffff0000, v81
    v_add_f32 v138, v138, v38
    v_add_f32 v139, v139, v39
    v_lshlrev_b32 v38, 16, v82
    v_and_b32 v39, 0xffff0000, v82
    v_add_f32 v140, v140, v38
    v_add_f32 v141, v141, v39
    v_lshlrev_b32 v38, 16, v83
    v_and_b32 v39, 0xffff0000, v83
    v_add_f32 v142, v142, v38
    v_add_f32 v143, v143, v39
    s_waitcnt vmcnt(3)
    v_lshlrev_b32 v38, 16, v84
    v_and_b32 v39, 0xffff0000, v84
    v_add_f32 v144, v144, v38
    v_add_f32 v145, v145, v39
    v_lshlrev_b32 v38, 16, v85
    v_and_b32 v39, 0xffff0000, v85
    v_add_f32 v146, v146, v38
    v_add_f32 v147, v147, v39
    v_lshlrev_b32 v38, 16, v86
    v_and_b32 v39, 0xffff0000, v86
    v_add_f32 v148, v148, v38
    v_add_f32 v149, v149, v39
    v_lshlrev_b32 v38, 16, v87
    v_and_b32 v39, 0xffff0000, v87
    v_add_f32 v150, v150, v38
    v_add_f32 v151, v151, v39
    s_waitcnt vmcnt(2)
    v_lshlrev_b32 v38, 16, v88
    v_and_b32 v39, 0xffff0000, v88
    v_add_f32 v128, v128, v38
    v_add_f32 v129, v129, v39
    v_lshlrev_b32 v38, 16, v89
    v_and_b32 v39, 0xffff0000, v89
    v_add_f32 v130, v130, v38
    v_add_f32 v131, v131, v39
    v_lshlrev_b32 v38, 16, v90
    v_and_b32 v39, 0xffff0000, v90
    v_add_f32 v132, v132, v38
    v_add_f32 v133, v133, v39
    v_lshlrev_b32 v38, 16, v91
    v_and_b32 v39, 0xffff0000, v91
    v_add_f32 v134, v134, v38
    v_add_f32 v135, v135, v39
    s_waitcnt vmcnt(1)
    v_lshlrev_b32 v38, 16, v92
    v_and_b32 v39, 0xffff0000, v92
    v_add_f32 v136, v136, v38
    v_add_f32 v137, v137, v39
    v_lshlrev_b32 v38, 16, v93
    v_and_b32 v39, 0xffff0000, v93
    v_add_f32 v138, v138, v38
    v_add_f32 v139, v139, v39
    v_lshlrev_b32 v38, 16, v94
    v_and_b32 v39, 0xffff0000, v94
    v_add_f32 v140, v140, v38
    v_add_f32 v141, v141, v39
    v_lshlrev_b32 v38, 16, v95
    v_and_b32 v39, 0xffff0000, v95
    v_add_f32 v142, v142, v38
    v_add_f32 v143, v143, v39
    s_waitcnt vmcnt(0)
    v_lshlrev_b32 v38, 16, v96
    v_and_b32 v39, 0xffff0000, v96
    v_add_f32 v144, v144, v38
    v_add_f32 v145, v145, v39
    v_lshlrev_b32 v38, 16, v97
    v_and_b32 v39, 0xffff0000, v97
    v_add_f32 v146, v146, v38
    v_add_f32 v147, v147, v39
    v_lshlrev_b32 v38, 16, v98
    v_and_b32 v39, 0xffff0000, v98
    v_add_f32 v148, v148, v38
    v_add_f32 v149, v149, v39
    v_lshlrev_b32 v38, 16, v99
    v_and_b32 v39, 0xffff0000, v99
    v_add_f32 v150, v150, v38
    v_add_f32 v151, v151, v39
    s_nop 2
    v_cvt_pk_bf16_f32 v112, v128, v129
    v_cvt_pk_bf16_f32 v113, v130, v131
    v_cvt_pk_bf16_f32 v114, v132, v133
    v_cvt_pk_bf16_f32 v115, v134, v135
    v_cvt_pk_bf16_f32 v116, v136, v137
    v_cvt_pk_bf16_f32 v117, v138, v139
    v_cvt_pk_bf16_f32 v118, v140, v141
    v_cvt_pk_bf16_f32 v119, v142, v143
    v_cvt_pk_bf16_f32 v120, v144, v145
    v_cvt_pk_bf16_f32 v121, v146, v147
    v_cvt_pk_bf16_f32 v122, v148, v149
    v_cvt_pk_bf16_f32 v123, v150, v151
    v_permlane32_swap_b32 v112, v114
    v_permlane32_swap_b32 v113, v115
    v_permlane32_swap_b32 v116, v118
    v_permlane32_swap_b32 v117, v119
    v_permlane32_swap_b32 v120, v122
    v_permlane32_swap_b32 v121, v123
    v_permlane16_swap_b32 v112, v114
    v_permlane16_swap_b32 v113, v115
    v_permlane16_swap_b32 v116, v118
    v_permlane16_swap_b32 v117, v119
    v_permlane16_swap_b32 v120, v122
    v_permlane16_swap_b32 v121, v123
    buffer_store_dwordx4 v[112:115], v17, s[32:35], 0 offen offset:0
    buffer_store_dwordx4 v[116:119], v17, s[32:35], s49 offen offset:0
    buffer_store_dwordx4 v[120:123], v17, s[32:35], 0 offen offset:64
    s_branch K_FIN
X_V1:
    s_add_u32 s53, s48, 1
    s_and_b32 s53, s53, 3
    s_mul_i32 s53, s53, 10240
    s_add_u32 s53, s53, 3072
    buffer_load_dwordx4 v[64:67], v11, s[28:31], s53 offen offset:0 sc1
    buffer_load_dwordx4 v[68:71], v11, s[28:31], s53 offen offset:1024 sc1
    buffer_load_dwordx4 v[72:75], v11, s[28:31], s53 offen offset:2048 sc1
    s_add_u32 s53, s48, 2
    s_and_b32 s53, s53, 3
    s_mul_i32 s53, s53, 10240
    s_add_u32 s53, s53, 3072
    buffer_load_dwordx4 v[76:79], v11, s[28:31], s53 offen offset:0 sc1
    buffer_load_dwordx4 v[80:83], v11, s[28:31], s53 offen offset:1024 sc1
    buffer_load_dwordx4 v[84:87], v11, s[28:31], s53 offen offset:2048 sc1
    s_add_u32 s53, s48, 3
    s_and_b32 s53, s53, 3
    s_mul_i32 s53, s53, 10240
    s_add_u32 s53, s53, 3072
    buffer_load_dwordx4 v[88:91], v11, s[28:31], s53 offen offset:0 sc1
    buffer_load_dwordx4 v[92:95], v11, s[28:31], s53 offen offset:1024 sc1
    buffer_load_dwordx4 v[96:99], v11, s[28:31], s53 offen offset:2048 sc1
    s_waitcnt vmcnt(8)
    v_lshlrev_b32 v38, 16, v64
    v_and_b32 v39, 0xffff0000, v64
    v_add_f32 v152, v152, v38
    v_add_f32 v153, v153, v39
    v_lshlrev_b32 v38, 16, v65
    v_and_b32 v39, 0xffff0000, v65
    v_add_f32 v154, v154, v38
    v_add_f32 v155, v155, v39
    v_lshlrev_b32 v38, 16, v66
    v_and_b32 v39, 0xffff0000, v66
    v_add_f32 v156, v156, v38
    v_add_f32 v157, v157, v39
    v_lshlrev_b32 v38, 16, v67
    v_and_b32 v39, 0xffff0000, v67
    v_add_f32 v158, v158, v38
    v_add_f32 v159, v159, v39
    s_waitcnt vmcnt(7)
    v_lshlrev_b32 v38, 16, v68
    v_and_b32 v39, 0xffff0000, v68
    v_add_f32 v160, v160, v38
    v_add_f32 v161, v161, v39
    v_lshlrev_b32 v38, 16, v69
    v_and_b32 v39, 0xffff0000, v69
    v_add_f32 v162, v162, v38
    v_add_f32 v163, v163, v39
    v_lshlrev_b32 v38, 16, v70
    v_and_b32 v39, 0xffff0000, v70
    v_add_f32 v164, v164, v38
    v_add_f32 v165, v165, v39
    v_lshlrev_b32 v38, 16, v71
    v_and_b32 v39, 0xffff0000, v71
    v_add_f32 v166, v166, v38
    v_add_f32 v167, v167, v39
    s_waitcnt vmcnt(6)
    v_lshlrev_b32 v38, 16, v72
    v_and_b32 v39, 0xffff0000, v72
    v_add_f32 v168, v168, v38
    v_add_f32 v169, v169, v39
    v_lshlrev_b32 v38, 16, v73
    v_and_b32 v39, 0xffff0000, v73
    v_add_f32 v170, v170, v38
    v_add_f32 v171, v171, v39
    v_lshlrev_b32 v38, 16, v74
    v_and_b32 v39, 0xffff0000, v74
    v_add_f32 v172, v172, v38
    v_add_f32 v173, v173, v39
    v_lshlrev_b32 v38, 16, v75
    v_and_b32 v39, 0xffff0000, v75
    v_add_f32 v174, v174, v38
    v_add_f32 v175, v175, v39
    s_waitcnt vmcnt(5)
    v_lshlrev_b32 v38, 16, v76
    v_and_b32 v39, 0xffff0000, v76
    v_add_f32 v152, v152, v38
    v_add_f32 v153, v153, v39
    v_lshlrev_b32 v38, 16, v77
    v_and_b32 v39, 0xffff0000, v77
    v_add_f32 v154, v154, v38
    v_add_f32 v155, v155, v39
    v_lshlrev_b32 v38, 16, v78
    v_and_b32 v39, 0xffff0000, v78
    v_add_f32 v156, v156, v38
    v_add_f32 v157, v157, v39
    v_lshlrev_b32 v38, 16, v79
    v_and_b32 v39, 0xffff0000, v79
    v_add_f32 v158, v158, v38
    v_add_f32 v159, v159, v39
    s_waitcnt vmcnt(4)
    v_lshlrev_b32 v38, 16, v80
    v_and_b32 v39, 0xffff0000, v80
    v_add_f32 v160, v160, v38
    v_add_f32 v161, v161, v39
    v_lshlrev_b32 v38, 16, v81
    v_and_b32 v39, 0xffff0000, v81
    v_add_f32 v162, v162, v38
    v_add_f32 v163, v163, v39
    v_lshlrev_b32 v38, 16, v82
    v_and_b32 v39, 0xffff0000, v82
    v_add_f32 v164, v164, v38
    v_add_f32 v165, v165, v39
    v_lshlrev_b32 v38, 16, v83
    v_and_b32 v39, 0xffff0000, v83
    v_add_f32 v166, v166, v38
    v_add_f32 v167, v167, v39
    s_waitcnt vmcnt(3)
    v_lshlrev_b32 v38, 16, v84
    v_and_b32 v39, 0xffff0000, v84
    v_add_f32 v168, v168, v38
    v_add_f32 v169, v169, v39
    v_lshlrev_b32 v38, 16, v85
    v_and_b32 v39, 0xffff0000, v85
    v_add_f32 v170, v170, v38
    v_add_f32 v171, v171, v39
    v_lshlrev_b32 v38, 16, v86
    v_and_b32 v39, 0xffff0000, v86
    v_add_f32 v172, v172, v38
    v_add_f32 v173, v173, v39
    v_lshlrev_b32 v38, 16, v87
    v_and_b32 v39, 0xffff0000, v87
    v_add_f32 v174, v174, v38
    v_add_f32 v175, v175, v39
    s_waitcnt vmcnt(2)
    v_lshlrev_b32 v38, 16, v88
    v_and_b32 v39, 0xffff0000, v88
    v_add_f32 v152, v152, v38
    v_add_f32 v153, v153, v39
    v_lshlrev_b32 v38, 16, v89
    v_and_b32 v39, 0xffff0000, v89
    v_add_f32 v154, v154, v38
    v_add_f32 v155, v155, v39
    v_lshlrev_b32 v38, 16, v90
    v_and_b32 v39, 0xffff0000, v90
    v_add_f32 v156, v156, v38
    v_add_f32 v157, v157, v39
    v_lshlrev_b32 v38, 16, v91
    v_and_b32 v39, 0xffff0000, v91
    v_add_f32 v158, v158, v38
    v_add_f32 v159, v159, v39
    s_waitcnt vmcnt(1)
    v_lshlrev_b32 v38, 16, v92
    v_and_b32 v39, 0xffff0000, v92
    v_add_f32 v160, v160, v38
    v_add_f32 v161, v161, v39
    v_lshlrev_b32 v38, 16, v93
    v_and_b32 v39, 0xffff0000, v93
    v_add_f32 v162, v162, v38
    v_add_f32 v163, v163, v39
    v_lshlrev_b32 v38, 16, v94
    v_and_b32 v39, 0xffff0000, v94
    v_add_f32 v164, v164, v38
    v_add_f32 v165, v165, v39
    v_lshlrev_b32 v38, 16, v95
    v_and_b32 v39, 0xffff0000, v95
    v_add_f32 v166, v166, v38
    v_add_f32 v167, v167, v39
    s_waitcnt vmcnt(0)
    v_lshlrev_b32 v38, 16, v96
    v_and_b32 v39, 0xffff0000, v96
    v_add_f32 v168, v168, v38
    v_add_f32 v169, v169, v39
    v_lshlrev_b32 v38, 16, v97
    v_and_b32 v39, 0xffff0000, v97
    v_add_f32 v170, v170, v38
    v_add_f32 v171, v171, v39
    v_lshlrev_b32 v38, 16, v98
    v_and_b32 v39, 0xffff0000, v98
    v_add_f32 v172, v172, v38
    v_add_f32 v173, v173, v39
    v_lshlrev_b32 v38, 16, v99
    v_and_b32 v39, 0xffff0000, v99
    v_add_f32 v174, v174, v38
    v_add_f32 v175, v175, v39
    s_nop 2
    v_cvt_pk_bf16_f32 v112, v152, v153
    v_cvt_pk_bf16_f32 v113, v154, v155
    v_cvt_pk_bf16_f32 v114, v156, v157
    v_cvt_pk_bf16_f32 v115, v158, v159
    v_cvt_pk_bf16_f32 v116, v160, v161
    v_cvt_pk_bf16_f32 v117, v162, v163
    v_cvt_pk_bf16_f32 v118, v164, v165
    v_cvt_pk_bf16_f32 v119, v166, v167
    v_cvt_pk_bf16_f32 v120, v168, v169
    v_cvt_pk_bf16_f32 v121, v170, v171
    v_cvt_pk_bf16_f32 v122, v172, v173
    v_cvt_pk_bf16_f32 v123, v174, v175
    v_permlane32_swap_b32 v112, v114
    v_permlane32_swap_b32 v113, v115
    v_permlane32_swap_b32 v116, v118
    v_permlane32_swap_b32 v117, v119
    v_permlane32_swap_b32 v120, v122
    v_permlane32_swap_b32 v121, v123
    v_permlane16_swap_b32 v112, v114
    v_permlane16_swap_b32 v113, v115
    v_permlane16_swap_b32 v116, v118
    v_permlane16_swap_b32 v117, v119
    v_permlane16_swap_b32 v120, v122
    v_permlane16_swap_b32 v121, v123
    buffer_store_dwordx4 v[112:115], v17, s[32:35], s49 offen offset:64
    buffer_store_dwordx4 v[116:119], v17, s[32:35], 0 offen offset:128
    buffer_store_dwordx4 v[120:123], v17, s[32:35], s49 offen offset:128
    s_branch K_FIN
X_V2:
    s_add_u32 s53, s48, 1
    s_and_b32 s53, s53, 3
    s_mul_i32 s53, s53, 10240
    s_add_u32 s53, s53, 6144
    buffer_load_dwordx4 v[64:67], v11, s[28:31], s53 offen offset:0 sc1
    buffer_load_dwordx4 v[68:71], v11, s[28:31], s53 offen offset:1024 sc1
    s_add_u32 s53, s48, 2
    s_and_b32 s53, s53, 3
    s_mul_i32 s53, s53, 10240
    s_add_u32 s53, s53, 6144
    buffer_load_dwordx4 v[76:79], v11, s[28:31], s53 offen offset:0 sc1
    buffer_load_dwordx4 v[80:83], v11, s[28:31], s53 offen offset:1024 sc1
    s_add_u32 s53, s48, 3
    s_and_b32 s53, s53, 3
    s_mul_i32 s53, s53, 10240
    s_add_u32 s53, s53, 6144
    buffer_load_dwordx4 v[88:91], v11, s[28:31], s53 offen offset:0 sc1
    buffer_load_dwordx4 v[92:95], v11, s[28:31], s53 offen offset:1024 sc1
    s_waitcnt vmcnt(5)
    v_lshlrev_b32 v38, 16, v64
    v_and_b32 v39, 0xffff0000, v64
    v_add_f32 v176, v176, v38
    v_add_f32 v177, v177, v39
    v_lshlrev_b32 v38, 16, v65
    v_and_b32 v39, 0xffff0000, v65
    v_add_f32 v178, v178, v38
    v_add_f32 v179, v179, v39
    v_lshlrev_b32 v38, 16, v66
    v_and_b32 v39, 0xffff0000, v66
    v_add_f32 v180, v180, v38
    v_add_f32 v181, v181, v39
    v_lshlrev_b32 v38, 16, v67
    v_and_b32 v39, 0xffff0000, v67
    v_add_f32 v182, v182, v38
    v_add_f32 v183, v183, v39
    s_waitcnt vmcnt(4)
    v_lshlrev_b32 v38, 16, v68
    v_and_b32 v39, 0xffff0000, v68
    v_add_f32 v184, v184, v38
    v_add_f32 v185, v185, v39
    v_lshlrev_b32 v38, 16, v69
    v_and_b32 v39, 0xffff0000, v69
    v_add_f32 v186, v186, v38
    v_add_f32 v187, v187, v39
    v_lshlrev_b32 v38, 16, v70
    v_and_b32 v39, 0xffff0000, v70
    v_add_f32 v188, v188, v38
    v_add_f32 v189, v189, v39
    v_lshlrev_b32 v38, 16, v71
    v_and_b32 v39, 0xffff0000, v71
    v_add_f32 v190, v190, v38
    v_add_f32 v191, v191, v39
    s_waitcnt vmcnt(3)
    v_lshlrev_b32 v38, 16, v76
    v_and_b32 v39, 0xffff0000, v76
    v_add_f32 v176, v176, v38
    v_add_f32 v177, v177, v39
    v_lshlrev_b32 v38, 16, v77
    v_and_b32 v39, 0xffff0000, v77
    v_add_f32 v178, v178, v38
    v_add_f32 v179, v179, v39
    v_lshlrev_b32 v38, 16, v78
    v_and_b32 v39, 0xffff0000, v78
    v_add_f32 v180, v180, v38
    v_add_f32 v181, v181, v39
    v_lshlrev_b32 v38, 16, v79
    v_and_b32 v39, 0xffff0000, v79
    v_add_f32 v182, v182, v38
    v_add_f32 v183, v183, v39
    s_waitcnt vmcnt(2)
    v_lshlrev_b32 v38, 16, v80
    v_and_b32 v39, 0xffff0000, v80
    v_add_f32 v184, v184, v38
    v_add_f32 v185, v185, v39
    v_lshlrev_b32 v38, 16, v81
    v_and_b32 v39, 0xffff0000, v81
    v_add_f32 v186, v186, v38
    v_add_f32 v187, v187, v39
    v_lshlrev_b32 v38, 16, v82
    v_and_b32 v39, 0xffff0000, v82
    v_add_f32 v188, v188, v38
    v_add_f32 v189, v189, v39
    v_lshlrev_b32 v38, 16, v83
    v_and_b32 v39, 0xffff0000, v83
    v_add_f32 v190, v190, v38
    v_add_f32 v191, v191, v39
    s_waitcnt vmcnt(1)
    v_lshlrev_b32 v38, 16, v88
    v_and_b32 v39, 0xffff0000, v88
    v_add_f32 v176, v176, v38
    v_add_f32 v177, v177, v39
    v_lshlrev_b32 v38, 16, v89
    v_and_b32 v39, 0xffff0000, v89
    v_add_f32 v178, v178, v38
    v_add_f32 v179, v179, v39
    v_lshlrev_b32 v38, 16, v90
    v_and_b32 v39, 0xffff0000, v90
    v_add_f32 v180, v180, v38
    v_add_f32 v181, v181, v39
    v_lshlrev_b32 v38, 16, v91
    v_and_b32 v39, 0xffff0000, v91
    v_add_f32 v182, v182, v38
    v_add_f32 v183, v183, v39
    s_waitcnt vmcnt(0)
    v_lshlrev_b32 v38, 16, v92
    v_and_b32 v39, 0xffff0000, v92
    v_add_f32 v184, v184, v38
    v_add_f32 v185, v185, v39
    v_lshlrev_b32 v38, 16, v93
    v_and_b32 v39, 0xffff0000, v93
    v_add_f32 v186, v186, v38
    v_add_f32 v187, v187, v39
    v_lshlrev_b32 v38, 16, v94
    v_and_b32 v39, 0xffff0000, v94
    v_add_f32 v188, v188, v38
    v_add_f32 v189, v189, v39
    v_lshlrev_b32 v38, 16, v95
    v_and_b32 v39, 0xffff0000, v95
    v_add_f32 v190, v190, v38
    v_add_f32 v191, v191, v39
    s_nop 2
    v_cvt_pk_bf16_f32 v112, v176, v177
    v_cvt_pk_bf16_f32 v113, v178, v179
    v_cvt_pk_bf16_f32 v114, v180, v181
    v_cvt_pk_bf16_f32 v115, v182, v183
    v_cvt_pk_bf16_f32 v116, v184, v185
    v_cvt_pk_bf16_f32 v117, v186, v187
    v_cvt_pk_bf16_f32 v118, v188, v189
    v_cvt_pk_bf16_f32 v119, v190, v191
    v_permlane32_swap_b32 v112, v114
    v_permlane32_swap_b32 v113, v115
    v_permlane32_swap_b32 v116, v118
    v_permlane32_swap_b32 v117, v119
    v_permlane16_swap_b32 v112, v114
    v_permlane16_swap_b32 v113, v115
    v_permlane16_swap_b32 v116, v118
    v_permlane16_swap_b32 v117, v119
    buffer_store_dwordx4 v[112:115], v17, s[32:35], 0 offen offset:192
    buffer_store_dwordx4 v[116:119], v17, s[32:35], s49 offen offset:192
    s_branch K_FIN
X_V3:
    s_add_u32 s53, s48, 1
    s_and_b32 s53, s53, 3
    s_mul_i32 s53, s53, 10240
    s_add_u32 s53, s53, 8192
    buffer_load_dwordx4 v[64:67], v11, s[28:31], s53 offen offset:0 sc1
    buffer_load_dwordx4 v[68:71], v11, s[28:31], s53 offen offset:1024 sc1
    s_add_u32 s53, s48, 2
    s_and_b32 s53, s53, 3
    s_mul_i32 s53, s53, 10240
    s_add_u32 s53, s53, 8192
    buffer_load_dwordx4 v[76:79], v11, s[28:31], s53 offen offset:0 sc1
    buffer_load_dwordx4 v[80:83], v11, s[28:31], s53 offen offset:1024 sc1
    s_add_u32 s53, s48, 3
    s_and_b32 s53, s53, 3
    s_mul_i32 s53, s53, 10240
    s_add_u32 s53, s53, 8192
    buffer_load_dwordx4 v[88:91], v11, s[28:31], s53 offen offset:0 sc1
    buffer_load_dwordx4 v[92:95], v11, s[28:31], s53 offen offset:1024 sc1
    s_waitcnt vmcnt(5)
    v_lshlrev_b32 v38, 16, v64
    v_and_b32 v39, 0xffff0000, v64
    v_add_f32 v192, v192, v38
    v_add_f32 v193, v193, v39
    v_lshlrev_b32 v38, 16, v65
    v_and_b32 v39, 0xffff0000, v65
    v_add_f32 v194, v194, v38
    v_add_f32 v195, v195, v39
    v_lshlrev_b32 v38, 16, v66
    v_and_b32 v39, 0xffff0000, v66
    v_add_f32 v196, v196, v38
    v_add_f32 v197, v197, v39
    v_lshlrev_b32 v38, 16, v67
    v_and_b32 v39, 0xffff0000, v67
    v_add_f32 v198, v198, v38
    v_add_f32 v199, v199, v39
    s_waitcnt vmcnt(4)
    v_lshlrev_b32 v38, 16, v68
    v_and_b32 v39, 0xffff0000, v68
    v_add_f32 v200, v200, v38
    v_add_f32 v201, v201, v39
    v_lshlrev_b32 v38, 16, v69
    v_and_b32 v39, 0xffff0000, v69
    v_add_f32 v202, v202, v38
    v_add_f32 v203, v203, v39
    v_lshlrev_b32 v38, 16, v70
    v_and_b32 v39, 0xffff0000, v70
    v_add_f32 v204, v204, v38
    v_add_f32 v205, v205, v39
    v_lshlrev_b32 v38, 16, v71
    v_and_b32 v39, 0xffff0000, v71
    v_add_f32 v206, v206, v38
    v_add_f32 v207, v207, v39
    s_waitcnt vmcnt(3)
    v_lshlrev_b32 v38, 16, v76
    v_and_b32 v39, 0xffff0000, v76
    v_add_f32 v192, v192, v38
    v_add_f32 v193, v193, v39
    v_lshlrev_b32 v38, 16, v77
    v_and_b32 v39, 0xffff0000, v77
    v_add_f32 v194, v194, v38
    v_add_f32 v195, v195, v39
    v_lshlrev_b32 v38, 16, v78
    v_and_b32 v39, 0xffff0000, v78
    v_add_f32 v196, v196, v38
    v_add_f32 v197, v197, v39
    v_lshlrev_b32 v38, 16, v79
    v_and_b32 v39, 0xffff0000, v79
    v_add_f32 v198, v198, v38
    v_add_f32 v199, v199, v39
    s_waitcnt vmcnt(2)
    v_lshlrev_b32 v38, 16, v80
    v_and_b32 v39, 0xffff0000, v80
    v_add_f32 v200, v200, v38
    v_add_f32 v201, v201, v39
    v_lshlrev_b32 v38, 16, v81
    v_and_b32 v39, 0xffff0000, v81
    v_add_f32 v202, v202, v38
    v_add_f32 v203, v203, v39
    v_lshlrev_b32 v38, 16, v82
    v_and_b32 v39, 0xffff0000, v82
    v_add_f32 v204, v204, v38
    v_add_f32 v205, v205, v39
    v_lshlrev_b32 v38, 16, v83
    v_and_b32 v39, 0xffff0000, v83
    v_add_f32 v206, v206, v38
    v_add_f32 v207, v207, v39
    s_waitcnt vmcnt(1)
    v_lshlrev_b32 v38, 16, v88
    v_and_b32 v39, 0xffff0000, v88
    v_add_f32 v192, v192, v38
    v_add_f32 v193, v193, v39
    v_lshlrev_b32 v38, 16, v89
    v_and_b32 v39, 0xffff0000, v89
    v_add_f32 v194, v194, v38
    v_add_f32 v195, v195, v39
    v_lshlrev_b32 v38, 16, v90
    v_and_b32 v39, 0xffff0000, v90
    v_add_f32 v196, v196, v38
    v_add_f32 v197, v197, v39
    v_lshlrev_b32 v38, 16, v91
    v_and_b32 v39, 0xffff0000, v91
    v_add_f32 v198, v198, v38
    v_add_f32 v199, v199, v39
    s_waitcnt vmcnt(0)
    v_lshlrev_b32 v38, 16, v92
    v_and_b32 v39, 0xffff0000, v92
    v_add_f32 v200, v200, v38
    v_add_f32 v201, v201, v39
    v_lshlrev_b32 v38, 16, v93
    v_and_b32 v39, 0xffff0000, v93
    v_add_f32 v202, v202, v38
    v_add_f32 v203, v203, v39
    v_lshlrev_b32 v38, 16, v94
    v_and_b32 v39, 0xffff0000, v94
    v_add_f32 v204, v204, v38
    v_add_f32 v205, v205, v39
    v_lshlrev_b32 v38, 16, v95
    v_and_b32 v39, 0xffff0000, v95
    v_add_f32 v206, v206, v38
    v_add_f32 v207, v207, v39
    s_nop 2
    v_cvt_pk_bf16_f32 v112, v192, v193
    v_cvt_pk_bf16_f32 v113, v194, v195
    v_cvt_pk_bf16_f32 v114, v196, v197
    v_cvt_pk_bf16_f32 v115, v198, v199
    v_cvt_pk_bf16_f32 v116, v200, v201
    v_cvt_pk_bf16_f32 v117, v202, v203
    v_cvt_pk_bf16_f32 v118, v204, v205
    v_cvt_pk_bf16_f32 v119, v206, v207
    v_permlane32_swap_b32 v112, v114
    v_permlane32_swap_b32 v113, v115
    v_permlane32_swap_b32 v116, v118
    v_permlane32_swap_b32 v117, v119
    v_permlane16_swap_b32 v112, v114
    v_permlane16_swap_b32 v113, v115
    v_permlane16_swap_b32 v116, v118
    v_permlane16_swap_b32 v117, v119
    buffer_store_dwordx4 v[112:115], v17, s[32:35], 0 offen offset:256
    buffer_store_dwordx4 v[116:119], v17, s[32:35], s49 offen offset:256
    s_branch K_FIN
K_FIN:
    s_add_u32 s3, s101, s40
    s_cmp_lg_u32 s3, 0
    s_cbranch_scc1 K_NOEP
    s_lshl_b32 s3, s100, 7
    s_add_u32 s3, s3, 65536
    v_mov_b32 v1, s3
    global_store_dword v1, v2, s[6:7] sc1
K_NOEP:
K_END:
    s_endpgm
K_CODE_END:
RA_E:
    s_mov_b32 s51, 0
    s_branch RA_P0
RA_O:
    s_mov_b32 s51, 1
    s_branch RA_P1
RA_G:
    s_mov_b32 s51, 2
    s_branch RA_P1
RA_H:
    s_mov_b32 s51, 3
    s_branch RA_P0
RA_X:
    s_mov_b32 s51, 4
RA_P1:
    s_nop 15
    v_max3_f32 v38, v160, v161, v162
    v_max3_f32 v39, v168, v169, v170
    v_max3_f32 v40, v176, v177, v178
    v_max3_f32 v41, v184, v185, v186
    v_max3_f32 v38, v38, v163, v164
    v_max3_f32 v39, v39, v171, v172
    v_max3_f32 v40, v40, v179, v180
    v_max3_f32 v41, v41, v187, v188
    v_max3_f32 v38, v38, v165, v166
    v_max3_f32 v39, v39, v173, v174
    v_max3_f32 v40, v40, v181, v182
    v_max3_f32 v41, v41, v189, v190
    v_max_f32 v38, v38, v167
    v_max_f32 v39, v39, v175
    v_max_f32 v40, v40, v183
    v_max_f32 v41, v41, v191
    v_mov_b32 v42, v38
    v_mov_b32 v43, v39
    v_mov_b32 v44, v40
    v_mov_b32 v45, v41
    v_permlane32_swap_b32 v38, v42
    v_permlane32_swap_b32 v39, v43
    v_permlane32_swap_b32 v40, v44
    v_permlane32_swap_b32 v41, v45
    v_max_f32 v38, v38, v42
    v_max_f32 v39, v39, v43
    v_max_f32 v40, v40, v44
    v_max_f32 v41, v41, v45
    v_mov_b32 v42, v38
    v_mov_b32 v43, v39
    v_mov_b32 v44, v40
    v_mov_b32 v45, v41
    v_permlane16_swap_b32 v38, v42
    v_permlane16_swap_b32 v39, v43
    v_permlane16_swap_b32 v40, v44
    v_permlane16_swap_b32 v41, v45
    v_max_f32 v38, v38, v42
    v_max_f32 v39, v39, v43
    v_max_f32 v40, v40, v44
    v_max_f32 v41, v41, v45
    v_max_f32 v38, 0, v38
    v_sub_f32 v160, v160, v38
    v_sub_f32 v96, v96, v38
    v_sub_f32 v161, v161, v38
    v_sub_f32 v97, v97, v38
    v_sub_f32 v162, v162, v38
    v_sub_f32 v98, v98, v38
    v_sub_f32 v163, v163, v38
    v_sub_f32 v99, v99, v38
    v_sub_f32 v164, v164, v38
    v_sub_f32 v100, v100, v38
    v_sub_f32 v165, v165, v38
    v_sub_f32 v101, v101, v38
    v_sub_f32 v166, v166, v38
    v_sub_f32 v102, v102, v38
    v_sub_f32 v167, v167, v38
    v_sub_f32 v103, v103, v38
    v_sub_f32 v224, v224, v38
    v_sub_f32 v225, v225, v38
    v_sub_f32 v226, v226, v38
    v_sub_f32 v227, v227, v38
    v_sub_f32 v38, 0, v38
    v_exp_f32 v42, v38
    s_nop 1
    v_mul_f32 v20, v20, v42
    v_max_f32 v39, 0, v39
    v_sub_f32 v168, v168, v39
    v_sub_f32 v104, v104, v39
    v_sub_f32 v169, v169, v39
    v_sub_f32 v105, v105, v39
    v_sub_f32 v170, v170, v39
    v_sub_f32 v106, v106, v39
    v_sub_f32 v171, v171, v39
    v_sub_f32 v107, v107, v39
    v_sub_f32 v172, v172, v39
    v_sub_f32 v108, v108, v39
    v_sub_f32 v173, v173, v39
    v_sub_f32 v109, v109, v39
    v_sub_f32 v174, v174, v39
    v_sub_f32 v110, v110, v39
    v_sub_f32 v175, v175, v39
    v_sub_f32 v111, v111, v39
    v_sub_f32 v228, v228, v39
    v_sub_f32 v229, v229, v39
    v_sub_f32 v230, v230, v39
    v_sub_f32 v231, v231, v39
    v_sub_f32 v39, 0, v39
    v_exp_f32 v43, v39
    s_nop 1
    v_mul_f32 v21, v21, v43
    v_max_f32 v40, 0, v40
    v_sub_f32 v176, v176, v40
    v_sub_f32 v112, v112, v40
    v_sub_f32 v177, v177, v40
    v_sub_f32 v113, v113, v40
    v_sub_f32 v178, v178, v40
    v_sub_f32 v114, v114, v40
    v_sub_f32 v179, v179, v40
    v_sub_f32 v115, v115, v40
    v_sub_f32 v180, v180, v40
    v_sub_f32 v116, v116, v40
    v_sub_f32 v181, v181, v40
    v_sub_f32 v117, v117, v40
    v_sub_f32 v182, v182, v40
    v_sub_f32 v118, v118, v40
    v_sub_f32 v183, v183, v40
    v_sub_f32 v119, v119, v40
    v_sub_f32 v232, v232, v40
    v_sub_f32 v233, v233, v40
    v_sub_f32 v234, v234, v40
    v_sub_f32 v235, v235, v40
    v_sub_f32 v40, 0, v40
    v_exp_f32 v44, v40
    s_nop 1
    v_mul_f32 v22, v22, v44
    v_max_f32 v41, 0, v41
    v_sub_f32 v184, v184, v41
    v_sub_f32 v120, v120, v41
    v_sub_f32 v185, v185, v41
    v_sub_f32 v121, v121, v41
    v_sub_f32 v186, v186, v41
    v_sub_f32 v122, v122, v41
    v_sub_f32 v187, v187, v41
    v_sub_f32 v123, v123, v41
    v_sub_f32 v188, v188, v41
    v_sub_f32 v124, v124, v41
    v_sub_f32 v189, v189, v41
    v_sub_f32 v125, v125, v41
    v_sub_f32 v190, v190, v41
    v_sub_f32 v126, v126, v41
    v_sub_f32 v191, v191, v41
    v_sub_f32 v127, v127, v41
    v_sub_f32 v236, v236, v41
    v_sub_f32 v237, v237, v41
    v_sub_f32 v238, v238, v41
    v_sub_f32 v239, v239, v41
    v_sub_f32 v41, 0, v41
    v_exp_f32 v45, v41
    s_nop 1
    v_mul_f32 v23, v23, v45
    v_exp_f32 v28, v160
    v_exp_f32 v29, v161
    s_nop 0
    v_add_f32 v24, v28, v29
    v_cvt_pk_bf16_f32 v240, v28, v29
    v_exp_f32 v30, v162
    s_nop 0
    v_add_f32 v24, v24, v30
    v_exp_f32 v31, v163
    s_nop 0
    v_add_f32 v24, v24, v31
    v_cvt_pk_bf16_f32 v241, v30, v31
    v_exp_f32 v32, v164
    s_nop 0
    v_add_f32 v24, v24, v32
    v_exp_f32 v33, v165
    s_nop 0
    v_add_f32 v24, v24, v33
    v_cvt_pk_bf16_f32 v242, v32, v33
    v_exp_f32 v34, v166
    s_nop 0
    v_add_f32 v24, v24, v34
    v_exp_f32 v35, v167
    s_nop 0
    v_add_f32 v24, v24, v35
    v_cvt_pk_bf16_f32 v243, v34, v35
    v_exp_f32 v28, v168
    v_exp_f32 v29, v169
    s_nop 0
    v_add_f32 v25, v28, v29
    v_cvt_pk_bf16_f32 v244, v28, v29
    v_exp_f32 v30, v170
    s_nop 0
    v_add_f32 v25, v25, v30
    v_exp_f32 v31, v171
    s_nop 0
    v_add_f32 v25, v25, v31
    v_cvt_pk_bf16_f32 v245, v30, v31
    v_exp_f32 v32, v172
    s_nop 0
    v_add_f32 v25, v25, v32
    v_exp_f32 v33, v173
    s_nop 0
    v_add_f32 v25, v25, v33
    v_cvt_pk_bf16_f32 v246, v32, v33
    v_exp_f32 v34, v174
    s_nop 0
    v_add_f32 v25, v25, v34
    v_exp_f32 v35, v175
    s_nop 0
    v_add_f32 v25, v25, v35
    v_cvt_pk_bf16_f32 v247, v34, v35
    v_exp_f32 v28, v176
    v_exp_f32 v29, v177
    s_nop 0
    v_add_f32 v26, v28, v29
    v_cvt_pk_bf16_f32 v248, v28, v29
    v_exp_f32 v30, v178
    s_nop 0
    v_add_f32 v26, v26, v30
    v_exp_f32 v31, v179
    s_nop 0
    v_add_f32 v26, v26, v31
    v_cvt_pk_bf16_f32 v249, v30, v31
    v_exp_f32 v32, v180
    s_nop 0
    v_add_f32 v26, v26, v32
    v_exp_f32 v33, v181
    s_nop 0
    v_add_f32 v26, v26, v33
    v_cvt_pk_bf16_f32 v250, v32, v33
    v_exp_f32 v34, v182
    s_nop 0
    v_add_f32 v26, v26, v34
    v_exp_f32 v35, v183
    s_nop 0
    v_add_f32 v26, v26, v35
    v_cvt_pk_bf16_f32 v251, v34, v35
    v_exp_f32 v28, v184
    v_exp_f32 v29, v185
    s_nop 0
    v_add_f32 v27, v28, v29
    v_cvt_pk_bf16_f32 v252, v28, v29
    v_exp_f32 v30, v186
    s_nop 0
    v_add_f32 v27, v27, v30
    v_exp_f32 v31, v187
    s_nop 0
    v_add_f32 v27, v27, v31
    v_cvt_pk_bf16_f32 v253, v30, v31
    v_exp_f32 v32, v188
    s_nop 0
    v_add_f32 v27, v27, v32
    v_exp_f32 v33, v189
    s_nop 0
    v_add_f32 v27, v27, v33
    v_cvt_pk_bf16_f32 v254, v32, v33
    v_exp_f32 v34, v190
    s_nop 0
    v_add_f32 v27, v27, v34
    v_exp_f32 v35, v191
    s_nop 0
    v_add_f32 v27, v27, v35
    v_cvt_pk_bf16_f32 v255, v34, v35
    s_branch RB_COMMON
RA_F:
    s_mov_b32 s51, 5
RA_P0:
    s_nop 15
    v_max3_f32 v38, v96, v97, v98
    v_max3_f32 v39, v104, v105, v106
    v_max3_f32 v40, v112, v113, v114
    v_max3_f32 v41, v120, v121, v122
    v_max3_f32 v38, v38, v99, v100
    v_max3_f32 v39, v39, v107, v108
    v_max3_f32 v40, v40, v115, v116
    v_max3_f32 v41, v41, v123, v124
    v_max3_f32 v38, v38, v101, v102
    v_max3_f32 v39, v39, v109, v110
    v_max3_f32 v40, v40, v117, v118
    v_max3_f32 v41, v41, v125, v126
    v_max_f32 v38, v38, v103
    v_max_f32 v39, v39, v111
    v_max_f32 v40, v40, v119
    v_max_f32 v41, v41, v127
    v_mov_b32 v42, v38
    v_mov_b32 v43, v39
    v_mov_b32 v44, v40
    v_mov_b32 v45, v41
    v_permlane32_swap_b32 v38, v42
    v_permlane32_swap_b32 v39, v43
    v_permlane32_swap_b32 v40, v44
    v_permlane32_swap_b32 v41, v45
    v_max_f32 v38, v38, v42
    v_max_f32 v39, v39, v43
    v_max_f32 v40, v40, v44
    v_max_f32 v41, v41, v45
    v_mov_b32 v42, v38
    v_mov_b32 v43, v39
    v_mov_b32 v44, v40
    v_mov_b32 v45, v41
    v_permlane16_swap_b32 v38, v42
    v_permlane16_swap_b32 v39, v43
    v_permlane16_swap_b32 v40, v44
    v_permlane16_swap_b32 v41, v45
    v_max_f32 v38, v38, v42
    v_max_f32 v39, v39, v43
    v_max_f32 v40, v40, v44
    v_max_f32 v41, v41, v45
    v_max_f32 v38, 0, v38
    v_sub_f32 v96, v96, v38
    v_sub_f32 v160, v160, v38
    v_sub_f32 v97, v97, v38
    v_sub_f32 v161, v161, v38
    v_sub_f32 v98, v98, v38
    v_sub_f32 v162, v162, v38
    v_sub_f32 v99, v99, v38
    v_sub_f32 v163, v163, v38
    v_sub_f32 v100, v100, v38
    v_sub_f32 v164, v164, v38
    v_sub_f32 v101, v101, v38
    v_sub_f32 v165, v165, v38
    v_sub_f32 v102, v102, v38
    v_sub_f32 v166, v166, v38
    v_sub_f32 v103, v103, v38
    v_sub_f32 v167, v167, v38
    v_sub_f32 v224, v224, v38
    v_sub_f32 v225, v225, v38
    v_sub_f32 v226, v226, v38
    v_sub_f32 v227, v227, v38
    v_sub_f32 v38, 0, v38
    v_exp_f32 v42, v38
    s_nop 1
    v_mul_f32 v20, v20, v42
    v_max_f32 v39, 0, v39
    v_sub_f32 v104, v104, v39
    v_sub_f32 v168, v168, v39
    v_sub_f32 v105, v105, v39
    v_sub_f32 v169, v169, v39
    v_sub_f32 v106, v106, v39
    v_sub_f32 v170, v170, v39
    v_sub_f32 v107, v107, v39
    v_sub_f32 v171, v171, v39
    v_sub_f32 v108, v108, v39
    v_sub_f32 v172, v172, v39
    v_sub_f32 v109, v109, v39
    v_sub_f32 v173, v173, v39
    v_sub_f32 v110, v110, v39
    v_sub_f32 v174, v174, v39
    v_sub_f32 v111, v111, v39
    v_sub_f32 v175, v175, v39
    v_sub_f32 v228, v228, v39
    v_sub_f32 v229, v229, v39
    v_sub_f32 v230, v230, v39
    v_sub_f32 v231, v231, v39
    v_sub_f32 v39, 0, v39
    v_exp_f32 v43, v39
    s_nop 1
    v_mul_f32 v21, v21, v43
    v_max_f32 v40, 0, v40
    v_sub_f32 v112, v112, v40
    v_sub_f32 v176, v176, v40
    v_sub_f32 v113, v113, v40
    v_sub_f32 v177, v177, v40
    v_sub_f32 v114, v114, v40
    v_sub_f32 v178, v178, v40
    v_sub_f32 v115, v115, v40
    v_sub_f32 v179, v179, v40
    v_sub_f32 v116, v116, v40
    v_sub_f32 v180, v180, v40
    v_sub_f32 v117, v117, v40
    v_sub_f32 v181, v181, v40
    v_sub_f32 v118, v118, v40
    v_sub_f32 v182, v182, v40
    v_sub_f32 v119, v119, v40
    v_sub_f32 v183, v183, v40
    v_sub_f32 v232, v232, v40
    v_sub_f32 v233, v233, v40
    v_sub_f32 v234, v234, v40
    v_sub_f32 v235, v235, v40
    v_sub_f32 v40, 0, v40
    v_exp_f32 v44, v40
    s_nop 1
    v_mul_f32 v22, v22, v44
    v_max_f32 v41, 0, v41
    v_sub_f32 v120, v120, v41
    v_sub_f32 v184, v184, v41
    v_sub_f32 v121, v121, v41
    v_sub_f32 v185, v185, v41
    v_sub_f32 v122, v122, v41
    v_sub_f32 v186, v186, v41
    v_sub_f32 v123, v123, v41
    v_sub_f32 v187, v187, v41
    v_sub_f32 v124, v124, v41
    v_sub_f32 v188, v188, v41
    v_sub_f32 v125, v125, v41
    v_sub_f32 v189, v189, v41
    v_sub_f32 v126, v126, v41
    v_sub_f32 v190, v190, v41
    v_sub_f32 v127, v127, v41
    v_sub_f32 v191, v191, v41
    v_sub_f32 v236, v236, v41
    v_sub_f32 v237, v237, v41
    v_sub_f32 v238, v238, v41
    v_sub_f32 v239, v239, v41
    v_sub_f32 v41, 0, v41
    v_exp_f32 v45, v41
    s_nop 1
    v_mul_f32 v23, v23, v45
    v_exp_f32 v28, v96
    v_exp_f32 v29, v97
    s_nop 0
    v_add_f32 v24, v28, v29
    v_cvt_pk_bf16_f32 v48, v28, v29
    v_exp_f32 v30, v98
    s_nop 0
    v_add_f32 v24, v24, v30
    v_exp_f32 v31, v99
    s_nop 0
    v_add_f32 v24, v24, v31
    v_cvt_pk_bf16_f32 v49, v30, v31
    v_exp_f32 v32, v100
    s_nop 0
    v_add_f32 v24, v24, v32
    v_exp_f32 v33, v101
    s_nop 0
    v_add_f32 v24, v24, v33
    v_cvt_pk_bf16_f32 v50, v32, v33
    v_exp_f32 v34, v102
    s_nop 0
    v_add_f32 v24, v24, v34
    v_exp_f32 v35, v103
    s_nop 0
    v_add_f32 v24, v24, v35
    v_cvt_pk_bf16_f32 v51, v34, v35
    v_exp_f32 v28, v104
    v_exp_f32 v29, v105
    s_nop 0
    v_add_f32 v25, v28, v29
    v_cvt_pk_bf16_f32 v52, v28, v29
    v_exp_f32 v30, v106
    s_nop 0
    v_add_f32 v25, v25, v30
    v_exp_f32 v31, v107
    s_nop 0
    v_add_f32 v25, v25, v31
    v_cvt_pk_bf16_f32 v53, v30, v31
    v_exp_f32 v32, v108
    s_nop 0
    v_add_f32 v25, v25, v32
    v_exp_f32 v33, v109
    s_nop 0
    v_add_f32 v25, v25, v33
    v_cvt_pk_bf16_f32 v54, v32, v33
    v_exp_f32 v34, v110
    s_nop 0
    v_add_f32 v25, v25, v34
    v_exp_f32 v35, v111
    s_nop 0
    v_add_f32 v25, v25, v35
    v_cvt_pk_bf16_f32 v55, v34, v35
    v_exp_f32 v28, v112
    v_exp_f32 v29, v113
    s_nop 0
    v_add_f32 v26, v28, v29
    v_cvt_pk_bf16_f32 v56, v28, v29
    v_exp_f32 v30, v114
    s_nop 0
    v_add_f32 v26, v26, v30
    v_exp_f32 v31, v115
    s_nop 0
    v_add_f32 v26, v26, v31
    v_cvt_pk_bf16_f32 v57, v30, v31
    v_exp_f32 v32, v116
    s_nop 0
    v_add_f32 v26, v26, v32
    v_exp_f32 v33, v117
    s_nop 0
    v_add_f32 v26, v26, v33
    v_cvt_pk_bf16_f32 v58, v32, v33
    v_exp_f32 v34, v118
    s_nop 0
    v_add_f32 v26, v26, v34
    v_exp_f32 v35, v119
    s_nop 0
    v_add_f32 v26, v26, v35
    v_cvt_pk_bf16_f32 v59, v34, v35
    v_exp_f32 v28, v120
    v_exp_f32 v29, v121
    s_nop 0
    v_add_f32 v27, v28, v29
    v_cvt_pk_bf16_f32 v60, v28, v29
    v_exp_f32 v30, v122
    s_nop 0
    v_add_f32 v27, v27, v30
    v_exp_f32 v31, v123
    s_nop 0
    v_add_f32 v27, v27, v31
    v_cvt_pk_bf16_f32 v61, v30, v31
    v_exp_f32 v32, v124
    s_nop 0
    v_add_f32 v27, v27, v32
    v_exp_f32 v33, v125
    s_nop 0
    v_add_f32 v27, v27, v33
    v_cvt_pk_bf16_f32 v62, v32, v33
    v_exp_f32 v34, v126
    s_nop 0
    v_add_f32 v27, v27, v34
    v_exp_f32 v35, v127
    s_nop 0
    v_add_f32 v27, v27, v35
    v_cvt_pk_bf16_f32 v63, v34, v35
    s_branch RB_COMMON
RB_COMMON:
    v_accvgpr_read_b32 v38, a0
    v_accvgpr_read_b32 v39, a1
    v_accvgpr_read_b32 v40, a2
    v_accvgpr_read_b32 v41, a3
    v_mul_f32 v38, v42, v38
    v_mul_f32 v39, v42, v39
    v_mul_f32 v40, v42, v40
    v_mul_f32 v41, v42, v41
    v_accvgpr_write_b32 a0, v38
    v_accvgpr_write_b32 a1, v39
    v_accvgpr_write_b32 a2, v40
    v_accvgpr_write_b32 a3, v41
    v_accvgpr_read_b32 v38, a8
    v_accvgpr_read_b32 v39, a9
    v_accvgpr_read_b32 v40, a10
    v_accvgpr_read_b32 v41, a11
    v_mul_f32 v38, v43, v38
    v_mul_f32 v39, v43, v39
    v_mul_f32 v40, v43, v40
    v_mul_f32 v41, v43, v41
    v_accvgpr_write_b32 a8, v38
    v_accvgpr_write_b32 a9, v39
    v_accvgpr_write_b32 a10, v40
    v_accvgpr_write_b32 a11, v41
    v_accvgpr_read_b32 v38, a16
    v_accvgpr_read_b32 v39, a17
    v_accvgpr_read_b32 v40, a18
    v_accvgpr_read_b32 v41, a19
    v_mul_f32 v38, v44, v38
    v_mul_f32 v39, v44, v39
    v_mul_f32 v40, v44, v40
    v_mul_f32 v41, v44, v41
    v_accvgpr_write_b32 a16, v38
    v_accvgpr_write_b32 a17, v39
    v_accvgpr_write_b32 a18, v40
    v_accvgpr_write_b32 a19, v41
    v_accvgpr_read_b32 v38, a24
    v_accvgpr_read_b32 v39, a25
    v_accvgpr_read_b32 v40, a26
    v_accvgpr_read_b32 v41, a27
    v_mul_f32 v38, v45, v38
    v_mul_f32 v39, v45, v39
    v_mul_f32 v40, v45, v40
    v_mul_f32 v41, v45, v41
    v_accvgpr_write_b32 a24, v38
    v_accvgpr_write_b32 a25, v39
    v_accvgpr_write_b32 a26, v40
    v_accvgpr_write_b32 a27, v41
    v_accvgpr_read_b32 v38, a4
    v_accvgpr_read_b32 v39, a5
    v_accvgpr_read_b32 v40, a6
    v_accvgpr_read_b32 v41, a7
    v_mul_f32 v38, v42, v38
    v_mul_f32 v39, v42, v39
    v_mul_f32 v40, v42, v40
    v_mul_f32 v41, v42, v41
    v_accvgpr_write_b32 a4, v38
    v_accvgpr_write_b32 a5, v39
    v_accvgpr_write_b32 a6, v40
    v_accvgpr_write_b32 a7, v41
    v_accvgpr_read_b32 v38, a12
    v_accvgpr_read_b32 v39, a13
    v_accvgpr_read_b32 v40, a14
    v_accvgpr_read_b32 v41, a15
    v_mul_f32 v38, v43, v38
    v_mul_f32 v39, v43, v39
    v_mul_f32 v40, v43, v40
    v_mul_f32 v41, v43, v41
    v_accvgpr_write_b32 a12, v38
    v_accvgpr_write_b32 a13, v39
    v_accvgpr_write_b32 a14, v40
    v_accvgpr_write_b32 a15, v41
    v_accvgpr_read_b32 v38, a20
    v_accvgpr_read_b32 v39, a21
    v_accvgpr_read_b32 v40, a22
    v_accvgpr_read_b32 v41, a23
    v_mul_f32 v38, v44, v38
    v_mul_f32 v39, v44, v39
    v_mul_f32 v40, v44, v40
    v_mul_f32 v41, v44, v41
    v_accvgpr_write_b32 a20, v38
    v_accvgpr_write_b32 a21, v39
    v_accvgpr_write_b32 a22, v40
    v_accvgpr_write_b32 a23, v41
    v_accvgpr_read_b32 v38, a28
    v_accvgpr_read_b32 v39, a29
    v_accvgpr_read_b32 v40, a30
    v_accvgpr_read_b32 v41, a31
    v_mul_f32 v38, v45, v38
    v_mul_f32 v39, v45, v39
    v_mul_f32 v40, v45, v40
    v_mul_f32 v41, v45, v41
    v_accvgpr_write_b32 a28, v38
    v_accvgpr_write_b32 a29, v39
    v_accvgpr_write_b32 a30, v40
    v_accvgpr_write_b32 a31, v41
    v_accvgpr_read_b32 v38, a32
    v_accvgpr_read_b32 v39, a33
    v_accvgpr_read_b32 v40, a34
    v_accvgpr_read_b32 v41, a35
    v_mul_f32 v38, v42, v38
    v_mul_f32 v39, v42, v39
    v_mul_f32 v40, v42, v40
    v_mul_f32 v41, v42, v41
    v_accvgpr_write_b32 a32, v38
    v_accvgpr_write_b32 a33, v39
    v_accvgpr_write_b32 a34, v40
    v_accvgpr_write_b32 a35, v41
    v_accvgpr_read_b32 v38, a40
    v_accvgpr_read_b32 v39, a41
    v_accvgpr_read_b32 v40, a42
    v_accvgpr_read_b32 v41, a43
    v_mul_f32 v38, v43, v38
    v_mul_f32 v39, v43, v39
    v_mul_f32 v40, v43, v40
    v_mul_f32 v41, v43, v41
    v_accvgpr_write_b32 a40, v38
    v_accvgpr_write_b32 a41, v39
    v_accvgpr_write_b32 a42, v40
    v_accvgpr_write_b32 a43, v41
    v_accvgpr_read_b32 v38, a48
    v_accvgpr_read_b32 v39, a49
    v_accvgpr_read_b32 v40, a50
    v_accvgpr_read_b32 v41, a51
    v_mul_f32 v38, v44, v38
    v_mul_f32 v39, v44, v39
    v_mul_f32 v40, v44, v40
    v_mul_f32 v41, v44, v41
    v_accvgpr_write_b32 a48, v38
    v_accvgpr_write_b32 a49, v39
    v_accvgpr_write_b32 a50, v40
    v_accvgpr_write_b32 a51, v41
    v_accvgpr_read_b32 v38, a56
    v_accvgpr_read_b32 v39, a57
    v_accvgpr_read_b32 v40, a58
    v_accvgpr_read_b32 v41, a59
    v_mul_f32 v38, v45, v38
    v_mul_f32 v39, v45, v39
    v_mul_f32 v40, v45, v40
    v_mul_f32 v41, v45, v41
    v_accvgpr_write_b32 a56, v38
    v_accvgpr_write_b32 a57, v39
    v_accvgpr_write_b32 a58, v40
    v_accvgpr_write_b32 a59, v41
    v_accvgpr_read_b32 v38, a36
    v_accvgpr_read_b32 v39, a37
    v_accvgpr_read_b32 v40, a38
    v_accvgpr_read_b32 v41, a39
    v_mul_f32 v38, v42, v38
    v_mul_f32 v39, v42, v39
    v_mul_f32 v40, v42, v40
    v_mul_f32 v41, v42, v41
    v_accvgpr_write_b32 a36, v38
    v_accvgpr_write_b32 a37, v39
    v_accvgpr_write_b32 a38, v40
    v_accvgpr_write_b32 a39, v41
    v_accvgpr_read_b32 v38, a44
    v_accvgpr_read_b32 v39, a45
    v_accvgpr_read_b32 v40, a46
    v_accvgpr_read_b32 v41, a47
    v_mul_f32 v38, v43, v38
    v_mul_f32 v39, v43, v39
    v_mul_f32 v40, v43, v40
    v_mul_f32 v41, v43, v41
    v_accvgpr_write_b32 a44, v38
    v_accvgpr_write_b32 a45, v39
    v_accvgpr_write_b32 a46, v40
    v_accvgpr_write_b32 a47, v41
    v_accvgpr_read_b32 v38, a52
    v_accvgpr_read_b32 v39, a53
    v_accvgpr_read_b32 v40, a54
    v_accvgpr_read_b32 v41, a55
    v_mul_f32 v38, v44, v38
    v_mul_f32 v39, v44, v39
    v_mul_f32 v40, v44, v40
    v_mul_f32 v41, v44, v41
    v_accvgpr_write_b32 a52, v38
    v_accvgpr_write_b32 a53, v39
    v_accvgpr_write_b32 a54, v40
    v_accvgpr_write_b32 a55, v41
    v_accvgpr_read_b32 v38, a60
    v_accvgpr_read_b32 v39, a61
    v_accvgpr_read_b32 v40, a62
    v_accvgpr_read_b32 v41, a63
    v_mul_f32 v38, v45, v38
    v_mul_f32 v39, v45, v39
    v_mul_f32 v40, v45, v40
    v_mul_f32 v41, v45, v41
    v_accvgpr_write_b32 a60, v38
    v_accvgpr_write_b32 a61, v39
    v_accvgpr_write_b32 a62, v40
    v_accvgpr_write_b32 a63, v41
    v_accvgpr_read_b32 v38, a64
    v_accvgpr_read_b32 v39, a65
    v_accvgpr_read_b32 v40, a66
    v_accvgpr_read_b32 v41, a67
    v_mul_f32 v38, v42, v38
    v_mul_f32 v39, v42, v39
    v_mul_f32 v40, v42, v40
    v_mul_f32 v41, v42, v41
    v_accvgpr_write_b32 a64, v38
    v_accvgpr_write_b32 a65, v39
    v_accvgpr_write_b32 a66, v40
    v_accvgpr_write_b32 a67, v41
    v_accvgpr_read_b32 v38, a72
    v_accvgpr_read_b32 v39, a73
    v_accvgpr_read_b32 v40, a74
    v_accvgpr_read_b32 v41, a75
    v_mul_f32 v38, v43, v38
    v_mul_f32 v39, v43, v39
    v_mul_f32 v40, v43, v40
    v_mul_f32 v41, v43, v41
    v_accvgpr_write_b32 a72, v38
    v_accvgpr_write_b32 a73, v39
    v_accvgpr_write_b32 a74, v40
    v_accvgpr_write_b32 a75, v41
    v_accvgpr_read_b32 v38, a80
    v_accvgpr_read_b32 v39, a81
    v_accvgpr_read_b32 v40, a82
    v_accvgpr_read_b32 v41, a83
    v_mul_f32 v38, v44, v38
    v_mul_f32 v39, v44, v39
    v_mul_f32 v40, v44, v40
    v_mul_f32 v41, v44, v41
    v_accvgpr_write_b32 a80, v38
    v_accvgpr_write_b32 a81, v39
    v_accvgpr_write_b32 a82, v40
    v_accvgpr_write_b32 a83, v41
    v_accvgpr_read_b32 v38, a88
    v_accvgpr_read_b32 v39, a89
    v_accvgpr_read_b32 v40, a90
    v_accvgpr_read_b32 v41, a91
    v_mul_f32 v38, v45, v38
    v_mul_f32 v39, v45, v39
    v_mul_f32 v40, v45, v40
    v_mul_f32 v41, v45, v41
    v_accvgpr_write_b32 a88, v38
    v_accvgpr_write_b32 a89, v39
    v_accvgpr_write_b32 a90, v40
    v_accvgpr_write_b32 a91, v41
    v_accvgpr_read_b32 v38, a68
    v_accvgpr_read_b32 v39, a69
    v_accvgpr_read_b32 v40, a70
    v_accvgpr_read_b32 v41, a71
    v_mul_f32 v38, v42, v38
    v_mul_f32 v39, v42, v39
    v_mul_f32 v40, v42, v40
    v_mul_f32 v41, v42, v41
    v_accvgpr_write_b32 a68, v38
    v_accvgpr_write_b32 a69, v39
    v_accvgpr_write_b32 a70, v40
    v_accvgpr_write_b32 a71, v41
    v_accvgpr_read_b32 v38, a76
    v_accvgpr_read_b32 v39, a77
    v_accvgpr_read_b32 v40, a78
    v_accvgpr_read_b32 v41, a79
    v_mul_f32 v38, v43, v38
    v_mul_f32 v39, v43, v39
    v_mul_f32 v40, v43, v40
    v_mul_f32 v41, v43, v41
    v_accvgpr_write_b32 a76, v38
    v_accvgpr_write_b32 a77, v39
    v_accvgpr_write_b32 a78, v40
    v_accvgpr_write_b32 a79, v41
    v_accvgpr_read_b32 v38, a84
    v_accvgpr_read_b32 v39, a85
    v_accvgpr_read_b32 v40, a86
    v_accvgpr_read_b32 v41, a87
    v_mul_f32 v38, v44, v38
    v_mul_f32 v39, v44, v39
    v_mul_f32 v40, v44, v40
    v_mul_f32 v41, v44, v41
    v_accvgpr_write_b32 a84, v38
    v_accvgpr_write_b32 a85, v39
    v_accvgpr_write_b32 a86, v40
    v_accvgpr_write_b32 a87, v41
    v_accvgpr_read_b32 v38, a92
    v_accvgpr_read_b32 v39, a93
    v_accvgpr_read_b32 v40, a94
    v_accvgpr_read_b32 v41, a95
    v_mul_f32 v38, v45, v38
    v_mul_f32 v39, v45, v39
    v_mul_f32 v40, v45, v40
    v_mul_f32 v41, v45, v41
    v_accvgpr_write_b32 a92, v38
    v_accvgpr_write_b32 a93, v39
    v_accvgpr_write_b32 a94, v40
    v_accvgpr_write_b32 a95, v41
    v_accvgpr_read_b32 v38, a96
    v_accvgpr_read_b32 v39, a97
    v_accvgpr_read_b32 v40, a98
    v_accvgpr_read_b32 v41, a99
    v_mul_f32 v38, v42, v38
    v_mul_f32 v39, v42, v39
    v_mul_f32 v40, v42, v40
    v_mul_f32 v41, v42, v41
    v_accvgpr_write_b32 a96, v38
    v_accvgpr_write_b32 a97, v39
    v_accvgpr_write_b32 a98, v40
    v_accvgpr_write_b32 a99, v41
    v_accvgpr_read_b32 v38, a104
    v_accvgpr_read_b32 v39, a105
    v_accvgpr_read_b32 v40, a106
    v_accvgpr_read_b32 v41, a107
    v_mul_f32 v38, v43, v38
    v_mul_f32 v39, v43, v39
    v_mul_f32 v40, v43, v40
    v_mul_f32 v41, v43, v41
    v_accvgpr_write_b32 a104, v38
    v_accvgpr_write_b32 a105, v39
    v_accvgpr_write_b32 a106, v40
    v_accvgpr_write_b32 a107, v41
    v_accvgpr_read_b32 v38, a112
    v_accvgpr_read_b32 v39, a113
    v_accvgpr_read_b32 v40, a114
    v_accvgpr_read_b32 v41, a115
    v_mul_f32 v38, v44, v38
    v_mul_f32 v39, v44, v39
    v_mul_f32 v40, v44, v40
    v_mul_f32 v41, v44, v41
    v_accvgpr_write_b32 a112, v38
    v_accvgpr_write_b32 a113, v39
    v_accvgpr_write_b32 a114, v40
    v_accvgpr_write_b32 a115, v41
    v_accvgpr_read_b32 v38, a120
    v_accvgpr_read_b32 v39, a121
    v_accvgpr_read_b32 v40, a122
    v_accvgpr_read_b32 v41, a123
    v_mul_f32 v38, v45, v38
    v_mul_f32 v39, v45, v39
    v_mul_f32 v40, v45, v40
    v_mul_f32 v41, v45, v41
    v_accvgpr_write_b32 a120, v38
    v_accvgpr_write_b32 a121, v39
    v_accvgpr_write_b32 a122, v40
    v_accvgpr_write_b32 a123, v41
    v_accvgpr_read_b32 v38, a100
    v_accvgpr_read_b32 v39, a101
    v_accvgpr_read_b32 v40, a102
    v_accvgpr_read_b32 v41, a103
    v_mul_f32 v38, v42, v38
    v_mul_f32 v39, v42, v39
    v_mul_f32 v40, v42, v40
    v_mul_f32 v41, v42, v41
    v_accvgpr_write_b32 a100, v38
    v_accvgpr_write_b32 a101, v39
    v_accvgpr_write_b32 a102, v40
    v_accvgpr_write_b32 a103, v41
    v_accvgpr_read_b32 v38, a108
    v_accvgpr_read_b32 v39, a109
    v_accvgpr_read_b32 v40, a110
    v_accvgpr_read_b32 v41, a111
    v_mul_f32 v38, v43, v38
    v_mul_f32 v39, v43, v39
    v_mul_f32 v40, v43, v40
    v_mul_f32 v41, v43, v41
    v_accvgpr_write_b32 a108, v38
    v_accvgpr_write_b32 a109, v39
    v_accvgpr_write_b32 a110, v40
    v_accvgpr_write_b32 a111, v41
    v_accvgpr_read_b32 v38, a116
    v_accvgpr_read_b32 v39, a117
    v_accvgpr_read_b32 v40, a118
    v_accvgpr_read_b32 v41, a119
    v_mul_f32 v38, v44, v38
    v_mul_f32 v39, v44, v39
    v_mul_f32 v40, v44, v40
    v_mul_f32 v41, v44, v41
    v_accvgpr_write_b32 a116, v38
    v_accvgpr_write_b32 a117, v39
    v_accvgpr_write_b32 a118, v40
    v_accvgpr_write_b32 a119, v41
    v_accvgpr_read_b32 v38, a124
    v_accvgpr_read_b32 v39, a125
    v_accvgpr_read_b32 v40, a126
    v_accvgpr_read_b32 v41, a127
    v_mul_f32 v38, v45, v38
    v_mul_f32 v39, v45, v39
    v_mul_f32 v40, v45, v40
    v_mul_f32 v41, v45, v41
    v_accvgpr_write_b32 a124, v38
    v_accvgpr_write_b32 a125, v39
    v_accvgpr_write_b32 a126, v40
    v_accvgpr_write_b32 a127, v41
    v_accvgpr_read_b32 v38, a128
    v_accvgpr_read_b32 v39, a129
    v_accvgpr_read_b32 v40, a130
    v_accvgpr_read_b32 v41, a131
    v_mul_f32 v38, v42, v38
    v_mul_f32 v39, v42, v39
    v_mul_f32 v40, v42, v40
    v_mul_f32 v41, v42, v41
    v_accvgpr_write_b32 a128, v38
    v_accvgpr_write_b32 a129, v39
    v_accvgpr_write_b32 a130, v40
    v_accvgpr_write_b32 a131, v41
    v_accvgpr_read_b32 v38, a136
    v_accvgpr_read_b32 v39, a137
    v_accvgpr_read_b32 v40, a138
    v_accvgpr_read_b32 v41, a139
    v_mul_f32 v38, v43, v38
    v_mul_f32 v39, v43, v39
    v_mul_f32 v40, v43, v40
    v_mul_f32 v41, v43, v41
    v_accvgpr_write_b32 a136, v38
    v_accvgpr_write_b32 a137, v39
    v_accvgpr_write_b32 a138, v40
    v_accvgpr_write_b32 a139, v41
    v_accvgpr_read_b32 v38, a144
    v_accvgpr_read_b32 v39, a145
    v_accvgpr_read_b32 v40, a146
    v_accvgpr_read_b32 v41, a147
    v_mul_f32 v38, v44, v38
    v_mul_f32 v39, v44, v39
    v_mul_f32 v40, v44, v40
    v_mul_f32 v41, v44, v41
    v_accvgpr_write_b32 a144, v38
    v_accvgpr_write_b32 a145, v39
    v_accvgpr_write_b32 a146, v40
    v_accvgpr_write_b32 a147, v41
    v_accvgpr_read_b32 v38, a152
    v_accvgpr_read_b32 v39, a153
    v_accvgpr_read_b32 v40, a154
    v_accvgpr_read_b32 v41, a155
    v_mul_f32 v38, v45, v38
    v_mul_f32 v39, v45, v39
    v_mul_f32 v40, v45, v40
    v_mul_f32 v41, v45, v41
    v_accvgpr_write_b32 a152, v38
    v_accvgpr_write_b32 a153, v39
    v_accvgpr_write_b32 a154, v40
    v_accvgpr_write_b32 a155, v41
    v_accvgpr_read_b32 v38, a132
    v_accvgpr_read_b32 v39, a133
    v_accvgpr_read_b32 v40, a134
    v_accvgpr_read_b32 v41, a135
    v_mul_f32 v38, v42, v38
    v_mul_f32 v39, v42, v39
    v_mul_f32 v40, v42, v40
    v_mul_f32 v41, v42, v41
    v_accvgpr_write_b32 a132, v38
    v_accvgpr_write_b32 a133, v39
    v_accvgpr_write_b32 a134, v40
    v_accvgpr_write_b32 a135, v41
    v_accvgpr_read_b32 v38, a140
    v_accvgpr_read_b32 v39, a141
    v_accvgpr_read_b32 v40, a142
    v_accvgpr_read_b32 v41, a143
    v_mul_f32 v38, v43, v38
    v_mul_f32 v39, v43, v39
    v_mul_f32 v40, v43, v40
    v_mul_f32 v41, v43, v41
    v_accvgpr_write_b32 a140, v38
    v_accvgpr_write_b32 a141, v39
    v_accvgpr_write_b32 a142, v40
    v_accvgpr_write_b32 a143, v41
    v_accvgpr_read_b32 v38, a148
    v_accvgpr_read_b32 v39, a149
    v_accvgpr_read_b32 v40, a150
    v_accvgpr_read_b32 v41, a151
    v_mul_f32 v38, v44, v38
    v_mul_f32 v39, v44, v39
    v_mul_f32 v40, v44, v40
    v_mul_f32 v41, v44, v41
    v_accvgpr_write_b32 a148, v38
    v_accvgpr_write_b32 a149, v39
    v_accvgpr_write_b32 a150, v40
    v_accvgpr_write_b32 a151, v41
    v_accvgpr_read_b32 v38, a156
    v_accvgpr_read_b32 v39, a157
    v_accvgpr_read_b32 v40, a158
    v_accvgpr_read_b32 v41, a159
    v_mul_f32 v38, v45, v38
    v_mul_f32 v39, v45, v39
    v_mul_f32 v40, v45, v40
    v_mul_f32 v41, v45, v41
    v_accvgpr_write_b32 a156, v38
    v_accvgpr_write_b32 a157, v39
    v_accvgpr_write_b32 a158, v40
    v_accvgpr_write_b32 a159, v41
    v_accvgpr_read_b32 v38, a160
    v_accvgpr_read_b32 v39, a161
    v_accvgpr_read_b32 v40, a162
    v_accvgpr_read_b32 v41, a163
    v_mul_f32 v38, v42, v38
    v_mul_f32 v39, v42, v39
    v_mul_f32 v40, v42, v40
    v_mul_f32 v41, v42, v41
    v_accvgpr_write_b32 a160, v38
    v_accvgpr_write_b32 a161, v39
    v_accvgpr_write_b32 a162, v40
    v_accvgpr_write_b32 a163, v41
    v_accvgpr_read_b32 v38, a168
    v_accvgpr_read_b32 v39, a169
    v_accvgpr_read_b32 v40, a170
    v_accvgpr_read_b32 v41, a171
    v_mul_f32 v38, v43, v38
    v_mul_f32 v39, v43, v39
    v_mul_f32 v40, v43, v40
    v_mul_f32 v41, v43, v41
    v_accvgpr_write_b32 a168, v38
    v_accvgpr_write_b32 a169, v39
    v_accvgpr_write_b32 a170, v40
    v_accvgpr_write_b32 a171, v41
    v_accvgpr_read_b32 v38, a176
    v_accvgpr_read_b32 v39, a177
    v_accvgpr_read_b32 v40, a178
    v_accvgpr_read_b32 v41, a179
    v_mul_f32 v38, v44, v38
    v_mul_f32 v39, v44, v39
    v_mul_f32 v40, v44, v40
    v_mul_f32 v41, v44, v41
    v_accvgpr_write_b32 a176, v38
    v_accvgpr_write_b32 a177, v39
    v_accvgpr_write_b32 a178, v40
    v_accvgpr_write_b32 a179, v41
    v_accvgpr_read_b32 v38, a184
    v_accvgpr_read_b32 v39, a185
    v_accvgpr_read_b32 v40, a186
    v_accvgpr_read_b32 v41, a187
    v_mul_f32 v38, v45, v38
    v_mul_f32 v39, v45, v39
    v_mul_f32 v40, v45, v40
    v_mul_f32 v41, v45, v41
    v_accvgpr_write_b32 a184, v38
    v_accvgpr_write_b32 a185, v39
    v_accvgpr_write_b32 a186, v40
    v_accvgpr_write_b32 a187, v41
    v_accvgpr_read_b32 v38, a164
    v_accvgpr_read_b32 v39, a165
    v_accvgpr_read_b32 v40, a166
    v_accvgpr_read_b32 v41, a167
    v_mul_f32 v38, v42, v38
    v_mul_f32 v39, v42, v39
    v_mul_f32 v40, v42, v40
    v_mul_f32 v41, v42, v41
    v_accvgpr_write_b32 a164, v38
    v_accvgpr_write_b32 a165, v39
    v_accvgpr_write_b32 a166, v40
    v_accvgpr_write_b32 a167, v41
    v_accvgpr_read_b32 v38, a172
    v_accvgpr_read_b32 v39, a173
    v_accvgpr_read_b32 v40, a174
    v_accvgpr_read_b32 v41, a175
    v_mul_f32 v38, v43, v38
    v_mul_f32 v39, v43, v39
    v_mul_f32 v40, v43, v40
    v_mul_f32 v41, v43, v41
    v_accvgpr_write_b32 a172, v38
    v_accvgpr_write_b32 a173, v39
    v_accvgpr_write_b32 a174, v40
    v_accvgpr_write_b32 a175, v41
    v_accvgpr_read_b32 v38, a180
    v_accvgpr_read_b32 v39, a181
    v_accvgpr_read_b32 v40, a182
    v_accvgpr_read_b32 v41, a183
    v_mul_f32 v38, v44, v38
    v_mul_f32 v39, v44, v39
    v_mul_f32 v40, v44, v40
    v_mul_f32 v41, v44, v41
    v_accvgpr_write_b32 a180, v38
    v_accvgpr_write_b32 a181, v39
    v_accvgpr_write_b32 a182, v40
    v_accvgpr_write_b32 a183, v41
    v_accvgpr_read_b32 v38, a188
    v_accvgpr_read_b32 v39, a189
    v_accvgpr_read_b32 v40, a190
    v_accvgpr_read_b32 v41, a191
    v_mul_f32 v38, v45, v38
    v_mul_f32 v39, v45, v39
    v_mul_f32 v40, v45, v40
    v_mul_f32 v41, v45, v41
    v_accvgpr_write_b32 a188, v38
    v_accvgpr_write_b32 a189, v39
    v_accvgpr_write_b32 a190, v40
    v_accvgpr_write_b32 a191, v41
    s_nop 3
    s_cmp_eq_u32 s51, 0
    s_cbranch_scc1 RA_RET_E
    s_cmp_eq_u32 s51, 1
    s_cbranch_scc1 RA_RET_O
    s_cmp_eq_u32 s51, 2
    s_cbranch_scc1 RA_RET_G
    s_cmp_eq_u32 s51, 3
    s_cbranch_scc1 RA_RET_H
    s_cmp_eq_u32 s51, 4
    s_cbranch_scc1 RA_RET_X
    s_branch RA_RET_F
H1B_SLOW:
    s_mov_b32 s52, 262144
H1B_POLL:
    global_load_dword v48, v3, s[6:7] offset:32 sc1
    s_sub_u32 s52, s52, 1
    s_waitcnt vmcnt(0)
    s_cbranch_scc1 H1B_OK
    v_cmp_ne_u32 vcc, s5, v48
    s_cbranch_vccz H1B_OK
    s_sleep 1
    s_branch H1B_POLL
.section .rodata,"a"
.p2align 6
.amdhsa_kernel standalone__gqa_block_cached__near_ridge_kernel
  .amdhsa_next_free_vgpr 512
  .amdhsa_next_free_sgpr 102
  .amdhsa_accum_offset 256
  .amdhsa_group_segment_fixed_size 0
  .amdhsa_kernarg_size 64
  .amdhsa_user_sgpr_count 2
  .amdhsa_user_sgpr_kernarg_segment_ptr 1
  .amdhsa_system_sgpr_workgroup_id_x 1
.end_amdhsa_kernel
```
